```python
import torch

def _softmax(x, axis=-1):
    return torch.softmax(x, dim=axis)
def _gelu(x):
    return torch.nn.functional.gelu(x, approximate="tanh")
def _silu(x):
    return torch.nn.functional.silu(x)
def _sigmoid(x):
    return torch.sigmoid(x)
def _layernorm(x, axis=-1, eps=1e-5):
    m = x.mean(dim=axis, keepdim=True)
    v = x.var(dim=axis, keepdim=True, unbiased=False)
    return (x - m) / torch.sqrt(v + eps)
def _scatter_add(tgt, idx, src, axis=0):
    return tgt.clone().index_add_(axis, idx, src)
def _segment_sum(src, seg, n):
    out = torch.zeros((n,) + src.shape[1:], dtype=src.dtype)
    return out.index_add_(0, seg, src)
def _pad(x, pw):
    flat = tuple(v for pair in reversed(pw) for v in pair)
    return torch.nn.functional.pad(x, flat)

kernel_name = 'interleave_layers__spectral_fnet__glu_gated_glu__prompt'

def setup_inputs():

    _w = (lambda a: (lambda t: t.to(torch.bfloat16) if t.is_floating_point() else t)(torch.as_tensor(a)))
    def _A_setup():
        B, S, D = 1, 2048, 640
        ns = torch.arange(S)[:, None] * torch.arange(S)[None, :]
        nd = torch.arange(D)[:, None] * torch.arange(D)[None, :]
        Ws_re = torch.cos(-2.0 * torch.pi * ns / S).to(float)
        Ws_im = torch.sin(-2.0 * torch.pi * ns / S).to(float)
        Wd_re = torch.cos(-2.0 * torch.pi * nd / D).to(float)
        Wd_im = torch.sin(-2.0 * torch.pi * nd / D).to(float)
        return {
            "x": _w((lambda *s: torch.randn(*s, dtype=torch.bfloat16) * 0.05)(B, S, D)),
            "dft_seq_re": _w(Ws_re),
            "dft_seq_im": _w(Ws_im),
            "dft_hid_re": _w(Wd_re),
            "dft_hid_im": _w(Wd_im),
        }
    _A_in = _A_setup()

    def _B_setup():
        B, S, D, F = 1, 2048, 640, 1536
        return {
            "x": _w((lambda *s: torch.randn(*s, dtype=torch.bfloat16) * 0.05)(B, S, D)),
            "w_gate": _w((lambda *s: torch.randn(*s, dtype=torch.bfloat16) * 1.6)(D, F)),
            "w_up": _w((lambda *s: torch.randn(*s, dtype=torch.bfloat16) * 0.8)(D, F)),
            "w_down": _w((lambda *s: torch.randn(*s, dtype=torch.bfloat16) * 0.8)(F, D)),
        }
    _B_in = _B_setup()

    return {
        "A_x": _A_in["x"],
        "A_dft_seq_re": _A_in["dft_seq_re"],
        "A_dft_seq_im": _A_in["dft_seq_im"],
        "A_dft_hid_re": _A_in["dft_hid_re"],
        "A_dft_hid_im": _A_in["dft_hid_im"],
        "B_x": _B_in["x"],
        "B_w_gate": _B_in["w_gate"],
        "B_w_up": _B_in["w_up"],
        "B_w_down": _B_in["w_down"],
    }

def reference(A_x, A_dft_seq_re, A_dft_seq_im, A_dft_hid_re, A_dft_hid_im, B_x, B_w_gate, B_w_up, B_w_down):
    def _A_ref(x, dft_seq_re, dft_seq_im, dft_hid_re, dft_hid_im):
        a = torch.einsum("bsd,ed->bse", x, dft_hid_re)
        b = torch.einsum("bsd,ed->bse", x, dft_hid_im)
        y = torch.einsum("ts,bse->bte", dft_seq_re, a) - torch.einsum("ts,bse->bte", dft_seq_im, b)
        return y

    def _B_ref(x, w_gate, w_up, w_down):
        g = torch.einsum("bsd,df->bsf", x, w_gate)
        u = torch.einsum("bsd,df->bsf", x, w_up)
        h = _sigmoid(g) * u
        return torch.einsum("bsf,fd->bsd", h, w_down)

    x = A_x
    x = x + _A_ref(_layernorm(x, axis=-1), A_dft_seq_re, A_dft_seq_im, A_dft_hid_re, A_dft_hid_im)
    x = x + _B_ref(_layernorm(x, axis=-1), B_w_gate, B_w_up, B_w_down)
    x = x + _A_ref(_layernorm(x, axis=-1), A_dft_seq_re, A_dft_seq_im, A_dft_hid_re, A_dft_hid_im)
    x = x + _B_ref(_layernorm(x, axis=-1), B_w_gate, B_w_up, B_w_down)
    return x
```

```asm
; @launch grid=(256,1,1) block=(256,1,1) lds=162816
.amdgcn_target "amdgcn-amd-amdhsa--gfx950"
.text
.p2align 8
.globl interleave_layers__spectral_fnet__glu_gated_glu__prompt_kernel
.type interleave_layers__spectral_fnet__glu_gated_glu__prompt_kernel,@function
interleave_layers__spectral_fnet__glu_gated_glu__prompt_kernel:
    s_cmp_ge_u32 s2, 256
    s_cbranch_scc1 interleave_layers__spectral_fnet__glu_gated_glu__prompt_kernel_end
    s_load_dwordx2 s[4:5], s[0:1], 88
    s_load_dwordx2 s[6:7], s[0:1], 0
    s_load_dwordx4 s[16:19], s[0:1], 48
    s_load_dwordx2 s[26:27], s[0:1], 64
    s_load_dwordx2 s[98:99], s[0:1], 72
    v_lshrrev_b32 v1, 6, v0
    v_and_b32 v2, 63, v0
    v_readfirstlane_b32 s32, v1
    v_lshlrev_b32 v3, 4, v2
    v_lshrrev_b32 v4, 4, v2
    v_and_b32 v8, 15, v2
    s_getpc_b64 s[60:61]
pc_1:
    s_add_u32 s60, s60, interleave_layers__spectral_fnet__glu_gated_glu__prompt_kernel - pc_1
    s_addc_u32 s61, s61, -1
    s_lshr_b32 s56, s2, 3
    s_lshl_b32 s56, s56, 2
    s_add_u32 s56, s56, s32
    s_lshl_b32 s56, s56, 10
    s_min_u32 s56, s56, code_end - interleave_layers__spectral_fnet__glu_gated_glu__prompt_kernel - 1024
    v_add_u32 v42, s56, v3
    global_load_dwordx4 v[236:239], v42, s[60:61]
    s_and_b32 s28, s2, 7
    s_lshr_b32 s29, s2, 3
    s_lshr_b32 s20, s28, 2
    s_lshl_b32 s20, s20, 3
    s_and_b32 s33, s29, 7
    s_add_u32 s20, s20, s33
    s_and_b32 s21, s28, 3
    s_lshl_b32 s21, s21, 2
    s_lshr_b32 s33, s29, 3
    s_add_u32 s21, s21, s33
    s_and_b32 s28, s2, 7
    s_lshr_b32 s24, s2, 3
    s_lshr_b32 s22, s24, 3
    s_lshl_b32 s22, s22, 3
    s_add_u32 s22, s22, s28
    s_and_b32 s24, s24, 7
    s_lshr_b32 s28, s22, 1
    s_sub_u32 s23, 32, s28
    s_cmp_eq_u32 s28, 0
    s_cselect_b32 s23, 16, s23
    s_bitcmp1_b32 s22, 0
    s_cselect_b32 s23, s23, s28
    v_xor_b32 v5, v4, v2
    v_and_b32 v5, 7, v5
    v_lshlrev_b32 v5, 4, v5
    v_lshrrev_b32 v6, 3, v2
    v_mul_u32_u24 v9, 81920, v6
    v_add_u32 v9, v9, v5
    v_xor_b32 v5, 64, v9
    v_add_u32 v5, 655360, v5
    s_lshr_b32 s33, s32, 1
    s_lshl_b32 s33, s33, 5
    s_add_u32 s33, s33, s23
    s_and_b32 s34, s32, 1
    s_lshl_b32 s34, s34, 10
    s_add_u32 s33, s33, s34
    s_mul_i32 s33, s33, 1280
    s_mul_i32 s35, s32, 20480
    s_add_u32 s35, s35, 57600
    s_min_u32 s36, s2, 191
    s_cmp_ge_u32 s36, 96
    s_cselect_b32 s46, 1, 0
    s_cselect_b32 s37, 96, 0
    s_sub_u32 s37, s36, s37
    s_and_b32 s38, s37, 3
    s_lshr_b32 s37, s37, 2
    v_lshrrev_b32 v10, 3, v2
    v_mul_u32_u24 v10, 3072, v10
    v_and_b32 v11, 7, v2
    v_lshl_add_u32 v11, v11, 4, v10
    s_mul_i32 s40, s38, 491520
    s_mul_i32 s41, s32, 122880
    s_add_u32 s40, s40, s41
    s_lshl_b32 s41, s37, 7
    s_add_u32 s40, s40, s41
    s_mul_i32 s42, s32, 5120
    s_add_u32 s42, s42, 37120
    s_and_b32 s34, s24, 1
    s_mul_i32 s34, s34, 640
    s_add_u32 s39, s33, 640
    s_sub_u32 s39, s39, s34
    s_add_u32 s33, s33, s34
    v_mov_b32 v40, v9
    v_mov_b32 v41, v5
    v_lshrrev_b32 v23, 2, v8
    v_bfe_u32 v24, v8, 1, 1
    v_and_b32 v25, 1, v8
    s_mul_i32 s43, s24, 40
    s_add_u32 s43, s43, 1
    v_lshlrev_b32 v26, 3, v23
    v_add3_u32 v26, v26, v24, s43
    v_lshlrev_b32 v27, 1, v23
    v_add3_u32 v27, v27, v24, s43
    v_add_u32 v27, 32, v27
    v_cvt_f32_u32 v26, v26
    v_cvt_f32_u32 v27, v27
    v_add_f32 v28, 0x00000000, v26
    v_mul_f32 v12, 0x3acccccd, v28
    v_add_f32 v28, 0x40000000, v26
    v_mul_f32 v13, 0x3acccccd, v28
    v_add_f32 v28, 0x40800000, v26
    v_mul_f32 v14, 0x3acccccd, v28
    v_add_f32 v28, 0x40c00000, v26
    v_mul_f32 v15, 0x3acccccd, v28
    v_mul_f32 v16, 0x3acccccd, v27
    v_cvt_f32_u32 v17, v25
    v_mul_f32 v17, 0x3e800000, v17
    v_lshlrev_b32 v28, 3, v4
    v_lshl_add_u32 v28, v1, 1, v28
    v_cvt_f32_u32 v28, v28
    v_add_f32 v18, 0x00000000, v28
    v_add_f32 v19, 0x42000000, v28
    v_add_f32 v20, 0x42800000, v28
    v_add_f32 v21, 0x42c00000, v28
    v_add_f32 v22, 0x43000000, v28
    v_lshl_add_u32 v27, v1, 2, v3
    v_add_u32 v27, 11520, v27
    v_fma_f32 v28, v12, v18, v17
    v_add_f32 v29, v28, v12
    v_cos_f32 v28, v28
    v_cos_f32 v29, v29
    s_nop 0
    v_cvt_pk_bf16_f32 v30, v28, v29
    ds_write_b32 v27, v30 offset:0
    v_fma_f32 v31, v12, v19, v17
    v_add_f32 v32, v31, v12
    v_cos_f32 v31, v31
    v_cos_f32 v32, v32
    s_nop 0
    v_cvt_pk_bf16_f32 v33, v31, v32
    ds_write_b32 v27, v33 offset:1024
    v_fma_f32 v34, v12, v20, v17
    v_add_f32 v35, v34, v12
    v_cos_f32 v34, v34
    v_cos_f32 v35, v35
    s_nop 0
    v_cvt_pk_bf16_f32 v36, v34, v35
    ds_write_b32 v27, v36 offset:2048
    v_fma_f32 v37, v12, v21, v17
    v_add_f32 v38, v37, v12
    v_cos_f32 v37, v37
    v_cos_f32 v38, v38
    s_nop 0
    v_cvt_pk_bf16_f32 v39, v37, v38
    ds_write_b32 v27, v39 offset:3072
    v_fma_f32 v28, v12, v22, v17
    v_add_f32 v29, v28, v12
    v_cos_f32 v28, v28
    v_cos_f32 v29, v29
    s_nop 0
    v_cvt_pk_bf16_f32 v30, v28, v29
    ds_write_b32 v27, v30 offset:4096
    s_waitcnt lgkmcnt(0)
    s_mov_b32 s8, s4
    s_mov_b32 s9, s5
    s_mov_b32 s10, 268435456
    s_mov_b32 s11, 0x20000
    s_mov_b32 s12, s6
    s_mov_b32 s13, s7
    s_mov_b32 s14, 2621440
    s_mov_b32 s15, 0x20000
    s_add_u32 m0, s35, 0
    s_nop 0
    buffer_load_dwordx4 v40, s[12:15], s33 offen offset:0  lds
    s_add_u32 m0, s35, 1024
    s_nop 0
    buffer_load_dwordx4 v41, s[12:15], s33 offen offset:0  lds
    s_add_u32 m0, s35, 1920
    s_nop 0
    buffer_load_dwordx4 v40, s[12:15], s33 offen offset:128  lds
    s_add_u32 m0, s35, 2944
    s_nop 0
    buffer_load_dwordx4 v41, s[12:15], s33 offen offset:128  lds
    s_add_u32 m0, s35, 3840
    s_nop 0
    buffer_load_dwordx4 v40, s[12:15], s33 offen offset:256  lds
    s_add_u32 m0, s35, 4864
    s_nop 0
    buffer_load_dwordx4 v41, s[12:15], s33 offen offset:256  lds
    s_cmp_eq_u32 s46, 0
    s_cselect_b32 s48, s16, s18
    s_cselect_b32 s49, s17, s19
    s_cmp_lt_u32 s2, 192
    s_cselect_b32 s50, 1966080, 0
    s_mov_b32 s51, 0x20000
    s_add_u32 m0, s42, 0
    s_nop 0
    buffer_load_dwordx4 v11, s[48:51], s40 offen nt lds
    s_add_u32 s40, s40, 24576
    s_add_u32 m0, s42, 1024
    s_nop 0
    buffer_load_dwordx4 v11, s[48:51], s40 offen nt lds
    s_add_u32 s40, s40, 24576
    s_add_u32 m0, s42, 2048
    s_nop 0
    buffer_load_dwordx4 v11, s[48:51], s40 offen nt lds
    s_add_u32 s40, s40, 24576
    s_add_u32 m0, s42, 3072
    s_nop 0
    buffer_load_dwordx4 v11, s[48:51], s40 offen nt lds
    s_add_u32 s40, s40, 24576
    s_add_u32 m0, s42, 4096
    s_nop 0
    buffer_load_dwordx4 v11, s[48:51], s40 offen nt lds
    s_add_u32 s60, s4, 37224448
    s_addc_u32 s61, s5, 0
    s_load_dwordx2 s[100:101], s[60:61], 0
    v_fma_f32 v31, v13, v18, v17
    v_add_f32 v32, v31, v13
    v_cos_f32 v31, v31
    v_cos_f32 v32, v32
    s_nop 0
    v_cvt_pk_bf16_f32 v33, v31, v32
    ds_write_b32 v27, v33 offset:5120
    v_fma_f32 v34, v13, v19, v17
    v_add_f32 v35, v34, v13
    v_cos_f32 v34, v34
    v_cos_f32 v35, v35
    s_nop 0
    v_cvt_pk_bf16_f32 v36, v34, v35
    ds_write_b32 v27, v36 offset:6144
    v_fma_f32 v37, v13, v20, v17
    v_add_f32 v38, v37, v13
    v_cos_f32 v37, v37
    v_cos_f32 v38, v38
    s_nop 0
    v_cvt_pk_bf16_f32 v39, v37, v38
    ds_write_b32 v27, v39 offset:7168
    v_fma_f32 v28, v13, v21, v17
    v_add_f32 v29, v28, v13
    v_cos_f32 v28, v28
    v_cos_f32 v29, v29
    s_nop 0
    v_cvt_pk_bf16_f32 v30, v28, v29
    ds_write_b32 v27, v30 offset:8192
    v_fma_f32 v31, v13, v22, v17
    v_add_f32 v32, v31, v13
    v_cos_f32 v31, v31
    v_cos_f32 v32, v32
    s_nop 0
    v_cvt_pk_bf16_f32 v33, v31, v32
    ds_write_b32 v27, v33 offset:9216
    v_fma_f32 v34, v14, v18, v17
    v_add_f32 v35, v34, v14
    v_cos_f32 v34, v34
    v_cos_f32 v35, v35
    s_nop 0
    v_cvt_pk_bf16_f32 v36, v34, v35
    ds_write_b32 v27, v36 offset:10240
    v_fma_f32 v37, v14, v19, v17
    v_add_f32 v38, v37, v14
    v_cos_f32 v37, v37
    v_cos_f32 v38, v38
    s_nop 0
    v_cvt_pk_bf16_f32 v39, v37, v38
    ds_write_b32 v27, v39 offset:11264
    v_fma_f32 v28, v14, v20, v17
    v_add_f32 v29, v28, v14
    v_cos_f32 v28, v28
    v_cos_f32 v29, v29
    s_nop 0
    v_cvt_pk_bf16_f32 v30, v28, v29
    ds_write_b32 v27, v30 offset:12288
    v_fma_f32 v31, v14, v21, v17
    v_add_f32 v32, v31, v14
    v_cos_f32 v31, v31
    v_cos_f32 v32, v32
    s_nop 0
    v_cvt_pk_bf16_f32 v33, v31, v32
    ds_write_b32 v27, v33 offset:13312
    v_fma_f32 v34, v14, v22, v17
    v_add_f32 v35, v34, v14
    v_cos_f32 v34, v34
    v_cos_f32 v35, v35
    s_nop 0
    v_cvt_pk_bf16_f32 v36, v34, v35
    ds_write_b32 v27, v36 offset:14336
    v_fma_f32 v37, v15, v18, v17
    v_add_f32 v38, v37, v15
    v_cos_f32 v37, v37
    v_cos_f32 v38, v38
    s_nop 0
    v_cvt_pk_bf16_f32 v39, v37, v38
    ds_write_b32 v27, v39 offset:15360
    v_fma_f32 v28, v15, v19, v17
    v_add_f32 v29, v28, v15
    v_cos_f32 v28, v28
    v_cos_f32 v29, v29
    s_nop 0
    v_cvt_pk_bf16_f32 v30, v28, v29
    ds_write_b32 v27, v30 offset:16384
    v_fma_f32 v31, v15, v20, v17
    v_add_f32 v32, v31, v15
    v_cos_f32 v31, v31
    v_cos_f32 v32, v32
    s_nop 0
    v_cvt_pk_bf16_f32 v33, v31, v32
    ds_write_b32 v27, v33 offset:17408
    v_fma_f32 v34, v15, v21, v17
    v_add_f32 v35, v34, v15
    v_cos_f32 v34, v34
    v_cos_f32 v35, v35
    s_nop 0
    v_cvt_pk_bf16_f32 v36, v34, v35
    ds_write_b32 v27, v36 offset:18432
    v_fma_f32 v37, v15, v22, v17
    v_add_f32 v38, v37, v15
    v_cos_f32 v37, v37
    v_cos_f32 v38, v38
    s_nop 0
    v_cvt_pk_bf16_f32 v39, v37, v38
    ds_write_b32 v27, v39 offset:19456
    v_fma_f32 v28, v16, v18, v17
    v_add_f32 v29, v28, v16
    v_cos_f32 v28, v28
    v_cos_f32 v29, v29
    s_nop 0
    v_cvt_pk_bf16_f32 v30, v28, v29
    ds_write_b32 v27, v30 offset:20480
    v_fma_f32 v31, v16, v19, v17
    v_add_f32 v32, v31, v16
    v_cos_f32 v31, v31
    v_cos_f32 v32, v32
    s_nop 0
    v_cvt_pk_bf16_f32 v33, v31, v32
    ds_write_b32 v27, v33 offset:21504
    v_fma_f32 v34, v16, v20, v17
    v_add_f32 v35, v34, v16
    v_cos_f32 v34, v34
    v_cos_f32 v35, v35
    s_nop 0
    v_cvt_pk_bf16_f32 v36, v34, v35
    ds_write_b32 v27, v36 offset:22528
    v_fma_f32 v37, v16, v21, v17
    v_add_f32 v38, v37, v16
    v_cos_f32 v37, v37
    v_cos_f32 v38, v38
    s_nop 0
    v_cvt_pk_bf16_f32 v39, v37, v38
    ds_write_b32 v27, v39 offset:23552
    v_fma_f32 v28, v16, v22, v17
    v_add_f32 v29, v28, v16
    v_cos_f32 v28, v28
    v_cos_f32 v29, v29
    s_nop 0
    v_cvt_pk_bf16_f32 v30, v28, v29
    ds_write_b32 v27, v30 offset:24576
    v_lshlrev_b32 v26, 31, v24
    v_xor_b32 v232, 0xbf800000, v26
    v_or_b32 v26, v24, v25
    v_lshlrev_b32 v26, 31, v26
    v_xor_b32 v233, 1.0, v26
    v_xor_b32 v234, 0xbf800000, v26
    v_lshlrev_b32 v26, 31, v23
    v_xor_b32 v235, v233, v26
    v_mov_b32 v108, 0x3f803f80
    v_mov_b32 v109, 0x3f803f80
    v_mov_b32 v110, 0x3f803f80
    v_mov_b32 v111, 0x3f803f80
    v_mul_u32_u24 v10, 80, v4
    v_lshrrev_b32 v29, 1, v8
    v_xor_b32 v29, v29, v4
    v_lshlrev_b32 v29, 4, v29
    v_lshl_add_u32 v9, v8, 7, v29
    v_xor_b32 v5, 64, v9
    v_add_u32 v9, s35, v9
    v_add_u32 v5, s35, v5
    v_bfe_u32 v13, v2, 2, 2
    v_and_b32 v14, 3, v2
    s_waitcnt lgkmcnt(0)
    s_barrier
    s_add_u32 s100, s100, 0x7f4a7c15
    s_addc_u32 s101, s101, 0x9e3779b9
    v_add_u32 v27, 11520, v3
    ds_read_b128 a[0:3], v27 offset:0
    ds_read_b128 a[4:7], v27 offset:1024
    ds_read_b128 a[8:11], v27 offset:2048
    ds_read_b128 a[12:15], v27 offset:3072
    ds_read_b128 a[16:19], v27 offset:4096
    ds_read_b128 a[20:23], v27 offset:5120
    ds_read_b128 a[24:27], v27 offset:6144
    ds_read_b128 a[28:31], v27 offset:7168
    ds_read_b128 a[32:35], v27 offset:8192
    ds_read_b128 a[36:39], v27 offset:9216
    ds_read_b128 a[40:43], v27 offset:10240
    ds_read_b128 a[44:47], v27 offset:11264
    ds_read_b128 a[48:51], v27 offset:12288
    ds_read_b128 a[52:55], v27 offset:13312
    ds_read_b128 a[56:59], v27 offset:14336
    ds_read_b128 a[60:63], v27 offset:15360
    ds_read_b128 a[64:67], v27 offset:16384
    ds_read_b128 a[68:71], v27 offset:17408
    ds_read_b128 a[72:75], v27 offset:18432
    ds_read_b128 a[76:79], v27 offset:19456
    ds_read_b128 a[80:83], v27 offset:20480
    ds_read_b128 a[84:87], v27 offset:21504
    ds_read_b128 a[88:91], v27 offset:22528
    ds_read_b128 a[92:95], v27 offset:23552
    ds_read_b128 a[96:99], v27 offset:24576
    s_mul_i32 s25, s36, 10240
    s_mul_i32 s41, s32, 320
    s_add_u32 s25, s25, s41
    s_mul_i32 s41, s32, 3072
    s_add_u32 s41, s41, 150528
    v_add_u32 v17, 0, v2
    v_mul_u32_u24 v18, 3277, v17
    v_lshrrev_b32 v18, 16, v18
    v_min_u32 v18, 7, v18
    v_mul_u32_u24 v18, 960, v18
    v_lshl_add_u32 v176, v17, 4, v18
    v_add_u32 v17, 64, v2
    v_mul_u32_u24 v18, 3277, v17
    v_lshrrev_b32 v18, 16, v18
    v_min_u32 v18, 7, v18
    v_mul_u32_u24 v18, 960, v18
    v_lshl_add_u32 v177, v17, 4, v18
    v_add_u32 v17, 128, v2
    v_mul_u32_u24 v18, 3277, v17
    v_lshrrev_b32 v18, 16, v18
    v_min_u32 v18, 7, v18
    v_mul_u32_u24 v18, 960, v18
    v_lshl_add_u32 v178, v17, 4, v18
    s_add_u32 m0, s35, 5760
    s_nop 0
    buffer_load_dwordx4 v40, s[12:15], s33 offen offset:384  lds
    s_add_u32 m0, s35, 6784
    s_nop 0
    buffer_load_dwordx4 v41, s[12:15], s33 offen offset:384  lds
    s_add_u32 m0, s35, 7680
    s_nop 0
    buffer_load_dwordx4 v40, s[12:15], s33 offen offset:512  lds
    s_add_u32 m0, s35, 8704
    s_nop 0
    buffer_load_dwordx4 v41, s[12:15], s33 offen offset:512  lds
    v_mov_b32 v179, v40
    v_mov_b32 v180, v41
    v_lshl_add_u32 v12, v4, 3, v13
    v_lshlrev_b32 v12, 7, v12
    v_lshl_add_u32 v12, v14, 4, v12
    s_lshr_b32 s44, s32, 1
    s_lshl_b32 s45, s44, 6
    s_and_b32 s52, s32, 1
    s_lshl_b32 s53, s52, 3
    s_add_u32 s45, s45, s53
    v_add_u32 v12, s45, v12
    v_mov_b32 v181, v12
    s_lshl_b32 s45, s37, 1
    s_add_u32 s45, s45, s44
    s_mul_i32 s47, s45, 86
    s_lshr_b32 s47, s47, 8
    s_mul_i32 s53, s47, 3
    s_sub_u32 s45, s45, s53
    s_lshl_b32 s45, s45, 1
    s_add_u32 s45, s45, s52
    s_lshl_b32 s28, s45, 1
    s_add_u32 s28, s28, s46
    s_mul_i32 s29, s47, 245760
    s_add_u32 s29, s29, 30408704
    s_mul_i32 s30, s45, 24
    s_add_u32 s30, s30, s46
    s_add_u32 s30, s30, 80
    s_mul_i32 s31, s38, 5
    s_lshl_b32 s55, s38, 4
    s_add_u32 s55, s55, s47
    s_mul_i32 s55, s55, 12
    s_add_u32 s55, s55, s28
    s_lshl_b32 s55, s55, 6
    s_add_u32 s55, s55, 36700160
    v_lshlrev_b32 v16, 4, v4
    s_lshl_b32 s62, s47, 6
    s_lshl_b32 s63, s28, 2
    s_add_u32 s62, s62, s63
    s_add_u32 s62, s62, s38
    s_lshl_b32 s63, s2, 2
    s_add_u32 s63, s63, s32
    s_add_u32 s63, s63, 256
    s_cmp_lt_u32 s2, 192
    s_cselect_b32 s62, s62, s63
    s_cselect_b32 s18, 268435456, 0
    s_mov_b32 s16, s4
    s_mov_b32 s17, s5
    s_mov_b32 s19, 0x20000
    s_waitcnt lgkmcnt(0)
    s_waitcnt vmcnt(13)
    ds_read_b128 v[216:219], v9 offset:0
    s_waitcnt vmcnt(13)
    ds_read_b128 v[220:223], v5 offset:0
    s_waitcnt vmcnt(11)
    ds_read_b128 v[224:227], v9 offset:2048
    s_waitcnt lgkmcnt(2)
    v_mfma_f32_16x16x32_bf16 v[20:23], v[216:219], a[0:3], 0
    s_add_u32 m0, s35, 10240
    s_nop 0
    buffer_load_dwordx4 v179, s[12:15], s39 offen offset:0  lds
    v_mfma_f32_16x16x32_bf16 v[24:27], v[216:219], a[20:23], 0
    v_mfma_f32_16x16x32_bf16 v[28:31], v[216:219], a[40:43], 0
    v_mfma_f32_16x16x32_bf16 v[32:35], v[216:219], a[60:63], 0
    s_add_u32 m0, s35, 11264
    s_nop 0
    buffer_load_dwordx4 v180, s[12:15], s39 offen offset:0  lds
    v_mfma_f32_16x16x32_bf16 v[36:39], v[216:219], a[80:83], 0
    v_mfma_f32_16x16x32_bf16 v[100:103], v[216:219], v[108:111], 0
    v_mfma_f32_16x16x32_bf16 v[104:107], v[216:219], v[216:219], 0
    s_waitcnt vmcnt(13)
    ds_read_b128 v[228:231], v5 offset:2048
    s_waitcnt lgkmcnt(2)
    v_mfma_f32_16x16x32_bf16 v[20:23], v[220:223], a[4:7], v[20:23]
    s_add_u32 m0, s35, 12160
    s_nop 0
    buffer_load_dwordx4 v179, s[12:15], s39 offen offset:128  lds
    v_mfma_f32_16x16x32_bf16 v[24:27], v[220:223], a[24:27], v[24:27]
    v_mfma_f32_16x16x32_bf16 v[28:31], v[220:223], a[44:47], v[28:31]
    v_mfma_f32_16x16x32_bf16 v[32:35], v[220:223], a[64:67], v[32:35]
    s_add_u32 m0, s35, 13184
    s_nop 0
    buffer_load_dwordx4 v180, s[12:15], s39 offen offset:128  lds
    v_mfma_f32_16x16x32_bf16 v[36:39], v[220:223], a[84:87], v[36:39]
    v_mfma_f32_16x16x32_bf16 v[100:103], v[220:223], v[108:111], v[100:103]
    v_mfma_f32_16x16x32_bf16 v[104:107], v[220:223], v[220:223], v[104:107]
    s_waitcnt vmcnt(13)
    ds_read_b128 v[216:219], v9 offset:4096
    s_waitcnt lgkmcnt(2)
    v_mfma_f32_16x16x32_bf16 v[20:23], v[224:227], a[8:11], v[20:23]
    s_add_u32 m0, s35, 14080
    s_nop 0
    buffer_load_dwordx4 v179, s[12:15], s39 offen offset:256  lds
    v_mfma_f32_16x16x32_bf16 v[24:27], v[224:227], a[28:31], v[24:27]
    v_lshl_add_u32 v184, v1, 4, v8
    v_mfma_f32_16x16x32_bf16 v[28:31], v[224:227], a[48:51], v[28:31]
    v_cvt_f32_u32 v184, v184
    v_mfma_f32_16x16x32_bf16 v[32:35], v[224:227], a[68:71], v[32:35]
    s_add_u32 m0, s35, 15104
    s_nop 0
    buffer_load_dwordx4 v180, s[12:15], s39 offen offset:256  lds
    v_mfma_f32_16x16x32_bf16 v[36:39], v[224:227], a[88:91], v[36:39]
    v_mul_f32 v184, 0x3c800000, v184
    v_mfma_f32_16x16x32_bf16 v[100:103], v[224:227], v[108:111], v[100:103]
    v_mfma_f32_16x16x32_bf16 v[104:107], v[224:227], v[224:227], v[104:107]
    s_waitcnt vmcnt(15)
    ds_read_b128 v[220:223], v5 offset:4096
    s_waitcnt lgkmcnt(2)
    v_mfma_f32_16x16x32_bf16 v[20:23], v[228:231], a[12:15], v[20:23]
    s_add_u32 m0, s35, 16000
    s_nop 0
    buffer_load_dwordx4 v179, s[12:15], s39 offen offset:384  lds
    v_mfma_f32_16x16x32_bf16 v[24:27], v[228:231], a[32:35], v[24:27]
    v_lshlrev_b32 v185, 4, v4
    v_mfma_f32_16x16x32_bf16 v[28:31], v[228:231], a[52:55], v[28:31]
    v_cvt_f32_u32 v185, v185
    v_mfma_f32_16x16x32_bf16 v[32:35], v[228:231], a[72:75], v[32:35]
    s_add_u32 m0, s35, 17024
    s_nop 0
    buffer_load_dwordx4 v180, s[12:15], s39 offen offset:384  lds
    v_mfma_f32_16x16x32_bf16 v[36:39], v[228:231], a[92:95], v[36:39]
    v_mul_f32 v185, v185, v184
    v_mfma_f32_16x16x32_bf16 v[100:103], v[228:231], v[108:111], v[100:103]
    v_mfma_f32_16x16x32_bf16 v[104:107], v[228:231], v[228:231], v[104:107]
    s_waitcnt vmcnt(10)
    ds_read_b128 v[224:227], v9 offset:6144
    s_waitcnt lgkmcnt(2)
    v_mfma_f32_16x16x32_bf16 v[20:23], v[216:219], a[16:19], v[20:23]
    s_add_u32 m0, s35, 17920
    s_nop 0
    buffer_load_dwordx4 v179, s[12:15], s39 offen offset:512  lds
    v_mfma_f32_16x16x32_bf16 v[24:27], v[216:219], a[36:39], v[24:27]
    v_add_f32 v192, v184, v184
    v_mfma_f32_16x16x32_bf16 v[28:31], v[216:219], a[56:59], v[28:31]
    s_mov_b32 s58, 0x00000000
    v_mfma_f32_16x16x32_bf16 v[32:35], v[216:219], a[76:79], v[32:35]
    s_add_u32 m0, s35, 18944
    s_nop 0
    buffer_load_dwordx4 v180, s[12:15], s39 offen offset:512  lds
    v_mfma_f32_16x16x32_bf16 v[36:39], v[216:219], a[96:99], v[36:39]
    v_fma_f32 v186, v184, s58, v185
    v_mfma_f32_16x16x32_bf16 v[100:103], v[216:219], v[108:111], v[100:103]
    v_mfma_f32_16x16x32_bf16 v[104:107], v[216:219], v[216:219], v[104:107]
    s_waitcnt vmcnt(12)
    ds_read_b128 v[228:231], v5 offset:6144
    s_waitcnt lgkmcnt(2)
    v_mfma_f32_16x16x32_bf16 v[40:43], v[220:223], a[0:3], 0
    s_mov_b32 s48, s26
    s_mov_b32 s49, s27
    s_add_u32 m0, s41, 0
    s_nop 0
    buffer_load_dwordx4 v176, s[48:51], s25 offen nt lds
    v_mfma_f32_16x16x32_bf16 v[44:47], v[220:223], a[20:23], 0
    v_add_f32 v187, v186, v192
    v_mfma_f32_16x16x32_bf16 v[48:51], v[220:223], a[40:43], 0
    v_cos_f32 v188, v186
    v_mfma_f32_16x16x32_bf16 v[52:55], v[220:223], a[60:63], 0
    s_add_u32 m0, s41, 1024
    s_nop 0
    buffer_load_dwordx4 v177, s[48:51], s25 offen nt lds
    v_mfma_f32_16x16x32_bf16 v[56:59], v[220:223], a[80:83], 0
    v_cos_f32 v189, v187
    v_mfma_f32_16x16x32_bf16 v[100:103], v[220:223], v[108:111], v[100:103]
    v_mfma_f32_16x16x32_bf16 v[104:107], v[220:223], v[220:223], v[104:107]
    s_waitcnt vmcnt(12)
    ds_read_b128 v[216:219], v9 offset:8192
    s_waitcnt lgkmcnt(2)
    v_mfma_f32_16x16x32_bf16 v[40:43], v[224:227], a[4:7], v[40:43]
    s_add_u32 m0, s41, 2048
    s_nop 0
    buffer_load_dwordx4 v178, s[48:51], s25 offen nt lds
    v_mfma_f32_16x16x32_bf16 v[44:47], v[224:227], a[24:27], v[44:47]
    v_sin_f32 v190, v186
    v_mfma_f32_16x16x32_bf16 v[48:51], v[224:227], a[44:47], v[48:51]
    v_sin_f32 v191, v187
    v_mfma_f32_16x16x32_bf16 v[52:55], v[224:227], a[64:67], v[52:55]
    v_cvt_pk_bf16_f32 v200, v188, v189
    v_mfma_f32_16x16x32_bf16 v[56:59], v[224:227], a[84:87], v[56:59]
    v_cvt_pk_bf16_f32 v208, -v190, -v191
    v_mfma_f32_16x16x32_bf16 v[100:103], v[224:227], v[108:111], v[100:103]
    v_mfma_f32_16x16x32_bf16 v[104:107], v[224:227], v[224:227], v[104:107]
    s_waitcnt vmcnt(13)
    ds_read_b128 v[220:223], v5 offset:8192
    s_waitcnt lgkmcnt(2)
    v_mfma_f32_16x16x32_bf16 v[40:43], v[228:231], a[8:11], v[40:43]
    s_mov_b32 s58, 0x40800000
    v_mfma_f32_16x16x32_bf16 v[44:47], v[228:231], a[28:31], v[44:47]
    v_fma_f32 v186, v184, s58, v185
    v_mfma_f32_16x16x32_bf16 v[48:51], v[228:231], a[48:51], v[48:51]
    v_add_f32 v187, v186, v192
    v_mfma_f32_16x16x32_bf16 v[52:55], v[228:231], a[68:71], v[52:55]
    v_cos_f32 v188, v186
    v_mfma_f32_16x16x32_bf16 v[56:59], v[228:231], a[88:91], v[56:59]
    v_cos_f32 v189, v187
    v_mfma_f32_16x16x32_bf16 v[100:103], v[228:231], v[108:111], v[100:103]
    v_mfma_f32_16x16x32_bf16 v[104:107], v[228:231], v[228:231], v[104:107]
    s_waitcnt vmcnt(11)
    ds_read_b128 v[224:227], v9 offset:10240
    s_waitcnt lgkmcnt(2)
    v_mfma_f32_16x16x32_bf16 v[40:43], v[216:219], a[12:15], v[40:43]
    v_sin_f32 v190, v186
    v_mfma_f32_16x16x32_bf16 v[44:47], v[216:219], a[32:35], v[44:47]
    v_sin_f32 v191, v187
    v_mfma_f32_16x16x32_bf16 v[48:51], v[216:219], a[52:55], v[48:51]
    v_cvt_pk_bf16_f32 v201, v188, v189
    v_mfma_f32_16x16x32_bf16 v[52:55], v[216:219], a[72:75], v[52:55]
    v_cvt_pk_bf16_f32 v209, -v190, -v191
    v_mfma_f32_16x16x32_bf16 v[56:59], v[216:219], a[92:95], v[56:59]
    s_mov_b32 s58, 0x41000000
    v_mfma_f32_16x16x32_bf16 v[100:103], v[216:219], v[108:111], v[100:103]
    v_mfma_f32_16x16x32_bf16 v[104:107], v[216:219], v[216:219], v[104:107]
    s_waitcnt vmcnt(11)
    ds_read_b128 v[228:231], v5 offset:10240
    s_waitcnt lgkmcnt(2)
    v_mfma_f32_16x16x32_bf16 v[40:43], v[220:223], a[16:19], v[40:43]
    v_fma_f32 v186, v184, s58, v185
    v_mfma_f32_16x16x32_bf16 v[44:47], v[220:223], a[36:39], v[44:47]
    v_add_f32 v187, v186, v192
    v_mfma_f32_16x16x32_bf16 v[48:51], v[220:223], a[56:59], v[48:51]
    v_cos_f32 v188, v186
    v_mfma_f32_16x16x32_bf16 v[52:55], v[220:223], a[76:79], v[52:55]
    v_cos_f32 v189, v187
    v_mfma_f32_16x16x32_bf16 v[56:59], v[220:223], a[96:99], v[56:59]
    v_sin_f32 v190, v186
    v_mfma_f32_16x16x32_bf16 v[100:103], v[220:223], v[108:111], v[100:103]
    v_mfma_f32_16x16x32_bf16 v[104:107], v[220:223], v[220:223], v[104:107]
    s_waitcnt vmcnt(9)
    ds_read_b128 v[216:219], v9 offset:12288
    s_waitcnt lgkmcnt(2)
    v_mfma_f32_16x16x32_bf16 v[60:63], v[224:227], a[0:3], 0
    v_sin_f32 v191, v187
    v_mfma_f32_16x16x32_bf16 v[64:67], v[224:227], a[20:23], 0
    v_cvt_pk_bf16_f32 v202, v188, v189
    v_mfma_f32_16x16x32_bf16 v[68:71], v[224:227], a[40:43], 0
    v_cvt_pk_bf16_f32 v210, -v190, -v191
    v_mfma_f32_16x16x32_bf16 v[72:75], v[224:227], a[60:63], 0
    s_mov_b32 s58, 0x41400000
    v_mfma_f32_16x16x32_bf16 v[76:79], v[224:227], a[80:83], 0
    v_fma_f32 v186, v184, s58, v185
    v_mfma_f32_16x16x32_bf16 v[100:103], v[224:227], v[108:111], v[100:103]
    v_mfma_f32_16x16x32_bf16 v[104:107], v[224:227], v[224:227], v[104:107]
    s_waitcnt vmcnt(9)
    ds_read_b128 v[220:223], v5 offset:12288
    s_waitcnt lgkmcnt(2)
    v_mfma_f32_16x16x32_bf16 v[60:63], v[228:231], a[4:7], v[60:63]
    v_add_f32 v187, v186, v192
    v_mfma_f32_16x16x32_bf16 v[64:67], v[228:231], a[24:27], v[64:67]
    v_cos_f32 v188, v186
    v_mfma_f32_16x16x32_bf16 v[68:71], v[228:231], a[44:47], v[68:71]
    v_cos_f32 v189, v187
    v_mfma_f32_16x16x32_bf16 v[72:75], v[228:231], a[64:67], v[72:75]
    v_sin_f32 v190, v186
    v_mfma_f32_16x16x32_bf16 v[76:79], v[228:231], a[84:87], v[76:79]
    v_sin_f32 v191, v187
    v_mfma_f32_16x16x32_bf16 v[100:103], v[228:231], v[108:111], v[100:103]
    v_mfma_f32_16x16x32_bf16 v[104:107], v[228:231], v[228:231], v[104:107]
    s_waitcnt vmcnt(7)
    ds_read_b128 v[224:227], v9 offset:14336
    s_waitcnt lgkmcnt(2)
    v_mfma_f32_16x16x32_bf16 v[60:63], v[216:219], a[8:11], v[60:63]
    v_cvt_pk_bf16_f32 v203, v188, v189
    v_mfma_f32_16x16x32_bf16 v[64:67], v[216:219], a[28:31], v[64:67]
    v_cvt_pk_bf16_f32 v211, -v190, -v191
    v_mfma_f32_16x16x32_bf16 v[68:71], v[216:219], a[48:51], v[68:71]
    s_mov_b32 s58, 0x3f800000
    v_mfma_f32_16x16x32_bf16 v[72:75], v[216:219], a[68:71], v[72:75]
    v_fma_f32 v186, v184, s58, v185
    v_mfma_f32_16x16x32_bf16 v[76:79], v[216:219], a[88:91], v[76:79]
    v_add_f32 v187, v186, v192
    v_mfma_f32_16x16x32_bf16 v[100:103], v[216:219], v[108:111], v[100:103]
    v_mfma_f32_16x16x32_bf16 v[104:107], v[216:219], v[216:219], v[104:107]
    s_waitcnt vmcnt(7)
    ds_read_b128 v[228:231], v5 offset:14336
    s_waitcnt lgkmcnt(2)
    v_mfma_f32_16x16x32_bf16 v[60:63], v[220:223], a[12:15], v[60:63]
    v_cos_f32 v188, v186
    v_mfma_f32_16x16x32_bf16 v[64:67], v[220:223], a[32:35], v[64:67]
    v_cos_f32 v189, v187
    v_mfma_f32_16x16x32_bf16 v[68:71], v[220:223], a[52:55], v[68:71]
    v_sin_f32 v190, v186
    v_mfma_f32_16x16x32_bf16 v[72:75], v[220:223], a[72:75], v[72:75]
    v_sin_f32 v191, v187
    v_mfma_f32_16x16x32_bf16 v[76:79], v[220:223], a[92:95], v[76:79]
    v_cvt_pk_bf16_f32 v204, v188, v189
    v_mfma_f32_16x16x32_bf16 v[100:103], v[220:223], v[108:111], v[100:103]
    v_mfma_f32_16x16x32_bf16 v[104:107], v[220:223], v[220:223], v[104:107]
    s_waitcnt vmcnt(5)
    ds_read_b128 v[216:219], v9 offset:16384
    s_waitcnt lgkmcnt(2)
    v_mfma_f32_16x16x32_bf16 v[60:63], v[224:227], a[16:19], v[60:63]
    v_cvt_pk_bf16_f32 v212, -v190, -v191
    v_mfma_f32_16x16x32_bf16 v[64:67], v[224:227], a[36:39], v[64:67]
    s_mov_b32 s58, 0x40a00000
    v_mfma_f32_16x16x32_bf16 v[68:71], v[224:227], a[56:59], v[68:71]
    v_fma_f32 v186, v184, s58, v185
    v_mfma_f32_16x16x32_bf16 v[72:75], v[224:227], a[76:79], v[72:75]
    v_add_f32 v187, v186, v192
    v_mfma_f32_16x16x32_bf16 v[76:79], v[224:227], a[96:99], v[76:79]
    v_cos_f32 v188, v186
    v_mfma_f32_16x16x32_bf16 v[100:103], v[224:227], v[108:111], v[100:103]
    v_mfma_f32_16x16x32_bf16 v[104:107], v[224:227], v[224:227], v[104:107]
    s_waitcnt vmcnt(5)
    ds_read_b128 v[220:223], v5 offset:16384
    s_waitcnt lgkmcnt(2)
    v_mfma_f32_16x16x32_bf16 v[80:83], v[228:231], a[0:3], 0
    v_cos_f32 v189, v187
    v_mfma_f32_16x16x32_bf16 v[84:87], v[228:231], a[20:23], 0
    v_sin_f32 v190, v186
    v_mfma_f32_16x16x32_bf16 v[88:91], v[228:231], a[40:43], 0
    v_sin_f32 v191, v187
    v_mfma_f32_16x16x32_bf16 v[92:95], v[228:231], a[60:63], 0
    v_cvt_pk_bf16_f32 v205, v188, v189
    v_mfma_f32_16x16x32_bf16 v[96:99], v[228:231], a[80:83], 0
    v_cvt_pk_bf16_f32 v213, -v190, -v191
    v_mfma_f32_16x16x32_bf16 v[100:103], v[228:231], v[108:111], v[100:103]
    v_mfma_f32_16x16x32_bf16 v[104:107], v[228:231], v[228:231], v[104:107]
    s_waitcnt vmcnt(3)
    ds_read_b128 v[224:227], v9 offset:18432
    s_waitcnt lgkmcnt(2)
    v_mfma_f32_16x16x32_bf16 v[80:83], v[216:219], a[4:7], v[80:83]
    s_mov_b32 s58, 0x41100000
    v_mfma_f32_16x16x32_bf16 v[84:87], v[216:219], a[24:27], v[84:87]
    v_fma_f32 v186, v184, s58, v185
    v_mfma_f32_16x16x32_bf16 v[88:91], v[216:219], a[44:47], v[88:91]
    v_add_f32 v187, v186, v192
    v_mfma_f32_16x16x32_bf16 v[92:95], v[216:219], a[64:67], v[92:95]
    v_cos_f32 v188, v186
    v_mfma_f32_16x16x32_bf16 v[96:99], v[216:219], a[84:87], v[96:99]
    v_cos_f32 v189, v187
    v_mfma_f32_16x16x32_bf16 v[100:103], v[216:219], v[108:111], v[100:103]
    v_mfma_f32_16x16x32_bf16 v[104:107], v[216:219], v[216:219], v[104:107]
    s_waitcnt vmcnt(3)
    ds_read_b128 v[228:231], v5 offset:18432
    s_waitcnt lgkmcnt(2)
    v_mfma_f32_16x16x32_bf16 v[80:83], v[220:223], a[8:11], v[80:83]
    v_sin_f32 v190, v186
    v_mfma_f32_16x16x32_bf16 v[84:87], v[220:223], a[28:31], v[84:87]
    v_sin_f32 v191, v187
    v_mfma_f32_16x16x32_bf16 v[88:91], v[220:223], a[48:51], v[88:91]
    v_cvt_pk_bf16_f32 v206, v188, v189
    v_mfma_f32_16x16x32_bf16 v[92:95], v[220:223], a[68:71], v[92:95]
    v_cvt_pk_bf16_f32 v214, -v190, -v191
    v_mfma_f32_16x16x32_bf16 v[96:99], v[220:223], a[88:91], v[96:99]
    s_mov_b32 s58, 0x41500000
    v_mfma_f32_16x16x32_bf16 v[100:103], v[220:223], v[108:111], v[100:103]
    v_mfma_f32_16x16x32_bf16 v[104:107], v[220:223], v[220:223], v[104:107]
    s_waitcnt lgkmcnt(1)
    v_mfma_f32_16x16x32_bf16 v[80:83], v[224:227], a[12:15], v[80:83]
    v_fma_f32 v186, v184, s58, v185
    v_mfma_f32_16x16x32_bf16 v[84:87], v[224:227], a[32:35], v[84:87]
    v_add_f32 v187, v186, v192
    v_mfma_f32_16x16x32_bf16 v[88:91], v[224:227], a[52:55], v[88:91]
    v_cos_f32 v188, v186
    v_mfma_f32_16x16x32_bf16 v[92:95], v[224:227], a[72:75], v[92:95]
    v_cos_f32 v189, v187
    v_mfma_f32_16x16x32_bf16 v[96:99], v[224:227], a[92:95], v[96:99]
    v_sin_f32 v190, v186
    v_mfma_f32_16x16x32_bf16 v[100:103], v[224:227], v[108:111], v[100:103]
    v_mfma_f32_16x16x32_bf16 v[104:107], v[224:227], v[224:227], v[104:107]
    s_waitcnt lgkmcnt(0)
    v_mfma_f32_16x16x32_bf16 v[80:83], v[228:231], a[16:19], v[80:83]
    v_sin_f32 v191, v187
    v_mfma_f32_16x16x32_bf16 v[84:87], v[228:231], a[36:39], v[84:87]
    v_cvt_pk_bf16_f32 v207, v188, v189
    v_mfma_f32_16x16x32_bf16 v[88:91], v[228:231], a[56:59], v[88:91]
    v_cvt_pk_bf16_f32 v215, -v190, -v191
    v_mfma_f32_16x16x32_bf16 v[92:95], v[228:231], a[76:79], v[92:95]
    v_mfma_f32_16x16x32_bf16 v[96:99], v[228:231], a[96:99], v[96:99]
    v_mfma_f32_16x16x32_bf16 v[100:103], v[228:231], v[108:111], v[100:103]
    v_mfma_f32_16x16x32_bf16 v[104:107], v[228:231], v[228:231], v[104:107]
    s_waitcnt vmcnt(17)
    s_barrier
    ds_read_b64_tr_b16 v[120:121], v12 offset:37120
    ds_read_b64_tr_b16 v[122:123], v12 offset:37632
    ds_read_b64_tr_b16 v[124:125], v12 offset:41216
    ds_read_b64_tr_b16 v[126:127], v12 offset:41728
    ds_read_b64_tr_b16 v[128:129], v12 offset:45312
    ds_read_b64_tr_b16 v[130:131], v12 offset:45824
    ds_read_b64_tr_b16 v[132:133], v12 offset:49408
    ds_read_b64_tr_b16 v[134:135], v12 offset:49920
    ds_read_b64_tr_b16 v[136:137], v12 offset:53504
    ds_read_b64_tr_b16 v[138:139], v12 offset:54016
    s_waitcnt lgkmcnt(0)
    s_add_u32 s52, s31, 0
    s_mul_i32 s53, s52, 12
    s_add_u32 s53, s53, s28
    s_lshl_b32 s54, s52, 1
    s_add_u32 s54, s54, s30
    s_cmp_lt_u32 s52, 8
    s_cselect_b32 s53, s53, s54
    s_lshl_b32 s53, s53, 10
    s_add_u32 s53, s53, s29
    v_mfma_f32_16x16x32_bf16 v[160:163], v[120:123], v[108:111], 0
    buffer_store_dwordx4 v[120:123], v3, s[16:19], s53 offen sc1
    s_add_u32 s52, s31, 1
    s_mul_i32 s53, s52, 12
    s_add_u32 s53, s53, s28
    s_lshl_b32 s54, s52, 1
    s_add_u32 s54, s54, s30
    s_cmp_lt_u32 s52, 8
    s_cselect_b32 s53, s53, s54
    s_lshl_b32 s53, s53, 10
    s_add_u32 s53, s53, s29
    v_mfma_f32_16x16x32_bf16 v[160:163], v[124:127], v[108:111], v[160:163]
    buffer_store_dwordx4 v[124:127], v3, s[16:19], s53 offen sc1
    s_add_u32 s52, s31, 2
    s_mul_i32 s53, s52, 12
    s_add_u32 s53, s53, s28
    s_lshl_b32 s54, s52, 1
    s_add_u32 s54, s54, s30
    s_cmp_lt_u32 s52, 8
    s_cselect_b32 s53, s53, s54
    s_lshl_b32 s53, s53, 10
    s_add_u32 s53, s53, s29
    v_mfma_f32_16x16x32_bf16 v[160:163], v[128:131], v[108:111], v[160:163]
    buffer_store_dwordx4 v[128:131], v3, s[16:19], s53 offen sc1
    s_add_u32 s52, s31, 3
    s_mul_i32 s53, s52, 12
    s_add_u32 s53, s53, s28
    s_lshl_b32 s54, s52, 1
    s_add_u32 s54, s54, s30
    s_cmp_lt_u32 s52, 8
    s_cselect_b32 s53, s53, s54
    s_lshl_b32 s53, s53, 10
    s_add_u32 s53, s53, s29
    v_mfma_f32_16x16x32_bf16 v[160:163], v[132:135], v[108:111], v[160:163]
    buffer_store_dwordx4 v[132:135], v3, s[16:19], s53 offen sc1
    s_add_u32 s52, s31, 4
    s_mul_i32 s53, s52, 12
    s_add_u32 s53, s53, s28
    s_lshl_b32 s54, s52, 1
    s_add_u32 s54, s54, s30
    s_cmp_lt_u32 s52, 8
    s_cselect_b32 s53, s53, s54
    s_lshl_b32 s53, s53, 10
    s_add_u32 s53, s53, s29
    v_mfma_f32_16x16x32_bf16 v[160:163], v[136:139], v[108:111], v[160:163]
    buffer_store_dwordx4 v[136:139], v3, s[16:19], s53 offen sc1
    v_fmac_f32 v20, v232, v60
    v_fmac_f32 v40, v232, v80
    v_fmac_f32 v21, v232, v61
    v_fmac_f32 v41, v232, v81
    v_fmac_f32 v22, v232, v62
    v_fmac_f32 v42, v232, v82
    v_fmac_f32 v23, v232, v63
    v_fmac_f32 v43, v232, v83
    v_fmac_f32 v24, v232, v64
    v_fmac_f32 v44, v232, v84
    v_fmac_f32 v25, v232, v65
    v_fmac_f32 v45, v232, v85
    v_fmac_f32 v26, v232, v66
    v_fmac_f32 v46, v232, v86
    v_fmac_f32 v27, v232, v67
    v_fmac_f32 v47, v232, v87
    ds_bpermute_b32 v112, v10, v104 offset:0
    ds_bpermute_b32 v113, v10, v105 offset:4
    ds_bpermute_b32 v114, v10, v106 offset:8
    ds_bpermute_b32 v115, v10, v107 offset:12
    v_fmac_f32 v28, v232, v68
    v_fmac_f32 v48, v232, v88
    v_fmac_f32 v29, v232, v69
    v_fmac_f32 v49, v232, v89
    v_fmac_f32 v30, v232, v70
    v_fmac_f32 v50, v232, v90
    v_fmac_f32 v31, v232, v71
    v_fmac_f32 v51, v232, v91
    v_fmac_f32 v32, v232, v72
    v_fmac_f32 v52, v232, v92
    v_fmac_f32 v33, v232, v73
    v_fmac_f32 v53, v232, v93
    v_fmac_f32 v34, v232, v74
    v_fmac_f32 v54, v232, v94
    v_fmac_f32 v35, v232, v75
    v_fmac_f32 v55, v232, v95
    v_fmac_f32 v36, v232, v76
    v_fmac_f32 v56, v232, v96
    v_fmac_f32 v37, v232, v77
    v_fmac_f32 v57, v232, v97
    v_fmac_f32 v38, v232, v78
    v_fmac_f32 v58, v232, v98
    v_fmac_f32 v39, v232, v79
    v_fmac_f32 v59, v232, v99
    s_waitcnt lgkmcnt(0)
    v_mul_f32 v100, 0x3acccccd, v100
    v_mul_f32 v112, 0x3acccccd, v112
    v_mul_f32 v101, 0x3acccccd, v101
    v_mul_f32 v113, 0x3acccccd, v113
    v_mul_f32 v102, 0x3acccccd, v102
    v_mul_f32 v114, 0x3acccccd, v114
    v_mul_f32 v103, 0x3acccccd, v103
    v_mul_f32 v115, 0x3acccccd, v115
    v_fma_f32 v112, -v100, v100, v112
    v_fma_f32 v113, -v101, v101, v113
    v_fma_f32 v114, -v102, v102, v114
    v_fma_f32 v115, -v103, v103, v115
    v_max_f32 v112, 0, v112
    v_max_f32 v113, 0, v113
    v_max_f32 v114, 0, v114
    v_max_f32 v115, 0, v115
    v_cvt_pk_bf16_f32 v112, v112, v112
    v_lshlrev_b32 v112, 16, v112
    v_cvt_pk_bf16_f32 v113, v113, v113
    v_lshlrev_b32 v113, 16, v113
    v_cvt_pk_bf16_f32 v114, v114, v114
    v_lshlrev_b32 v114, 16, v114
    v_cvt_pk_bf16_f32 v115, v115, v115
    v_lshlrev_b32 v115, 16, v115
    v_add_f32 v112, 0x3727c5ac, v112
    v_add_f32 v113, 0x3727c5ac, v113
    v_add_f32 v114, 0x3727c5ac, v114
    v_add_f32 v115, 0x3727c5ac, v115
    v_cvt_pk_bf16_f32 v112, v112, v112
    v_lshlrev_b32 v112, 16, v112
    v_cvt_pk_bf16_f32 v113, v113, v113
    v_lshlrev_b32 v113, 16, v113
    v_cvt_pk_bf16_f32 v114, v114, v114
    v_lshlrev_b32 v114, 16, v114
    v_cvt_pk_bf16_f32 v115, v115, v115
    v_lshlrev_b32 v115, 16, v115
    v_sqrt_f32 v112, v112
    v_sqrt_f32 v113, v113
    v_sqrt_f32 v114, v114
    v_sqrt_f32 v115, v115
    v_cvt_pk_bf16_f32 v112, v112, v112
    v_lshlrev_b32 v112, 16, v112
    v_cvt_pk_bf16_f32 v113, v113, v113
    v_lshlrev_b32 v113, 16, v113
    v_cvt_pk_bf16_f32 v114, v114, v114
    v_lshlrev_b32 v114, 16, v114
    v_cvt_pk_bf16_f32 v115, v115, v115
    v_lshlrev_b32 v115, 16, v115
    v_rcp_f32 v112, v112
    v_rcp_f32 v113, v113
    v_rcp_f32 v114, v114
    v_rcp_f32 v115, v115
    s_bitcmp1_b32 s24, 0
    s_cselect_b32 s44, 0x80000000, 0
    v_and_b32 v116, s44, v232
    v_xor_b32 v112, v116, v112
    v_xor_b32 v113, v116, v113
    v_xor_b32 v114, v116, v114
    v_xor_b32 v115, v116, v115
    v_fmac_f32_dpp v20, v40, v233 quad_perm:[1,0,2,3] row_mask:0xf bank_mask:0xf
    v_fmac_f32_dpp v21, v41, v233 quad_perm:[1,0,2,3] row_mask:0xf bank_mask:0xf
    v_fmac_f32_dpp v22, v42, v233 quad_perm:[1,0,2,3] row_mask:0xf bank_mask:0xf
    v_fmac_f32_dpp v23, v43, v233 quad_perm:[1,0,2,3] row_mask:0xf bank_mask:0xf
    v_fmac_f32_dpp v24, v44, v234 quad_perm:[1,0,2,3] row_mask:0xf bank_mask:0xf
    v_fmac_f32_dpp v25, v45, v234 quad_perm:[1,0,2,3] row_mask:0xf bank_mask:0xf
    v_fmac_f32_dpp v26, v46, v234 quad_perm:[1,0,2,3] row_mask:0xf bank_mask:0xf
    v_fmac_f32_dpp v27, v47, v234 quad_perm:[1,0,2,3] row_mask:0xf bank_mask:0xf
    v_fmac_f32_dpp v28, v48, v233 quad_perm:[1,0,2,3] row_mask:0xf bank_mask:0xf
    v_fmac_f32_dpp v29, v49, v233 quad_perm:[1,0,2,3] row_mask:0xf bank_mask:0xf
    v_fmac_f32_dpp v30, v50, v233 quad_perm:[1,0,2,3] row_mask:0xf bank_mask:0xf
    v_fmac_f32_dpp v31, v51, v233 quad_perm:[1,0,2,3] row_mask:0xf bank_mask:0xf
    v_fmac_f32_dpp v32, v52, v234 quad_perm:[1,0,2,3] row_mask:0xf bank_mask:0xf
    v_fmac_f32_dpp v33, v53, v234 quad_perm:[1,0,2,3] row_mask:0xf bank_mask:0xf
    v_fmac_f32_dpp v34, v54, v234 quad_perm:[1,0,2,3] row_mask:0xf bank_mask:0xf
    v_fmac_f32_dpp v35, v55, v234 quad_perm:[1,0,2,3] row_mask:0xf bank_mask:0xf
    v_fmac_f32_dpp v36, v56, v235 quad_perm:[1,0,2,3] row_mask:0xf bank_mask:0xf
    v_fmac_f32_dpp v37, v57, v235 quad_perm:[1,0,2,3] row_mask:0xf bank_mask:0xf
    v_fmac_f32_dpp v38, v58, v235 quad_perm:[1,0,2,3] row_mask:0xf bank_mask:0xf
    v_fmac_f32_dpp v39, v59, v235 quad_perm:[1,0,2,3] row_mask:0xf bank_mask:0xf
    s_mov_b32 s45, 0
    v_mul_u32_u24 v6, 144, v8
    v_lshlrev_b32 v7, 3, v4
    v_add3_u32 v6, v6, v7, s45
    s_lshl_b32 s44, s32, 5
    v_add_u32 v9, s44, v6
    v_add_u32 v6, v6, v7
    v_mul_f32 v20, v20, v112
    v_mul_f32 v21, v21, v113
    v_mul_f32 v22, v22, v114
    v_mul_f32 v23, v23, v115
    v_cvt_pk_bf16_f32 v40, v20, v21
    v_cvt_pk_bf16_f32 v41, v22, v23
    ds_write_b64 v9, v[40:41] offset:0
    v_mul_f32 v24, v24, v112
    v_mul_f32 v25, v25, v113
    v_mul_f32 v26, v26, v114
    v_mul_f32 v27, v27, v115
    v_cvt_pk_bf16_f32 v44, v24, v25
    v_cvt_pk_bf16_f32 v45, v26, v27
    ds_write_b64 v9, v[44:45] offset:2304
    v_mul_f32 v28, v28, v112
    v_mul_f32 v29, v29, v113
    v_mul_f32 v30, v30, v114
    v_mul_f32 v31, v31, v115
    v_cvt_pk_bf16_f32 v48, v28, v29
    v_cvt_pk_bf16_f32 v49, v30, v31
    ds_write_b64 v9, v[48:49] offset:4608
    v_mul_f32 v32, v32, v112
    v_mul_f32 v33, v33, v113
    v_mul_f32 v34, v34, v114
    v_mul_f32 v35, v35, v115
    v_cvt_pk_bf16_f32 v52, v32, v33
    v_cvt_pk_bf16_f32 v53, v34, v35
    ds_write_b64 v9, v[52:53] offset:6912
    v_mul_f32 v36, v36, v112
    v_mul_f32 v37, v37, v113
    v_mul_f32 v38, v38, v114
    v_mul_f32 v39, v39, v115
    v_cvt_pk_bf16_f32 v56, v36, v37
    v_cvt_pk_bf16_f32 v57, v38, v39
    ds_write_b64 v9, v[56:57] offset:9216
    s_mov_b32 exec_lo, 0x10001
    s_mov_b32 exec_hi, 0x10001
    buffer_store_dwordx4 v[160:163], v16, s[16:19], s55 offen sc1
    s_mov_b64 exec, -1
    s_waitcnt lgkmcnt(0)
    s_barrier
    ds_read_b128 v[120:123], v6 offset:0
    ds_read_b128 v[124:127], v6 offset:64
    ds_read_b128 v[128:131], v6 offset:2304
    ds_read_b128 v[132:135], v6 offset:2368
    ds_read_b128 v[136:139], v6 offset:4608
    ds_read_b128 v[140:143], v6 offset:4672
    ds_read_b128 v[144:147], v6 offset:6912
    ds_read_b128 v[148:151], v6 offset:6976
    ds_read_b128 v[152:155], v6 offset:9216
    ds_read_b128 v[156:159], v6 offset:9280
    s_mul_i32 s45, s32, 2560
    s_add_u32 s45, s45, 11520
    v_mul_u32_u24 v10, 160, v8
    v_add_u32 v10, s45, v10
    v_add_u32 v12, s45, v3
    v_lshl_add_u32 v11, v4, 2, v10
    v_lshl_add_u32 v10, v4, 4, v10
    s_mul_i32 s44, s23, 81920
    s_mul_i32 s45, s24, 10240
    s_add_u32 s44, s44, s45
    s_add_u32 s44, s44, 1048576
    s_mul_i32 s45, s32, 2560
    s_add_u32 s44, s44, s45
    s_waitcnt lgkmcnt(8)
    v_mfma_f32_16x16x32_bf16 v[20:23], v[120:123], v[200:203], 0
    v_mfma_f32_16x16x32_bf16 v[24:27], v[120:123], v[208:211], 0
    v_mfma_f32_16x16x32_bf16 v[20:23], v[124:127], v[204:207], v[20:23]
    v_mfma_f32_16x16x32_bf16 v[24:27], v[124:127], v[212:215], v[24:27]
    s_waitcnt lgkmcnt(6)
    v_mfma_f32_16x16x32_bf16 v[28:31], v[128:131], v[200:203], 0
    v_mfma_f32_16x16x32_bf16 v[32:35], v[128:131], v[208:211], 0
    v_mfma_f32_16x16x32_bf16 v[28:31], v[132:135], v[204:207], v[28:31]
    v_mfma_f32_16x16x32_bf16 v[32:35], v[132:135], v[212:215], v[32:35]
    s_waitcnt lgkmcnt(4)
    v_mfma_f32_16x16x32_bf16 v[36:39], v[136:139], v[200:203], 0
    v_mfma_f32_16x16x32_bf16 v[40:43], v[136:139], v[208:211], 0
    v_mfma_f32_16x16x32_bf16 v[36:39], v[140:143], v[204:207], v[36:39]
    v_mfma_f32_16x16x32_bf16 v[40:43], v[140:143], v[212:215], v[40:43]
    s_waitcnt lgkmcnt(2)
    v_mfma_f32_16x16x32_bf16 v[44:47], v[144:147], v[200:203], 0
    v_mfma_f32_16x16x32_bf16 v[48:51], v[144:147], v[208:211], 0
    v_mfma_f32_16x16x32_bf16 v[44:47], v[148:151], v[204:207], v[44:47]
    v_mfma_f32_16x16x32_bf16 v[48:51], v[148:151], v[212:215], v[48:51]
    s_waitcnt lgkmcnt(0)
    v_mfma_f32_16x16x32_bf16 v[52:55], v[152:155], v[200:203], 0
    v_mfma_f32_16x16x32_bf16 v[56:59], v[152:155], v[208:211], 0
    v_mfma_f32_16x16x32_bf16 v[52:55], v[156:159], v[204:207], v[52:55]
    v_mfma_f32_16x16x32_bf16 v[56:59], v[156:159], v[212:215], v[56:59]
    v_sub_f32 v76, v20, v25
    v_sub_f32 v77, v22, v27
    v_add_f32 v78, v24, v21
    v_add_f32 v79, v26, v23
    v_cvt_pk_bf16_f32 v60, v76, v77
    v_cvt_pk_bf16_f32 v68, v78, v79
    v_sub_f32 v80, v28, v33
    v_sub_f32 v81, v30, v35
    v_add_f32 v82, v32, v29
    v_add_f32 v83, v34, v31
    v_cvt_pk_bf16_f32 v61, v80, v81
    v_cvt_pk_bf16_f32 v69, v82, v83
    v_sub_f32 v76, v36, v41
    v_sub_f32 v77, v38, v43
    v_add_f32 v78, v40, v37
    v_add_f32 v79, v42, v39
    v_cvt_pk_bf16_f32 v62, v76, v77
    v_cvt_pk_bf16_f32 v70, v78, v79
    v_sub_f32 v80, v44, v49
    v_sub_f32 v81, v46, v51
    v_add_f32 v82, v48, v45
    v_add_f32 v83, v50, v47
    v_cvt_pk_bf16_f32 v63, v80, v81
    v_cvt_pk_bf16_f32 v71, v82, v83
    v_sub_f32 v76, v52, v57
    v_sub_f32 v77, v54, v59
    v_add_f32 v78, v56, v53
    v_add_f32 v79, v58, v55
    v_cvt_pk_bf16_f32 v64, v76, v77
    v_cvt_pk_bf16_f32 v72, v78, v79
    ds_write_b128 v10, v[60:63]
    ds_write_b128 v10, v[68:71] offset:80
    ds_write_b32 v11, v64 offset:64
    ds_write_b32 v11, v72 offset:144
    s_waitcnt lgkmcnt(0)
    ds_read_b128 v[84:87], v12 offset:0
    ds_read_b128 v[88:91], v12 offset:1024
    ds_read_b128 v[92:95], v12 offset:2048
    s_waitcnt lgkmcnt(2)
    buffer_store_dwordx4 v[84:87], v3, s[8:11], s44 offen offset:0 sc1
    s_waitcnt lgkmcnt(1)
    buffer_store_dwordx4 v[88:91], v3, s[8:11], s44 offen offset:1024 sc1
    s_waitcnt lgkmcnt(0)
    s_mov_b32 exec_hi, 0
    buffer_store_dwordx4 v[92:95], v3, s[8:11], s44 offen offset:2048 sc1
    s_mov_b32 exec_hi, -1
    s_waitcnt vmcnt(3)
    s_lshr_b32 s56, s62, 5
    s_and_b32 s57, s62, 31
    s_lshl_b32 s56, s56, 10
    s_lshl_b32 s57, s57, 5
    s_add_u32 s56, s56, s57
    s_add_u32 s56, s56, 38277120
    v_mov_b32 v252, s100
    v_mov_b32 v253, s101
    s_mov_b64 exec, 1
    buffer_store_dwordx2 v[252:253], v3, s[8:11], s56 offen sc1
    s_mov_b64 exec, -1
    s_waitcnt vmcnt(1)
    s_lshl_b32 s56, s24, 2
    s_add_u32 s56, s56, s32
    s_mov_b32 s57, s22
    s_lshl_b32 s56, s56, 10
    s_lshl_b32 s57, s57, 5
    s_add_u32 s56, s56, s57
    s_add_u32 s56, s56, 38146048
    v_mov_b32 v252, s100
    v_mov_b32 v253, s101
    s_mov_b64 exec, 1
    buffer_store_dwordx2 v[252:253], v3, s[8:11], s56 offen sc1
    s_mov_b64 exec, -1
    s_waitcnt vmcnt(11)
    s_min_u32 s36, s2, 191
    s_lshr_b32 s44, s36, 2
    s_mul_i32 s44, s44, 5120
    s_and_b32 s45, s36, 3
    s_lshl_b32 s45, s45, 8
    s_add_u32 s44, s44, s45
    s_mul_i32 s45, s32, 491520
    s_add_u32 s44, s44, s45
    s_add_u32 s44, s44, 34603008
    s_mul_i32 s41, s32, 3072
    s_add_u32 s41, s41, 150528
    s_mov_b32 s45, 240640
    v_bfe_u32 v13, v2, 2, 2
    v_and_b32 v14, 3, v2
    v_mul_u32_u24 v20, 320, v13
    v_add_u32 v20, s41, v20
    v_lshlrev_b32 v21, 4, v8
    v_add_u32 v22, 0, v4
    v_min_u32 v22, 9, v22
    v_mul_u32_u24 v23, 52, v22
    v_lshrrev_b32 v23, 8, v23
    v_mul_u32_u24 v12, 5, v23
    v_sub_u32 v12, v22, v12
    v_lshrrev_b32 v15, 1, v12
    v_lshlrev_b32 v15, 3, v15
    v_and_b32 v16, 1, v12
    v_add_u32 v15, v15, v16
    v_lshl_add_u32 v16, v14, 1, v15
    v_add_u32 v17, v14, v15
    v_cmp_gt_u32 vcc, 4, v12
    v_mul_u32_u24 v18, 20, v23
    v_mul_lo_u32 v23, v23, s45
    v_cndmask_b32 v16, v17, v16, vcc
    v_add_u32 v16, v16, v18
    v_lshl_add_u32 v16, v16, 3, v20
    v_lshl_add_u32 v23, v22, 10, v23
    v_add_u32 v24, v23, v21
    ds_read_b64_tr_b16 v[28:29], v16 offset:0
    ds_read_b64_tr_b16 v[30:31], v16 offset:1280
    v_add_u32 v22, 4, v4
    v_min_u32 v22, 9, v22
    v_mul_u32_u24 v23, 52, v22
    v_lshrrev_b32 v23, 8, v23
    v_mul_u32_u24 v12, 5, v23
    v_sub_u32 v12, v22, v12
    v_lshrrev_b32 v15, 1, v12
    v_lshlrev_b32 v15, 3, v15
    v_and_b32 v16, 1, v12
    v_add_u32 v15, v15, v16
    v_lshl_add_u32 v16, v14, 1, v15
    v_add_u32 v17, v14, v15
    v_cmp_gt_u32 vcc, 4, v12
    v_mul_u32_u24 v18, 20, v23
    v_mul_lo_u32 v23, v23, s45
    v_cndmask_b32 v16, v17, v16, vcc
    v_add_u32 v16, v16, v18
    v_lshl_add_u32 v16, v16, 3, v20
    v_lshl_add_u32 v23, v22, 10, v23
    v_add_u32 v25, v23, v21
    ds_read_b64_tr_b16 v[32:33], v16 offset:0
    ds_read_b64_tr_b16 v[34:35], v16 offset:1280
    v_add_u32 v22, 8, v4
    v_min_u32 v22, 9, v22
    v_mul_u32_u24 v23, 52, v22
    v_lshrrev_b32 v23, 8, v23
    v_mul_u32_u24 v12, 5, v23
    v_sub_u32 v12, v22, v12
    v_lshrrev_b32 v15, 1, v12
    v_lshlrev_b32 v15, 3, v15
    v_and_b32 v16, 1, v12
    v_add_u32 v15, v15, v16
    v_lshl_add_u32 v16, v14, 1, v15
    v_add_u32 v17, v14, v15
    v_cmp_gt_u32 vcc, 4, v12
    v_mul_u32_u24 v18, 20, v23
    v_mul_lo_u32 v23, v23, s45
    v_cndmask_b32 v16, v17, v16, vcc
    v_add_u32 v16, v16, v18
    v_lshl_add_u32 v16, v16, 3, v20
    v_lshl_add_u32 v23, v22, 10, v23
    v_add_u32 v26, v23, v21
    ds_read_b64_tr_b16 v[36:37], v16 offset:0
    ds_read_b64_tr_b16 v[38:39], v16 offset:1280
    s_waitcnt lgkmcnt(0)
    buffer_store_dwordx4 v[28:31], v24, s[16:19], s44 offen sc1
    buffer_store_dwordx4 v[32:35], v25, s[16:19], s44 offen sc1
    s_mov_b32 exec_hi, 0
    buffer_store_dwordx4 v[36:39], v26, s[16:19], s44 offen sc1
    s_mov_b32 exec_hi, -1
    s_mov_b32 s60, s22
    s_mov_b32 s61, s24
    s_lshr_b32 s56, s60, 1
    s_sub_u32 s63, 32, s56
    s_cmp_eq_u32 s56, 0
    s_cselect_b32 s63, 16, s63
    s_bitcmp1_b32 s60, 0
    s_cselect_b32 s63, s63, s56
    s_mul_i32 s25, s21, 245760
    s_mul_i32 s26, s32, 6144
    s_add_u32 s25, s25, s26
    s_add_u32 s25, s25, 30408704
    s_mul_i32 s31, s61, 245760
    s_mul_i32 s30, s32, 61440
    s_add_u32 s31, s31, s30
    s_add_u32 s31, s31, 34603008
    s_mul_i32 s29, s21, 768
    s_add_u32 s29, s29, 36700160
    s_and_b32 s33, s21, 7
    s_lshr_b32 s34, s21, 3
    s_and_b32 s35, s32, 1
    s_xor_b32 s34, s34, s35
    s_sub_u32 s36, 32, s20
    s_cmp_eq_u32 s20, 0
    s_cselect_b32 s36, 16, s36
    s_cmp_eq_u32 s34, 0
    s_cselect_b32 s36, s20, s36
    s_lshl_b32 s37, s35, 5
    s_add_u32 s36, s36, s37
    s_sub_u32 s37, 64, s36
    s_and_b32 s37, s37, 63
    s_cmp_lt_u32 s32, 2
    s_cselect_b32 s37, s36, s37
    s_cselect_b32 s39, -2, 0
    s_lshl_b32 s38, s20, 1
    s_add_u32 s38, s38, s34
    s_lshl_b32 s38, s38, 1
    s_add_u32 s38, s38, s35
    s_lshl_b32 s38, s38, 1
    v_add_u32 v20, 0, v2
    v_mul_u32_u24 v21, 13108, v20
    v_lshrrev_b32 v21, 17, v21
    v_mul_u32_u24 v22, 81760, v21
    v_lshl_add_u32 v10, v20, 4, v22
    v_add_u32 v20, 64, v2
    v_mul_u32_u24 v21, 13108, v20
    v_lshrrev_b32 v21, 17, v21
    v_mul_u32_u24 v22, 81760, v21
    v_lshl_add_u32 v11, v20, 4, v22
    v_add_u32 v20, 128, v2
    v_mul_u32_u24 v21, 13108, v20
    v_lshrrev_b32 v21, 17, v21
    v_mul_u32_u24 v22, 81760, v21
    v_lshl_add_u32 v12, v20, 4, v22
    v_add_u32 v20, 192, v2
    v_mul_u32_u24 v21, 13108, v20
    v_lshrrev_b32 v21, 17, v21
    v_mul_u32_u24 v22, 81760, v21
    v_lshl_add_u32 v13, v20, 4, v22
    v_add_u32 v20, 256, v2
    v_mul_u32_u24 v21, 13108, v20
    v_lshrrev_b32 v21, 17, v21
    v_mul_u32_u24 v22, 81760, v21
    v_lshl_add_u32 v14, v20, 4, v22
    v_lshrrev_b32 v20, 1, v2
    v_mul_u32_u24 v20, 81920, v20
    v_and_b32 v21, 1, v2
    v_mul_u32_u24 v21, 80, v21
    v_add_u32 v47, v20, v21
    s_mul_i32 s40, s37, 160
    s_add_u32 s40, s40, s39
    s_mul_i32 s41, s33, 10240
    s_add_u32 s40, s40, s41
    s_add_u32 s40, s40, 1048576
    s_sub_u32 s41, s40, 10160
    s_mul_i32 s42, s32, 6144
    s_add_u32 s42, s42, 122880
    s_mul_i32 s43, s33, 5
    s_sub_u32 s44, 75, s43
    s_cmp_lt_u32 s32, 2
    s_cselect_b32 s43, s43, s44
    v_lshlrev_b32 v5, 4, v8
    v_lshl_add_u32 v5, v4, 3, v5
    s_mul_i32 s44, s38, 20480
    s_lshl_b32 s45, s43, 8
    s_add_u32 s44, s44, s45
    v_mul_u32_u24 v6, 81920, v8
    v_lshl_add_u32 v7, v4, 3, v6
    v_lshl_add_u32 v6, v4, 4, v6
    s_mul_i32 s46, s36, 1280
    s_lshl_b32 s45, s43, 4
    s_add_u32 s46, s46, s45
    s_add_u32 s47, s46, 1310720
    v_lshlrev_b32 v36, 6, v8
    v_add_u32 v36, s36, v36
    v_cvt_f32_u32 v36, v36
    v_mul_f32 v36, 0x3a000000, v36
    v_lshlrev_b32 v38, 2, v4
    v_cvt_f32_u32 v38, v38
    s_cmp_lt_u32 s32, 2
    s_cselect_b32 s48, 0, 0x80000000
    v_lshlrev_b32 v99, 2, v0
    v_mul_f32 v37, v38, v36
    s_mov_b32 s49, 0x00000000
    v_fma_f32 v40, v36, s49, v37
    v_cos_f32 v41, v40
    v_sin_f32 v42, v40
    s_nop 0
    v_xor_b32 v42, s48, v42
    v_cvt_pk_bf16_f32 v20, v41, v42
    s_mov_b32 s49, 0x3f800000
    v_fma_f32 v43, v36, s49, v37
    v_cos_f32 v44, v43
    v_sin_f32 v45, v43
    s_nop 0
    v_xor_b32 v45, s48, v45
    v_cvt_pk_bf16_f32 v21, v44, v45
    s_mov_b32 s49, 0x40000000
    v_fma_f32 v40, v36, s49, v37
    v_cos_f32 v41, v40
    v_sin_f32 v42, v40
    s_nop 0
    v_xor_b32 v42, s48, v42
    v_cvt_pk_bf16_f32 v22, v41, v42
    s_mov_b32 s49, 0x40400000
    v_fma_f32 v43, v36, s49, v37
    v_cos_f32 v44, v43
    v_sin_f32 v45, v43
    s_nop 0
    v_xor_b32 v45, s48, v45
    v_cvt_pk_bf16_f32 v23, v44, v45
    s_mov_b32 s49, 0x41800000
    v_fma_f32 v40, v36, s49, v37
    v_cos_f32 v41, v40
    v_sin_f32 v42, v40
    s_nop 0
    v_xor_b32 v42, s48, v42
    v_cvt_pk_bf16_f32 v24, v41, v42
    s_mov_b32 s49, 0x41880000
    v_fma_f32 v43, v36, s49, v37
    v_cos_f32 v44, v43
    v_sin_f32 v45, v43
    s_nop 0
    v_xor_b32 v45, s48, v45
    v_cvt_pk_bf16_f32 v25, v44, v45
    s_mov_b32 s49, 0x41900000
    v_fma_f32 v40, v36, s49, v37
    v_cos_f32 v41, v40
    v_sin_f32 v42, v40
    s_nop 0
    v_xor_b32 v42, s48, v42
    v_cvt_pk_bf16_f32 v26, v41, v42
    s_mov_b32 s49, 0x41980000
    v_fma_f32 v43, v36, s49, v37
    v_cos_f32 v44, v43
    v_sin_f32 v45, v43
    s_nop 0
    v_xor_b32 v45, s48, v45
    v_cvt_pk_bf16_f32 v27, v44, v45
    buffer_load_dwordx4 v[100:103], v6, s[12:15], s46 offen
    buffer_load_dwordx2 v[104:105], v7, s[12:15], s46 offen offset:64
    buffer_load_dwordx4 v[106:109], v6, s[12:15], s47 offen
    buffer_load_dwordx2 v[110:111], v7, s[12:15], s47 offen offset:64
    v_add_f32 v36, 0.5, v36
    v_mul_f32 v37, v38, v36
    s_mov_b32 s49, 0x00000000
    v_fma_f32 v40, v36, s49, v37
    v_cos_f32 v41, v40
    v_sin_f32 v42, v40
    s_nop 0
    v_xor_b32 v42, s48, v42
    v_cvt_pk_bf16_f32 v28, v41, v42
    s_mov_b32 s49, 0x3f800000
    v_fma_f32 v43, v36, s49, v37
    v_cos_f32 v44, v43
    v_sin_f32 v45, v43
    s_nop 0
    v_xor_b32 v45, s48, v45
    v_cvt_pk_bf16_f32 v29, v44, v45
    s_mov_b32 s49, 0x40000000
    v_fma_f32 v40, v36, s49, v37
    v_cos_f32 v41, v40
    v_sin_f32 v42, v40
    s_nop 0
    v_xor_b32 v42, s48, v42
    v_cvt_pk_bf16_f32 v30, v41, v42
    s_mov_b32 s49, 0x40400000
    v_fma_f32 v43, v36, s49, v37
    v_cos_f32 v44, v43
    v_sin_f32 v45, v43
    s_nop 0
    v_xor_b32 v45, s48, v45
    v_cvt_pk_bf16_f32 v31, v44, v45
    s_mov_b32 s49, 0x41800000
    v_fma_f32 v40, v36, s49, v37
    v_cos_f32 v41, v40
    v_sin_f32 v42, v40
    s_nop 0
    v_xor_b32 v42, s48, v42
    v_cvt_pk_bf16_f32 v32, v41, v42
    s_mov_b32 s49, 0x41880000
    v_fma_f32 v43, v36, s49, v37
    v_cos_f32 v44, v43
    v_sin_f32 v45, v43
    s_nop 0
    v_xor_b32 v45, s48, v45
    v_cvt_pk_bf16_f32 v33, v44, v45
    s_mov_b32 s49, 0x41900000
    v_fma_f32 v40, v36, s49, v37
    v_cos_f32 v41, v40
    v_sin_f32 v42, v40
    s_nop 0
    v_xor_b32 v42, s48, v42
    v_cvt_pk_bf16_f32 v34, v41, v42
    s_mov_b32 s49, 0x41980000
    v_fma_f32 v43, v36, s49, v37
    v_cos_f32 v44, v43
    v_sin_f32 v45, v43
    s_nop 0
    v_xor_b32 v45, s48, v45
    v_cvt_pk_bf16_f32 v35, v44, v45
    v_bfe_u32 v15, v2, 2, 2
    v_and_b32 v16, 3, v2
    v_lshl_add_u32 v17, v4, 3, v15
    v_mul_u32_u24 v17, 80, v17
    v_add_u32 v17, s42, v17
    v_and_b32 v18, 1, v16
    v_add_u32 v96, s42, v3
    v_mul_u32_u24 v97, 80, v2
    v_add_u32 v97, s42, v97
    s_lshl_b32 s50, s38, 11
    s_lshl_b32 s51, s33, 8
    s_add_u32 s50, s50, s51
    s_lshr_b32 s51, s32, 1
    s_lshl_b32 s51, s51, 7
    s_add_u32 s50, s50, s51
    s_add_u32 s50, s50, 13631488
    s_add_u32 s44, s44, 7340032
    s_add_u32 s45, s44, 20480
    v_lshlrev_b32 v9, 3, v8
    v_lshl_add_u32 v9, v4, 11, v9
    v_mov_b32 v39, 0x3f803f80
    s_mov_b32 s52, -1
    s_mov_b32 s53, 0
    s_waitcnt vmcnt(4)
    s_min_u32 s56, s2, 255
    s_lshl_b32 s57, s32, 8
    s_add_u32 s57, s57, s56
    s_lshr_b32 s56, s57, 5
    s_add_u32 s56, s56, 64
    s_and_b32 s57, s57, 31
    s_lshl_b32 s56, s56, 10
    s_lshl_b32 s57, s57, 5
    s_add_u32 s56, s56, s57
    s_add_u32 s56, s56, 38277120
    v_mov_b32 v252, s100
    v_mov_b32 v253, s101
    s_mov_b64 exec, 1
    buffer_store_dwordx2 v[252:253], v3, s[8:11], s56 offen sc1
    s_mov_b64 exec, -1
    s_cmp_lt_u32 s32, 2
    s_cselect_b32 s57, 4096, 0
    s_cmp_eq_u32 s33, 0
    s_cselect_b32 s57, 0, s57
    v_lshrrev_b32 v252, 5, v2
    v_mul_lo_u32 v252, v252, s57
    v_and_b32 v254, 31, v2
    v_lshlrev_b32 v254, 5, v254
    v_sub_u32 v254, v254, v252
    v_add_u32 v254, 4096, v254
    s_lshl_b32 s57, s33, 12
    s_lshr_b32 s58, s37, 4
    s_lshl_b32 s58, s58, 10
    s_add_u32 s57, s57, s58
    s_add_u32 s59, s57, 38141952
    s_barrier
    s_mov_b32 s58, 0x40000
sync_2_p:
    buffer_load_dwordx2 v[252:253], v254, s[8:11], s59 offen sc1
    s_sub_u32 s58, s58, 1
    s_waitcnt vmcnt(0)
    v_cmp_ne_u64 vcc, s[100:101], v[252:253]
    s_cbranch_scc1 sync_2_x
    s_cbranch_vccnz sync_2_p
sync_2_x:
    s_mov_b64 exec, -1
    s_lshl_b32 s57, s21, 1
    s_mov_b32 s58, 0
    s_lshl_b32 s57, s57, 10
    s_lshl_b32 s58, s58, 5
    s_add_u32 s57, s57, s58
    s_add_u32 s59, s57, 38277120
    v_lshlrev_b32 v254, 5, v2
    s_mov_b32 exec_hi, 0xffff
    buffer_load_dwordx2 v[252:253], v254, s[8:11], s59 offen sc1
    s_mov_b64 exec, -1
    buffer_load_dwordx4 v[120:123], v10, s[8:11], s40 offen sc1
    buffer_load_dwordx4 v[124:127], v11, s[8:11], s40 offen sc1
    buffer_load_dwordx4 v[128:131], v12, s[8:11], s40 offen sc1
    buffer_load_dwordx4 v[132:135], v13, s[8:11], s40 offen sc1
    buffer_load_dwordx4 v[136:139], v14, s[8:11], s40 offen sc1
    buffer_load_ushort v98, v47, s[8:11], s41 offen sc1
    s_waitcnt vmcnt(6)
    s_mov_b32 exec_hi, 0xffff
    v_cmp_ne_u64 vcc, s[100:101], v[252:253]
    s_mov_b64 exec, -1
    s_cbranch_vccz chk_3
    s_mov_b32 exec_hi, 0xffff
    s_mov_b32 s58, 0x40000
sync_4_p:
    buffer_load_dwordx2 v[252:253], v254, s[8:11], s59 offen sc1
    s_sub_u32 s58, s58, 1
    s_waitcnt vmcnt(0)
    v_cmp_ne_u64 vcc, s[100:101], v[252:253]
    s_cbranch_scc1 sync_4_x
    s_cbranch_vccnz sync_4_p
sync_4_x:
    s_mov_b64 exec, -1
chk_3:
    s_lshr_b32 s57, s61, 1
    s_lshl_b32 s57, s57, 3
    s_add_u32 s57, s57, 64
    s_mul_i32 s58, s32, 48
    s_lshl_b32 s57, s57, 10
    s_lshl_b32 s58, s58, 5
    s_add_u32 s57, s57, s58
    s_add_u32 s59, s57, 38277120
    v_lshlrev_b32 v254, 5, v2
    s_mov_b32 exec_hi, 0xffff
    buffer_load_dwordx2 v[252:253], v254, s[8:11], s59 offen sc1
    s_mov_b64 exec, -1
    s_add_u32 s27, s25, 0
    s_add_u32 m0, s26, 0
    s_nop 0
    buffer_load_dwordx4 v3, s[8:11], s27 offen offset:0 sc1 lds
    buffer_load_dwordx4 v3, s[8:11], s27 offen offset:1024 sc1 lds
    buffer_load_dwordx4 v3, s[8:11], s27 offen offset:2048 sc1 lds
    buffer_load_dwordx4 v3, s[8:11], s27 offen offset:3072 sc1 lds
    s_cmp_ge_u32 s32, 2
    s_cbranch_scc1 fb0_right
    v_lshl_add_u32 v19, v16, 4, v17
    v_lshl_add_u32 v46, v18, 3, v17
    v_add_u32 v46, 64, v46
    s_waitcnt vmcnt(13)
    v_lshlrev_b32 v48, 16, v100
    v_and_b32 v49, 0xffff0000, v100
    v_lshlrev_b32 v50, 16, v101
    v_and_b32 v51, 0xffff0000, v101
    v_lshlrev_b32 v52, 16, v102
    v_and_b32 v53, 0xffff0000, v102
    v_lshlrev_b32 v54, 16, v103
    v_and_b32 v55, 0xffff0000, v103
    v_lshlrev_b32 v56, 16, v104
    v_and_b32 v57, 0xffff0000, v104
    v_lshlrev_b32 v58, 16, v105
    v_and_b32 v59, 0xffff0000, v105
    v_lshlrev_b32 v60, 16, v106
    v_and_b32 v61, 0xffff0000, v106
    v_lshlrev_b32 v62, 16, v107
    v_and_b32 v63, 0xffff0000, v107
    v_lshlrev_b32 v64, 16, v108
    v_and_b32 v65, 0xffff0000, v108
    v_lshlrev_b32 v66, 16, v109
    v_and_b32 v67, 0xffff0000, v109
    v_lshlrev_b32 v68, 16, v110
    v_and_b32 v69, 0xffff0000, v110
    v_lshlrev_b32 v70, 16, v111
    v_and_b32 v71, 0xffff0000, v111
    v_mov_b32 v40, v48
    v_mov_b32 v41, v60
    s_waitcnt vmcnt(5)
    ds_write_b128 v96, v[120:123] offset:0
    ds_write_b128 v96, v[124:127] offset:1024
    ds_write_b128 v96, v[128:131] offset:2048
    ds_write_b128 v96, v[132:135] offset:3072
    ds_write_b128 v96, v[136:139] offset:4096
    ds_write_b16 v97, v98
    ds_read_b64_tr_b16 v[72:73], v19 offset:0
    ds_read_b64_tr_b16 v[74:75], v19 offset:320
    ds_read_b64_tr_b16 v[76:77], v19 offset:2560
    ds_read_b64_tr_b16 v[78:79], v19 offset:2880
    ds_read_b64_tr_b16 v[80:81], v19 offset:8
    ds_read_b64_tr_b16 v[82:83], v19 offset:328
    ds_read_b64_tr_b16 v[84:85], v19 offset:2568
    ds_read_b64_tr_b16 v[86:87], v19 offset:2888
    ds_read_b64_tr_b16 v[88:89], v46 offset:0
    ds_read_b64_tr_b16 v[90:91], v46 offset:320
    ds_read_b64_tr_b16 v[92:93], v46 offset:2560
    ds_read_b64_tr_b16 v[94:95], v46 offset:2880
    s_waitcnt lgkmcnt(8)
    v_mfma_f32_16x16x32_bf16 v[48:51], v[72:75], v[20:23], v[48:51]
    v_mfma_f32_16x16x32_bf16 v[60:63], v[72:75], v[28:31], v[60:63]
    v_mfma_f32_16x16x32_bf16 v[48:51], v[76:79], v[24:27], v[48:51]
    v_mfma_f32_16x16x32_bf16 v[60:63], v[76:79], v[32:35], v[60:63]
    s_waitcnt lgkmcnt(4)
    v_mfma_f32_16x16x32_bf16 v[52:55], v[80:83], v[20:23], v[52:55]
    v_mfma_f32_16x16x32_bf16 v[64:67], v[80:83], v[28:31], v[64:67]
    v_mfma_f32_16x16x32_bf16 v[52:55], v[84:87], v[24:27], v[52:55]
    v_mfma_f32_16x16x32_bf16 v[64:67], v[84:87], v[32:35], v[64:67]
    s_waitcnt lgkmcnt(0)
    v_mfma_f32_16x16x32_bf16 v[56:59], v[88:91], v[20:23], v[56:59]
    v_mfma_f32_16x16x32_bf16 v[68:71], v[88:91], v[28:31], v[68:71]
    v_mfma_f32_16x16x32_bf16 v[56:59], v[92:95], v[24:27], v[56:59]
    v_mfma_f32_16x16x32_bf16 v[68:71], v[92:95], v[32:35], v[68:71]
    s_cmp_eq_u32 s33, 0
    s_cselect_b32 s54, 0xffff, 0
    s_mov_b32 s55, 0
    v_cndmask_b32 v48, v48, v40, s[54:55]
    v_cndmask_b32 v60, v60, v41, s[54:55]
    v_cvt_pk_bf16_f32 v100, v48, v49
    v_cvt_pk_bf16_f32 v101, v50, v51
    v_cvt_pk_bf16_f32 v102, v52, v53
    v_cvt_pk_bf16_f32 v103, v54, v55
    v_cvt_pk_bf16_f32 v104, v56, v57
    v_cvt_pk_bf16_f32 v105, v58, v59
    buffer_store_dwordx4 v[100:103], v3, s[8:11], s44 offen sc1
    v_cvt_pk_bf16_f32 v106, v60, v61
    v_cvt_pk_bf16_f32 v107, v62, v63
    v_cvt_pk_bf16_f32 v108, v64, v65
    v_cvt_pk_bf16_f32 v109, v66, v67
    v_cvt_pk_bf16_f32 v110, v68, v69
    v_cvt_pk_bf16_f32 v111, v70, v71
    buffer_store_dwordx4 v[106:109], v3, s[8:11], s45 offen sc1
    s_mov_b64 exec, s[52:53]
    buffer_store_dwordx2 v[104:105], v5, s[8:11], s44 offen offset:1024 sc1
    buffer_store_dwordx2 v[110:111], v5, s[8:11], s45 offen offset:1024 sc1
    s_mov_b64 exec, -1
    v_cndmask_b32 v72, 0, v104, s[52:53]
    v_cndmask_b32 v73, 0, v105, s[52:53]
    v_cndmask_b32 v74, 0, v110, s[52:53]
    v_cndmask_b32 v75, 0, v111, s[52:53]
    v_dot2_f32_bf16 v40, v100, v39, 0
    v_dot2_f32_bf16 v41, v100, v100, 0
    v_dot2_f32_bf16 v40, v101, v39, v40
    v_dot2_f32_bf16 v41, v101, v101, v41
    v_dot2_f32_bf16 v40, v102, v39, v40
    v_dot2_f32_bf16 v41, v102, v102, v41
    v_dot2_f32_bf16 v40, v103, v39, v40
    v_dot2_f32_bf16 v41, v103, v103, v41
    v_dot2_f32_bf16 v40, v72, v39, v40
    v_dot2_f32_bf16 v41, v72, v72, v41
    v_dot2_f32_bf16 v40, v73, v39, v40
    v_dot2_f32_bf16 v41, v73, v73, v41
    v_dot2_f32_bf16 v42, v106, v39, 0
    v_dot2_f32_bf16 v43, v106, v106, 0
    v_dot2_f32_bf16 v42, v107, v39, v42
    v_dot2_f32_bf16 v43, v107, v107, v43
    v_dot2_f32_bf16 v42, v108, v39, v42
    v_dot2_f32_bf16 v43, v108, v108, v43
    v_dot2_f32_bf16 v42, v109, v39, v42
    v_dot2_f32_bf16 v43, v109, v109, v43
    v_dot2_f32_bf16 v42, v74, v39, v42
    v_dot2_f32_bf16 v43, v74, v74, v43
    v_dot2_f32_bf16 v42, v75, v39, v42
    v_dot2_f32_bf16 v43, v75, v75, v43
    v_mov_b32 v76, v40
    v_mov_b32 v77, v41
    v_mov_b32 v78, v42
    v_mov_b32 v79, v43
    v_permlane16_swap_b32 v40, v76
    v_permlane16_swap_b32 v41, v77
    v_permlane16_swap_b32 v42, v78
    v_permlane16_swap_b32 v43, v79
    v_add_f32 v40, v40, v76
    v_add_f32 v41, v41, v77
    v_add_f32 v42, v42, v78
    v_add_f32 v43, v43, v79
    v_mov_b32 v76, v40
    v_mov_b32 v77, v41
    v_mov_b32 v78, v42
    v_mov_b32 v79, v43
    v_permlane32_swap_b32 v40, v76
    v_permlane32_swap_b32 v41, v77
    v_permlane32_swap_b32 v42, v78
    v_permlane32_swap_b32 v43, v79
    v_add_f32 v40, v40, v76
    v_add_f32 v41, v41, v77
    v_add_f32 v42, v42, v78
    v_add_f32 v43, v43, v79
    s_mov_b64 exec, 0xffff0000
    v_mov_b32 v40, v42
    v_mov_b32 v41, v43
    s_mov_b64 exec, s[52:53]
    buffer_store_dwordx2 v[40:41], v9, s[8:11], s50 offen sc1
    s_mov_b64 exec, -1
    s_branch fb0_s2done
fb0_right:
    v_lshlrev_b32 v16, 4, v16
    v_sub_u32 v19, v17, v16
    v_add_u32 v19, 64, v19
    v_lshlrev_b32 v18, 3, v18
    v_sub_u32 v46, v17, v18
    v_add_u32 v46, 8, v46
    s_waitcnt vmcnt(13)
    v_lshlrev_b32 v51, 16, v100
    v_and_b32 v50, 0xffff0000, v100
    v_lshlrev_b32 v49, 16, v101
    v_and_b32 v48, 0xffff0000, v101
    v_lshlrev_b32 v55, 16, v102
    v_and_b32 v54, 0xffff0000, v102
    v_lshlrev_b32 v53, 16, v103
    v_and_b32 v52, 0xffff0000, v103
    v_lshlrev_b32 v59, 16, v104
    v_and_b32 v58, 0xffff0000, v104
    v_lshlrev_b32 v57, 16, v105
    v_and_b32 v56, 0xffff0000, v105
    v_lshlrev_b32 v63, 16, v106
    v_and_b32 v62, 0xffff0000, v106
    v_lshlrev_b32 v61, 16, v107
    v_and_b32 v60, 0xffff0000, v107
    v_lshlrev_b32 v67, 16, v108
    v_and_b32 v66, 0xffff0000, v108
    v_lshlrev_b32 v65, 16, v109
    v_and_b32 v64, 0xffff0000, v109
    v_lshlrev_b32 v71, 16, v110
    v_and_b32 v70, 0xffff0000, v110
    v_lshlrev_b32 v69, 16, v111
    v_and_b32 v68, 0xffff0000, v111
    s_waitcnt vmcnt(5)
    ds_write_b128 v96, v[120:123] offset:0
    ds_write_b128 v96, v[124:127] offset:1024
    ds_write_b128 v96, v[128:131] offset:2048
    ds_write_b128 v96, v[132:135] offset:3072
    ds_write_b128 v96, v[136:139] offset:4096
    ds_read_b64_tr_b16 v[72:73], v19 offset:8
    ds_read_b64_tr_b16 v[74:75], v19 offset:328
    ds_read_b64_tr_b16 v[76:77], v19 offset:2568
    ds_read_b64_tr_b16 v[78:79], v19 offset:2888
    ds_read_b64_tr_b16 v[80:81], v19 offset:0
    ds_read_b64_tr_b16 v[82:83], v19 offset:320
    ds_read_b64_tr_b16 v[84:85], v19 offset:2560
    ds_read_b64_tr_b16 v[86:87], v19 offset:2880
    ds_read_b64_tr_b16 v[88:89], v46 offset:0
    ds_read_b64_tr_b16 v[90:91], v46 offset:320
    ds_read_b64_tr_b16 v[92:93], v46 offset:2560
    ds_read_b64_tr_b16 v[94:95], v46 offset:2880
    s_waitcnt lgkmcnt(8)
    v_mfma_f32_16x16x32_bf16 v[48:51], v[72:75], v[20:23], v[48:51]
    v_mfma_f32_16x16x32_bf16 v[60:63], v[72:75], v[28:31], v[60:63]
    v_mfma_f32_16x16x32_bf16 v[48:51], v[76:79], v[24:27], v[48:51]
    v_mfma_f32_16x16x32_bf16 v[60:63], v[76:79], v[32:35], v[60:63]
    s_waitcnt lgkmcnt(4)
    v_mfma_f32_16x16x32_bf16 v[52:55], v[80:83], v[20:23], v[52:55]
    v_mfma_f32_16x16x32_bf16 v[64:67], v[80:83], v[28:31], v[64:67]
    v_mfma_f32_16x16x32_bf16 v[52:55], v[84:87], v[24:27], v[52:55]
    v_mfma_f32_16x16x32_bf16 v[64:67], v[84:87], v[32:35], v[64:67]
    s_waitcnt lgkmcnt(0)
    v_mfma_f32_16x16x32_bf16 v[56:59], v[88:91], v[20:23], v[56:59]
    v_mfma_f32_16x16x32_bf16 v[68:71], v[88:91], v[28:31], v[68:71]
    v_mfma_f32_16x16x32_bf16 v[56:59], v[92:95], v[24:27], v[56:59]
    v_mfma_f32_16x16x32_bf16 v[68:71], v[92:95], v[32:35], v[68:71]
    v_cvt_pk_bf16_f32 v100, v51, v50
    v_cvt_pk_bf16_f32 v101, v49, v48
    v_cvt_pk_bf16_f32 v102, v55, v54
    v_cvt_pk_bf16_f32 v103, v53, v52
    s_nop 2
    v_cvt_pk_bf16_f32 v104, v59, v58
    v_cvt_pk_bf16_f32 v105, v57, v56
    buffer_store_dwordx4 v[100:103], v3, s[8:11], s44 offen sc1
    v_cvt_pk_bf16_f32 v106, v63, v62
    v_cvt_pk_bf16_f32 v107, v61, v60
    v_cvt_pk_bf16_f32 v108, v67, v66
    v_cvt_pk_bf16_f32 v109, v65, v64
    v_cvt_pk_bf16_f32 v110, v71, v70
    v_cvt_pk_bf16_f32 v111, v69, v68
    buffer_store_dwordx4 v[106:109], v3, s[8:11], s45 offen sc1
    s_mov_b64 exec, s[52:53]
    buffer_store_dwordx2 v[104:105], v5, s[8:11], s44 offen offset:1024 sc1
    buffer_store_dwordx2 v[110:111], v5, s[8:11], s45 offen offset:1024 sc1
    s_mov_b64 exec, -1
    v_cndmask_b32 v72, 0, v104, s[52:53]
    v_cndmask_b32 v73, 0, v105, s[52:53]
    v_cndmask_b32 v74, 0, v110, s[52:53]
    v_cndmask_b32 v75, 0, v111, s[52:53]
    v_dot2_f32_bf16 v40, v100, v39, 0
    v_dot2_f32_bf16 v41, v100, v100, 0
    v_dot2_f32_bf16 v40, v101, v39, v40
    v_dot2_f32_bf16 v41, v101, v101, v41
    v_dot2_f32_bf16 v40, v102, v39, v40
    v_dot2_f32_bf16 v41, v102, v102, v41
    v_dot2_f32_bf16 v40, v103, v39, v40
    v_dot2_f32_bf16 v41, v103, v103, v41
    v_dot2_f32_bf16 v40, v72, v39, v40
    v_dot2_f32_bf16 v41, v72, v72, v41
    v_dot2_f32_bf16 v40, v73, v39, v40
    v_dot2_f32_bf16 v41, v73, v73, v41
    v_dot2_f32_bf16 v42, v106, v39, 0
    v_dot2_f32_bf16 v43, v106, v106, 0
    v_dot2_f32_bf16 v42, v107, v39, v42
    v_dot2_f32_bf16 v43, v107, v107, v43
    v_dot2_f32_bf16 v42, v108, v39, v42
    v_dot2_f32_bf16 v43, v108, v108, v43
    v_dot2_f32_bf16 v42, v109, v39, v42
    v_dot2_f32_bf16 v43, v109, v109, v43
    v_dot2_f32_bf16 v42, v74, v39, v42
    v_dot2_f32_bf16 v43, v74, v74, v43
    v_dot2_f32_bf16 v42, v75, v39, v42
    v_dot2_f32_bf16 v43, v75, v75, v43
    v_mov_b32 v76, v40
    v_mov_b32 v77, v41
    v_mov_b32 v78, v42
    v_mov_b32 v79, v43
    v_permlane16_swap_b32 v40, v76
    v_permlane16_swap_b32 v41, v77
    v_permlane16_swap_b32 v42, v78
    v_permlane16_swap_b32 v43, v79
    v_add_f32 v40, v40, v76
    v_add_f32 v41, v41, v77
    v_add_f32 v42, v42, v78
    v_add_f32 v43, v43, v79
    v_mov_b32 v76, v40
    v_mov_b32 v77, v41
    v_mov_b32 v78, v42
    v_mov_b32 v79, v43
    v_permlane32_swap_b32 v40, v76
    v_permlane32_swap_b32 v41, v77
    v_permlane32_swap_b32 v42, v78
    v_permlane32_swap_b32 v43, v79
    v_add_f32 v40, v40, v76
    v_add_f32 v41, v41, v77
    v_add_f32 v42, v42, v78
    v_add_f32 v43, v43, v79
    s_mov_b64 exec, 0xffff0000
    v_mov_b32 v40, v42
    v_mov_b32 v41, v43
    s_mov_b64 exec, s[52:53]
    buffer_store_dwordx2 v[40:41], v9, s[8:11], s50 offen sc1
    s_mov_b64 exec, -1
fb0_s2done:
    buffer_load_dword v112, v99, s[8:11], s29 offen sc1
    s_add_u32 s29, s29, 12288
    buffer_load_dword v113, v99, s[8:11], s29 offen sc1
    s_add_u32 s29, s29, 12288
    buffer_load_dword v114, v99, s[8:11], s29 offen sc1
    s_add_u32 s29, s29, 12288
    buffer_load_dword v115, v99, s[8:11], s29 offen sc1
    s_add_u32 s27, s27, 4096
    s_add_u32 m0, s26, 4096
    s_nop 0
    buffer_load_dwordx4 v3, s[8:11], s27 offen offset:0 sc1 lds
    buffer_load_dwordx4 v3, s[8:11], s27 offen offset:1024 sc1 lds
    s_add_u32 s27, s25, 24576
    s_add_u32 m0, s26, 24576
    s_nop 0
    buffer_load_dwordx4 v3, s[8:11], s27 offen offset:0 sc1 lds
    buffer_load_dwordx4 v3, s[8:11], s27 offen offset:1024 sc1 lds
    buffer_load_dwordx4 v3, s[8:11], s27 offen offset:2048 sc1 lds
    s_waitcnt vmcnt(18)
    s_mov_b32 exec_hi, 0xffff
    v_cmp_ne_u64 vcc, s[100:101], v[252:253]
    s_mov_b64 exec, -1
    s_cbranch_vccz chk_5
    s_mov_b32 exec_hi, 0xffff
    s_mov_b32 s58, 0x40000
sync_6_p:
    buffer_load_dwordx2 v[252:253], v254, s[8:11], s59 offen sc1
    s_sub_u32 s58, s58, 1
    s_waitcnt vmcnt(0)
    v_cmp_ne_u64 vcc, s[100:101], v[252:253]
    s_cbranch_scc1 sync_6_x
    s_cbranch_vccnz sync_6_p
sync_6_x:
    s_mov_b64 exec, -1
chk_5:
    s_waitcnt vmcnt(5)
    v_add_f32 v112, v112, v113
    v_add_f32 v114, v114, v115
    v_add_f32 v112, v112, v114
    v_cvt_pk_bf16_f32 v113, v112, v112
    v_lshlrev_b32 v113, 16, v113
    v_sub_f32 v113, v112, v113
    v_cvt_pk_bf16_f32 v112, v112, v113
    v_mov_b32 v113, 0
    v_mov_b32 v114, 0
    v_mov_b32 v115, 0
    v_lshlrev_b32 v99, 2, v99
    v_add_u32 v99, 147456, v99
    s_cmp_eq_u32 s32, 3
    s_cbranch_scc1 fb0_nocs
    ds_write_b128 v99, v[112:115]
fb0_nocs:
    s_waitcnt lgkmcnt(0)
    s_waitcnt vmcnt(9)
    s_lshr_b32 s56, s38, 1
    s_lshr_b32 s57, s32, 1
    s_lshl_b32 s58, s33, 1
    s_add_u32 s57, s57, s58
    s_lshl_b32 s56, s56, 10
    s_lshl_b32 s57, s57, 5
    s_add_u32 s56, s56, s57
    s_add_u32 s56, s56, 37228544
    v_mov_b32 v252, s100
    v_mov_b32 v253, s101
    s_mov_b64 exec, 1
    buffer_store_dwordx2 v[252:253], v3, s[8:11], s56 offen sc1
    s_mov_b64 exec, -1
    buffer_load_dwordx4 v3, s[8:11], s27 offen offset:3072 sc1 lds
    s_add_u32 s27, s27, 4096
    s_add_u32 m0, s26, 28672
    s_nop 0
    buffer_load_dwordx4 v3, s[8:11], s27 offen offset:0 sc1 lds
    buffer_load_dwordx4 v3, s[8:11], s27 offen offset:1024 sc1 lds
    s_add_u32 s27, s25, 49152
    s_add_u32 m0, s26, 49152
    s_nop 0
    buffer_load_dwordx4 v3, s[8:11], s27 offen offset:0 sc1 lds
    buffer_load_dwordx4 v3, s[8:11], s27 offen offset:1024 sc1 lds
    buffer_load_dwordx4 v3, s[8:11], s27 offen offset:2048 sc1 lds
    buffer_load_dwordx4 v3, s[8:11], s27 offen offset:3072 sc1 lds
    s_add_u32 s27, s27, 4096
    s_add_u32 m0, s26, 53248
    s_nop 0
    buffer_load_dwordx4 v3, s[8:11], s27 offen offset:0 sc1 lds
    buffer_load_dwordx4 v3, s[8:11], s27 offen offset:1024 sc1 lds
    s_add_u32 s27, s25, 73728
    s_add_u32 m0, s26, 73728
    s_nop 0
    buffer_load_dwordx4 v3, s[8:11], s27 offen offset:0 sc1 lds
    buffer_load_dwordx4 v3, s[8:11], s27 offen offset:1024 sc1 lds
    buffer_load_dwordx4 v3, s[8:11], s27 offen offset:2048 sc1 lds
    buffer_load_dwordx4 v3, s[8:11], s27 offen offset:3072 sc1 lds
    s_add_u32 s27, s27, 4096
    s_add_u32 m0, s26, 77824
    s_nop 0
    buffer_load_dwordx4 v3, s[8:11], s27 offen offset:0 sc1 lds
    buffer_load_dwordx4 v3, s[8:11], s27 offen offset:1024 sc1 lds
    s_add_u32 s27, s25, 98304
    s_add_u32 m0, s26, 98304
    s_nop 0
    buffer_load_dwordx4 v3, s[8:11], s27 offen offset:0 sc1 lds
    buffer_load_dwordx4 v3, s[8:11], s27 offen offset:1024 sc1 lds
    buffer_load_dwordx4 v3, s[8:11], s27 offen offset:2048 sc1 lds
    buffer_load_dwordx4 v3, s[8:11], s27 offen offset:3072 sc1 lds
    s_add_u32 s27, s27, 4096
    s_add_u32 m0, s26, 102400
    s_nop 0
    buffer_load_dwordx4 v3, s[8:11], s27 offen offset:0 sc1 lds
    buffer_load_dwordx4 v3, s[8:11], s27 offen offset:1024 sc1 lds
    s_add_u32 s27, s25, 122880
    s_add_u32 m0, s26, 122880
    s_nop 0
    buffer_load_dwordx4 v3, s[8:11], s27 offen offset:0 sc1 lds
    buffer_load_dwordx4 v3, s[8:11], s27 offen offset:1024 sc1 lds
    buffer_load_dwordx4 v3, s[8:11], s27 offen offset:2048 sc1 lds
    buffer_load_dwordx4 v3, s[8:11], s27 offen offset:3072 sc1 lds
    s_add_u32 s27, s27, 4096
    s_add_u32 m0, s26, 126976
    s_nop 0
    buffer_load_dwordx4 v3, s[8:11], s27 offen offset:0 sc1 lds
    buffer_load_dwordx4 v3, s[8:11], s27 offen offset:1024 sc1 lds
    s_add_u32 s30, s31, 0
    buffer_load_dwordx4 a[160:163], v3, s[8:11], s30 offen offset:0 sc1
    buffer_load_dwordx4 a[164:167], v3, s[8:11], s30 offen offset:1024 sc1
    buffer_load_dwordx4 a[168:171], v3, s[8:11], s30 offen offset:2048 sc1
    buffer_load_dwordx4 a[172:175], v3, s[8:11], s30 offen offset:3072 sc1
    s_add_u32 s30, s31, 4096
    buffer_load_dwordx4 a[176:179], v3, s[8:11], s30 offen offset:0 sc1
    s_add_u32 s30, s31, 15360
    buffer_load_dwordx4 a[180:183], v3, s[8:11], s30 offen offset:0 sc1
    buffer_load_dwordx4 a[184:187], v3, s[8:11], s30 offen offset:1024 sc1
    buffer_load_dwordx4 a[188:191], v3, s[8:11], s30 offen offset:2048 sc1
    s_lshl_b32 s33, s20, 2
    s_add_u32 s33, s33, s32
    s_mul_i32 s34, s33, 40960
    s_add_u32 s34, s34, 7340032
    s_mul_i32 s40, s33, 98304
    s_mul_i32 s41, s21, 3072
    s_add_u32 s40, s40, s41
    s_add_u32 s40, s40, 14680064
    s_add_u32 s41, s40, 49152
    s_lshl_b32 s43, s33, 12
    s_add_u32 s43, s43, 13631488
    v_lshlrev_b32 v15, 3, v8
    v_lshl_add_u32 v15, v4, 7, v15
    v_lshlrev_b32 v14, 4, v8
    v_add_u32 v14, 147456, v14
    v_add_u32 v5, 49152, v3
    v_add_u32 v6, 98304, v3
    s_mov_b32 s46, 0xffff
    s_mov_b32 s47, 0
    s_add_u32 s56, s32, 0
    s_and_b32 s56, s56, 3
    s_lshl_b32 s57, s60, 2
    s_add_u32 s57, s57, s56
    s_mul_i32 s57, s57, 49152
    s_mul_i32 s56, s32, 12288
    s_add_u32 s57, s57, s56
    s_add_u32 s48, s57, 14680064
    s_add_u32 s56, s32, 1
    s_and_b32 s56, s56, 3
    s_lshl_b32 s57, s60, 2
    s_add_u32 s57, s57, s56
    s_mul_i32 s57, s57, 49152
    s_mul_i32 s56, s32, 12288
    s_add_u32 s57, s57, s56
    s_add_u32 s49, s57, 14680064
    s_add_u32 s56, s32, 2
    s_and_b32 s56, s56, 3
    s_lshl_b32 s57, s60, 2
    s_add_u32 s57, s57, s56
    s_mul_i32 s57, s57, 49152
    s_mul_i32 s56, s32, 12288
    s_add_u32 s57, s57, s56
    s_add_u32 s50, s57, 14680064
    s_add_u32 s56, s32, 3
    s_and_b32 s56, s56, 3
    s_lshl_b32 s57, s60, 2
    s_add_u32 s57, s57, s56
    s_mul_i32 s57, s57, 49152
    s_mul_i32 s56, s32, 12288
    s_add_u32 s57, s57, s56
    s_add_u32 s51, s57, 14680064
    s_lshl_b32 s56, s60, 2
    s_add_u32 s56, s56, s32
    s_mul_i32 s56, s56, 20480
    s_mul_i32 s57, s61, 2560
    s_add_u32 s52, s56, s57
    s_mul_i32 s53, s32, 12288
    s_lshl_b32 s54, s32, 13
    s_mul_i32 s56, s32, 12288
    s_sub_u32 s55, s48, s56
    s_add_u32 s55, s55, 2048
    s_lshl_b32 s57, s20, 2
    s_add_u32 s57, s57, s32
    s_mov_b32 s58, 0
    s_lshl_b32 s57, s57, 10
    s_lshl_b32 s58, s58, 5
    s_add_u32 s57, s57, s58
    s_add_u32 s59, s57, 37228544
    v_lshlrev_b32 v254, 5, v2
    s_waitcnt vmcnt(39)
    s_barrier
    s_mov_b64 exec, 0xffff
    s_mov_b32 s58, 0x40000
sync_7_p:
    buffer_load_dwordx2 v[252:253], v254, s[8:11], s59 offen sc1
    s_sub_u32 s58, s58, 1
    s_waitcnt vmcnt(0)
    v_cmp_ne_u64 vcc, s[100:101], v[252:253]
    s_cbranch_scc1 sync_7_x
    s_cbranch_vccnz sync_7_p
sync_7_x:
    s_mov_b64 exec, -1
    s_add_u32 s38, s34, 0
    buffer_load_dwordx4 a[0:3], v3, s[8:11], s38 offen offset:0 sc1
    s_add_u32 s39, s34, 20480
    buffer_load_dwordx4 a[4:7], v3, s[8:11], s39 offen offset:0 sc1
    buffer_load_dwordx4 a[8:11], v3, s[8:11], s38 offen offset:1024 sc1
    buffer_load_dwordx4 a[12:15], v3, s[8:11], s39 offen offset:1024 sc1
    ds_read_b128 v[112:115], v3 offset:0
    ds_read_b128 v[116:119], v3 offset:1024
    ds_read_b128 v[120:123], v3 offset:2048
    ds_read_b128 v[124:127], v3 offset:3072
    ds_read_b128 v[128:131], v3 offset:4096
    ds_read_b128 v[132:135], v3 offset:5120
    ds_read_b128 v[136:139], v3 offset:6144
    ds_read_b128 v[140:143], v3 offset:7168
    s_waitcnt vmcnt(2)
    s_waitcnt lgkmcnt(6)
    v_mfma_f32_16x16x32_bf16 v[16:19], v[112:115], a[0:3], 0
    ds_read_b128 v[144:147], v3 offset:8192
    v_mfma_f32_16x16x32_bf16 v[20:23], v[112:115], a[4:7], 0
    buffer_load_dwordx4 a[16:19], v3, s[8:11], s38 offen offset:2048 sc1
    v_mfma_f32_16x16x32_bf16 v[28:31], v[116:119], a[4:7], 0
    ds_read_b128 v[148:151], v3 offset:9216
    v_mfma_f32_16x16x32_bf16 v[24:27], v[116:119], a[0:3], 0
    s_waitcnt lgkmcnt(6)
    v_mfma_f32_16x16x32_bf16 v[32:35], v[120:123], a[0:3], 0
    ds_read_b128 v[112:115], v3 offset:10240
    v_mfma_f32_16x16x32_bf16 v[36:39], v[120:123], a[4:7], 0
    buffer_load_dwordx4 a[20:23], v3, s[8:11], s39 offen offset:2048 sc1
    v_mfma_f32_16x16x32_bf16 v[44:47], v[124:127], a[4:7], 0
    ds_read_b128 v[116:119], v3 offset:11264
    v_mfma_f32_16x16x32_bf16 v[40:43], v[124:127], a[0:3], 0
    s_waitcnt lgkmcnt(6)
    v_mfma_f32_16x16x32_bf16 v[48:51], v[128:131], a[0:3], 0
    ds_read_b128 v[120:123], v3 offset:12288
    v_mfma_f32_16x16x32_bf16 v[52:55], v[128:131], a[4:7], 0
    buffer_load_dwordx4 a[24:27], v3, s[8:11], s38 offen offset:3072 sc1
    v_mfma_f32_16x16x32_bf16 v[60:63], v[132:135], a[4:7], 0
    ds_read_b128 v[124:127], v3 offset:13312
    v_mfma_f32_16x16x32_bf16 v[56:59], v[132:135], a[0:3], 0
    s_waitcnt lgkmcnt(6)
    v_mfma_f32_16x16x32_bf16 v[64:67], v[136:139], a[0:3], 0
    ds_read_b128 v[128:131], v3 offset:14336
    v_mfma_f32_16x16x32_bf16 v[68:71], v[136:139], a[4:7], 0
    buffer_load_dwordx4 a[28:31], v3, s[8:11], s39 offen offset:3072 sc1
    v_mfma_f32_16x16x32_bf16 v[76:79], v[140:143], a[4:7], 0
    ds_read_b128 v[132:135], v3 offset:15360
    v_mfma_f32_16x16x32_bf16 v[72:75], v[140:143], a[0:3], 0
    s_waitcnt lgkmcnt(6)
    v_mfma_f32_16x16x32_bf16 v[80:83], v[144:147], a[0:3], 0
    ds_read_b128 v[136:139], v3 offset:16384
    v_mfma_f32_16x16x32_bf16 v[84:87], v[144:147], a[4:7], 0
    s_add_u32 s38, s34, 4096
    buffer_load_dwordx4 a[32:35], v3, s[8:11], s38 offen offset:0 sc1
    v_mfma_f32_16x16x32_bf16 v[92:95], v[148:151], a[4:7], 0
    ds_read_b128 v[140:143], v3 offset:17408
    v_mfma_f32_16x16x32_bf16 v[88:91], v[148:151], a[0:3], 0
    s_waitcnt lgkmcnt(6)
    v_mfma_f32_16x16x32_bf16 v[96:99], v[112:115], a[0:3], 0
    ds_read_b128 v[144:147], v3 offset:18432
    v_mfma_f32_16x16x32_bf16 v[100:103], v[112:115], a[4:7], 0
    s_add_u32 s39, s34, 24576
    buffer_load_dwordx4 a[36:39], v3, s[8:11], s39 offen offset:0 sc1
    v_mfma_f32_16x16x32_bf16 v[108:111], v[116:119], a[4:7], 0
    ds_read_b128 v[148:151], v3 offset:19456
    v_mfma_f32_16x16x32_bf16 v[104:107], v[116:119], a[0:3], 0
    s_waitcnt vmcnt(6)
    s_waitcnt lgkmcnt(6)
    v_mfma_f32_16x16x32_bf16 v[16:19], v[120:123], a[8:11], v[16:19]
    ds_read_b128 v[112:115], v3 offset:20480
    v_mfma_f32_16x16x32_bf16 v[20:23], v[120:123], a[12:15], v[20:23]
    buffer_load_dwordx4 a[40:43], v3, s[8:11], s38 offen offset:1024 sc1
    v_mfma_f32_16x16x32_bf16 v[28:31], v[124:127], a[12:15], v[28:31]
    ds_read_b128 v[116:119], v3 offset:21504
    v_mfma_f32_16x16x32_bf16 v[24:27], v[124:127], a[8:11], v[24:27]
    s_waitcnt lgkmcnt(6)
    v_mfma_f32_16x16x32_bf16 v[32:35], v[128:131], a[8:11], v[32:35]
    ds_read_b128 v[120:123], v3 offset:22528
    v_mfma_f32_16x16x32_bf16 v[36:39], v[128:131], a[12:15], v[36:39]
    buffer_load_dwordx4 a[44:47], v3, s[8:11], s39 offen offset:1024 sc1
    v_mfma_f32_16x16x32_bf16 v[44:47], v[132:135], a[12:15], v[44:47]
    ds_read_b128 v[124:127], v3 offset:23552
    v_mfma_f32_16x16x32_bf16 v[40:43], v[132:135], a[8:11], v[40:43]
    s_waitcnt vmcnt(44)
    s_barrier
    s_waitcnt lgkmcnt(6)
    v_mfma_f32_16x16x32_bf16 v[48:51], v[136:139], a[8:11], v[48:51]
    ds_read_b128 v[128:131], v3 offset:24576
    v_mfma_f32_16x16x32_bf16 v[52:55], v[136:139], a[12:15], v[52:55]
    buffer_load_dwordx4 a[48:51], v3, s[8:11], s38 offen offset:2048 sc1
    v_mfma_f32_16x16x32_bf16 v[60:63], v[140:143], a[12:15], v[60:63]
    ds_read_b128 v[132:135], v3 offset:25600
    v_mfma_f32_16x16x32_bf16 v[56:59], v[140:143], a[8:11], v[56:59]
    s_waitcnt lgkmcnt(6)
    v_mfma_f32_16x16x32_bf16 v[64:67], v[144:147], a[8:11], v[64:67]
    ds_read_b128 v[136:139], v3 offset:26624
    v_mfma_f32_16x16x32_bf16 v[68:71], v[144:147], a[12:15], v[68:71]
    buffer_load_dwordx4 a[52:55], v3, s[8:11], s39 offen offset:2048 sc1
    v_mfma_f32_16x16x32_bf16 v[76:79], v[148:151], a[12:15], v[76:79]
    ds_read_b128 v[140:143], v3 offset:27648
    v_mfma_f32_16x16x32_bf16 v[72:75], v[148:151], a[8:11], v[72:75]
    s_waitcnt lgkmcnt(6)
    v_mfma_f32_16x16x32_bf16 v[80:83], v[112:115], a[8:11], v[80:83]
    ds_read_b128 v[144:147], v3 offset:28672
    v_mfma_f32_16x16x32_bf16 v[84:87], v[112:115], a[12:15], v[84:87]
    buffer_load_dwordx4 a[56:59], v3, s[8:11], s38 offen offset:3072 sc1
    v_mfma_f32_16x16x32_bf16 v[92:95], v[116:119], a[12:15], v[92:95]
    ds_read_b128 v[148:151], v3 offset:29696
    v_mfma_f32_16x16x32_bf16 v[88:91], v[116:119], a[8:11], v[88:91]
    s_waitcnt lgkmcnt(6)
    v_mfma_f32_16x16x32_bf16 v[96:99], v[120:123], a[8:11], v[96:99]
    ds_read_b128 v[112:115], v3 offset:30720
    v_mfma_f32_16x16x32_bf16 v[100:103], v[120:123], a[12:15], v[100:103]
    buffer_load_dwordx4 a[60:63], v3, s[8:11], s39 offen offset:3072 sc1
    v_mfma_f32_16x16x32_bf16 v[108:111], v[124:127], a[12:15], v[108:111]
    ds_read_b128 v[116:119], v3 offset:31744
    v_mfma_f32_16x16x32_bf16 v[104:107], v[124:127], a[8:11], v[104:107]
    s_waitcnt vmcnt(10)
    s_waitcnt lgkmcnt(6)
    v_mfma_f32_16x16x32_bf16 v[16:19], v[128:131], a[16:19], v[16:19]
    ds_read_b128 v[120:123], v3 offset:32768
    v_mfma_f32_16x16x32_bf16 v[20:23], v[128:131], a[20:23], v[20:23]
    s_add_u32 s38, s34, 8192
    buffer_load_dwordx4 a[64:67], v3, s[8:11], s38 offen offset:0 sc1
    v_mfma_f32_16x16x32_bf16 v[28:31], v[132:135], a[20:23], v[28:31]
    ds_read_b128 v[124:127], v3 offset:33792
    v_mfma_f32_16x16x32_bf16 v[24:27], v[132:135], a[16:19], v[24:27]
    s_waitcnt lgkmcnt(6)
    v_mfma_f32_16x16x32_bf16 v[32:35], v[136:139], a[16:19], v[32:35]
    ds_read_b128 v[128:131], v3 offset:34816
    v_mfma_f32_16x16x32_bf16 v[36:39], v[136:139], a[20:23], v[36:39]
    s_add_u32 s39, s34, 28672
    buffer_load_dwordx4 a[68:71], v3, s[8:11], s39 offen offset:0 sc1
    v_mfma_f32_16x16x32_bf16 v[44:47], v[140:143], a[20:23], v[44:47]
    ds_read_b128 v[132:135], v3 offset:35840
    v_mfma_f32_16x16x32_bf16 v[40:43], v[140:143], a[16:19], v[40:43]
    s_waitcnt lgkmcnt(6)
    v_mfma_f32_16x16x32_bf16 v[48:51], v[144:147], a[16:19], v[48:51]
    ds_read_b128 v[136:139], v3 offset:36864
    v_mfma_f32_16x16x32_bf16 v[52:55], v[144:147], a[20:23], v[52:55]
    buffer_load_dwordx4 a[72:75], v3, s[8:11], s38 offen offset:1024 sc1
    v_mfma_f32_16x16x32_bf16 v[60:63], v[148:151], a[20:23], v[60:63]
    ds_read_b128 v[140:143], v3 offset:37888
    v_mfma_f32_16x16x32_bf16 v[56:59], v[148:151], a[16:19], v[56:59]
    s_waitcnt lgkmcnt(6)
    v_mfma_f32_16x16x32_bf16 v[64:67], v[112:115], a[16:19], v[64:67]
    ds_read_b128 v[144:147], v3 offset:38912
    v_mfma_f32_16x16x32_bf16 v[68:71], v[112:115], a[20:23], v[68:71]
    buffer_load_dwordx4 a[76:79], v3, s[8:11], s39 offen offset:1024 sc1
    v_mfma_f32_16x16x32_bf16 v[76:79], v[116:119], a[20:23], v[76:79]
    ds_read_b128 v[148:151], v3 offset:39936
    v_mfma_f32_16x16x32_bf16 v[72:75], v[116:119], a[16:19], v[72:75]
    s_waitcnt lgkmcnt(6)
    v_mfma_f32_16x16x32_bf16 v[80:83], v[120:123], a[16:19], v[80:83]
    ds_read_b128 v[112:115], v3 offset:40960
    v_mfma_f32_16x16x32_bf16 v[84:87], v[120:123], a[20:23], v[84:87]
    buffer_load_dwordx2 v[160:161], v15, s[8:11], s43 offen offset:0 sc1
    v_mfma_f32_16x16x32_bf16 v[92:95], v[124:127], a[20:23], v[92:95]
    ds_read_b128 v[116:119], v3 offset:41984
    v_mfma_f32_16x16x32_bf16 v[88:91], v[124:127], a[16:19], v[88:91]
    s_waitcnt lgkmcnt(6)
    v_mfma_f32_16x16x32_bf16 v[96:99], v[128:131], a[16:19], v[96:99]
    ds_read_b128 v[120:123], v3 offset:43008
    v_mfma_f32_16x16x32_bf16 v[100:103], v[128:131], a[20:23], v[100:103]
    buffer_load_dwordx2 v[162:163], v15, s[8:11], s43 offen offset:512 sc1
    v_mfma_f32_16x16x32_bf16 v[108:111], v[132:135], a[20:23], v[108:111]
    ds_read_b128 v[124:127], v3 offset:44032
    v_mfma_f32_16x16x32_bf16 v[104:107], v[132:135], a[16:19], v[104:107]
    s_waitcnt vmcnt(14)
    s_waitcnt lgkmcnt(6)
    v_mfma_f32_16x16x32_bf16 v[16:19], v[136:139], a[24:27], v[16:19]
    ds_read_b128 v[128:131], v3 offset:45056
    v_mfma_f32_16x16x32_bf16 v[20:23], v[136:139], a[28:31], v[20:23]
    buffer_load_dwordx2 v[164:165], v15, s[8:11], s43 offen offset:1024 sc1
    v_mfma_f32_16x16x32_bf16 v[28:31], v[140:143], a[28:31], v[28:31]
    ds_read_b128 v[132:135], v3 offset:46080
    v_mfma_f32_16x16x32_bf16 v[24:27], v[140:143], a[24:27], v[24:27]
    s_waitcnt lgkmcnt(6)
    v_mfma_f32_16x16x32_bf16 v[32:35], v[144:147], a[24:27], v[32:35]
    ds_read_b128 v[136:139], v3 offset:47104
    v_mfma_f32_16x16x32_bf16 v[36:39], v[144:147], a[28:31], v[36:39]
    buffer_load_dwordx2 v[166:167], v15, s[8:11], s43 offen offset:1536 sc1
    v_mfma_f32_16x16x32_bf16 v[44:47], v[148:151], a[28:31], v[44:47]
    ds_read_b128 v[140:143], v3 offset:48128
    v_mfma_f32_16x16x32_bf16 v[40:43], v[148:151], a[24:27], v[40:43]
    s_waitcnt vmcnt(50)
    s_barrier
    s_waitcnt lgkmcnt(6)
    v_mfma_f32_16x16x32_bf16 v[48:51], v[112:115], a[24:27], v[48:51]
    ds_read_b128 v[144:147], v5 offset:0
    v_mfma_f32_16x16x32_bf16 v[52:55], v[112:115], a[28:31], v[52:55]
    buffer_load_dwordx2 v[168:169], v15, s[8:11], s43 offen offset:2048 sc1
    v_mfma_f32_16x16x32_bf16 v[60:63], v[116:119], a[28:31], v[60:63]
    ds_read_b128 v[148:151], v5 offset:1024
    v_mfma_f32_16x16x32_bf16 v[56:59], v[116:119], a[24:27], v[56:59]
    s_waitcnt lgkmcnt(6)
    v_mfma_f32_16x16x32_bf16 v[64:67], v[120:123], a[24:27], v[64:67]
    ds_read_b128 v[112:115], v5 offset:2048
    v_mfma_f32_16x16x32_bf16 v[68:71], v[120:123], a[28:31], v[68:71]
    buffer_load_dwordx2 v[170:171], v15, s[8:11], s43 offen offset:2560 sc1
    v_mfma_f32_16x16x32_bf16 v[76:79], v[124:127], a[28:31], v[76:79]
    ds_read_b128 v[116:119], v5 offset:3072
    v_mfma_f32_16x16x32_bf16 v[72:75], v[124:127], a[24:27], v[72:75]
    s_waitcnt lgkmcnt(6)
    v_mfma_f32_16x16x32_bf16 v[80:83], v[128:131], a[24:27], v[80:83]
    ds_read_b128 v[120:123], v5 offset:4096
    v_mfma_f32_16x16x32_bf16 v[84:87], v[128:131], a[28:31], v[84:87]
    buffer_load_dwordx2 v[172:173], v15, s[8:11], s43 offen offset:3072 sc1
    v_mfma_f32_16x16x32_bf16 v[92:95], v[132:135], a[28:31], v[92:95]
    ds_read_b128 v[124:127], v5 offset:5120
    v_mfma_f32_16x16x32_bf16 v[88:91], v[132:135], a[24:27], v[88:91]
    s_waitcnt lgkmcnt(6)
    v_mfma_f32_16x16x32_bf16 v[96:99], v[136:139], a[24:27], v[96:99]
    ds_read_b128 v[128:131], v5 offset:6144
    v_mfma_f32_16x16x32_bf16 v[100:103], v[136:139], a[28:31], v[100:103]
    buffer_load_dwordx2 v[174:175], v15, s[8:11], s43 offen offset:3584 sc1
    v_mfma_f32_16x16x32_bf16 v[108:111], v[140:143], a[28:31], v[108:111]
    ds_read_b128 v[132:135], v5 offset:7168
    v_mfma_f32_16x16x32_bf16 v[104:107], v[140:143], a[24:27], v[104:107]
    s_waitcnt vmcnt(18)
    s_waitcnt lgkmcnt(6)
    v_mfma_f32_16x16x32_bf16 v[16:19], v[144:147], a[32:35], v[16:19]
    ds_read_b128 v[136:139], v5 offset:8192
    v_mfma_f32_16x16x32_bf16 v[20:23], v[144:147], a[36:39], v[20:23]
    buffer_load_dwordx4 a[80:83], v3, s[8:11], s38 offen offset:2048 sc1
    v_mfma_f32_16x16x32_bf16 v[28:31], v[148:151], a[36:39], v[28:31]
    ds_read_b128 v[140:143], v5 offset:9216
    v_mfma_f32_16x16x32_bf16 v[24:27], v[148:151], a[32:35], v[24:27]
    s_waitcnt lgkmcnt(6)
    v_mfma_f32_16x16x32_bf16 v[32:35], v[112:115], a[32:35], v[32:35]
    ds_read_b128 v[144:147], v5 offset:10240
    v_mfma_f32_16x16x32_bf16 v[36:39], v[112:115], a[36:39], v[36:39]
    buffer_load_dwordx4 a[84:87], v3, s[8:11], s39 offen offset:2048 sc1
    v_mfma_f32_16x16x32_bf16 v[44:47], v[116:119], a[36:39], v[44:47]
    ds_read_b128 v[148:151], v5 offset:11264
    v_mfma_f32_16x16x32_bf16 v[40:43], v[116:119], a[32:35], v[40:43]
    s_waitcnt lgkmcnt(6)
    v_mfma_f32_16x16x32_bf16 v[48:51], v[120:123], a[32:35], v[48:51]
    ds_read_b128 v[112:115], v5 offset:12288
    v_mfma_f32_16x16x32_bf16 v[52:55], v[120:123], a[36:39], v[52:55]
    buffer_load_dwordx4 a[88:91], v3, s[8:11], s38 offen offset:3072 sc1
    v_mfma_f32_16x16x32_bf16 v[60:63], v[124:127], a[36:39], v[60:63]
    ds_read_b128 v[116:119], v5 offset:13312
    v_mfma_f32_16x16x32_bf16 v[56:59], v[124:127], a[32:35], v[56:59]
    s_waitcnt lgkmcnt(6)
    v_mfma_f32_16x16x32_bf16 v[64:67], v[128:131], a[32:35], v[64:67]
    ds_read_b128 v[120:123], v5 offset:14336
    v_mfma_f32_16x16x32_bf16 v[68:71], v[128:131], a[36:39], v[68:71]
    buffer_load_dwordx4 a[92:95], v3, s[8:11], s39 offen offset:3072 sc1
    v_mfma_f32_16x16x32_bf16 v[76:79], v[132:135], a[36:39], v[76:79]
    ds_read_b128 v[124:127], v5 offset:15360
    v_mfma_f32_16x16x32_bf16 v[72:75], v[132:135], a[32:35], v[72:75]
    s_waitcnt lgkmcnt(6)
    v_mfma_f32_16x16x32_bf16 v[80:83], v[136:139], a[32:35], v[80:83]
    ds_read_b128 v[128:131], v5 offset:16384
    v_mfma_f32_16x16x32_bf16 v[84:87], v[136:139], a[36:39], v[84:87]
    s_add_u32 s38, s34, 12288
    buffer_load_dwordx4 a[96:99], v3, s[8:11], s38 offen offset:0 sc1
    v_mfma_f32_16x16x32_bf16 v[92:95], v[140:143], a[36:39], v[92:95]
    ds_read_b128 v[132:135], v5 offset:17408
    v_mfma_f32_16x16x32_bf16 v[88:91], v[140:143], a[32:35], v[88:91]
    s_waitcnt lgkmcnt(6)
    v_mfma_f32_16x16x32_bf16 v[96:99], v[144:147], a[32:35], v[96:99]
    ds_read_b128 v[136:139], v5 offset:18432
    v_mfma_f32_16x16x32_bf16 v[100:103], v[144:147], a[36:39], v[100:103]
    s_add_u32 s39, s34, 32768
    buffer_load_dwordx4 a[100:103], v3, s[8:11], s39 offen offset:0 sc1
    v_mfma_f32_16x16x32_bf16 v[108:111], v[148:151], a[36:39], v[108:111]
    ds_read_b128 v[140:143], v5 offset:19456
    v_mfma_f32_16x16x32_bf16 v[104:107], v[148:151], a[32:35], v[104:107]
    s_waitcnt vmcnt(22)
    s_waitcnt lgkmcnt(6)
    v_mfma_f32_16x16x32_bf16 v[16:19], v[112:115], a[40:43], v[16:19]
    ds_read_b128 v[144:147], v5 offset:20480
    v_mfma_f32_16x16x32_bf16 v[20:23], v[112:115], a[44:47], v[20:23]
    buffer_load_dwordx4 a[104:107], v3, s[8:11], s38 offen offset:1024 sc1
    v_mfma_f32_16x16x32_bf16 v[28:31], v[116:119], a[44:47], v[28:31]
    ds_read_b128 v[148:151], v5 offset:21504
    v_mfma_f32_16x16x32_bf16 v[24:27], v[116:119], a[40:43], v[24:27]
    s_waitcnt lgkmcnt(6)
    v_mfma_f32_16x16x32_bf16 v[32:35], v[120:123], a[40:43], v[32:35]
    ds_read_b128 v[112:115], v5 offset:22528
    v_mfma_f32_16x16x32_bf16 v[36:39], v[120:123], a[44:47], v[36:39]
    buffer_load_dwordx4 a[108:111], v3, s[8:11], s39 offen offset:1024 sc1
    v_mfma_f32_16x16x32_bf16 v[44:47], v[124:127], a[44:47], v[44:47]
    ds_read_b128 v[116:119], v5 offset:23552
    v_mfma_f32_16x16x32_bf16 v[40:43], v[124:127], a[40:43], v[40:43]
    s_waitcnt vmcnt(56)
    s_barrier
    s_waitcnt lgkmcnt(6)
    v_mfma_f32_16x16x32_bf16 v[48:51], v[128:131], a[40:43], v[48:51]
    ds_read_b128 v[120:123], v5 offset:24576
    v_mfma_f32_16x16x32_bf16 v[52:55], v[128:131], a[44:47], v[52:55]
    buffer_load_dwordx4 a[112:115], v3, s[8:11], s38 offen offset:2048 sc1
    v_mfma_f32_16x16x32_bf16 v[60:63], v[132:135], a[44:47], v[60:63]
    ds_read_b128 v[124:127], v5 offset:25600
    v_mfma_f32_16x16x32_bf16 v[56:59], v[132:135], a[40:43], v[56:59]
    s_waitcnt lgkmcnt(6)
    v_mfma_f32_16x16x32_bf16 v[64:67], v[136:139], a[40:43], v[64:67]
    ds_read_b128 v[128:131], v5 offset:26624
    v_mfma_f32_16x16x32_bf16 v[68:71], v[136:139], a[44:47], v[68:71]
    buffer_load_dwordx4 a[116:119], v3, s[8:11], s39 offen offset:2048 sc1
    v_mfma_f32_16x16x32_bf16 v[76:79], v[140:143], a[44:47], v[76:79]
    ds_read_b128 v[132:135], v5 offset:27648
    v_mfma_f32_16x16x32_bf16 v[72:75], v[140:143], a[40:43], v[72:75]
    s_waitcnt lgkmcnt(6)
    v_mfma_f32_16x16x32_bf16 v[80:83], v[144:147], a[40:43], v[80:83]
    ds_read_b128 v[136:139], v5 offset:28672
    v_mfma_f32_16x16x32_bf16 v[84:87], v[144:147], a[44:47], v[84:87]
    buffer_load_dwordx4 a[120:123], v3, s[8:11], s38 offen offset:3072 sc1
    v_mfma_f32_16x16x32_bf16 v[92:95], v[148:151], a[44:47], v[92:95]
    ds_read_b128 v[140:143], v5 offset:29696
    v_mfma_f32_16x16x32_bf16 v[88:91], v[148:151], a[40:43], v[88:91]
    s_waitcnt lgkmcnt(6)
    v_mfma_f32_16x16x32_bf16 v[96:99], v[112:115], a[40:43], v[96:99]
    ds_read_b128 v[144:147], v5 offset:30720
    v_mfma_f32_16x16x32_bf16 v[100:103], v[112:115], a[44:47], v[100:103]
    buffer_load_dwordx4 a[124:127], v3, s[8:11], s39 offen offset:3072 sc1
    v_mfma_f32_16x16x32_bf16 v[108:111], v[116:119], a[44:47], v[108:111]
    ds_read_b128 v[148:151], v5 offset:31744
    v_mfma_f32_16x16x32_bf16 v[104:107], v[116:119], a[40:43], v[104:107]
    s_waitcnt vmcnt(26)
    s_waitcnt lgkmcnt(6)
    v_mfma_f32_16x16x32_bf16 v[16:19], v[120:123], a[48:51], v[16:19]
    ds_read_b128 v[112:115], v5 offset:32768
    v_mfma_f32_16x16x32_bf16 v[20:23], v[120:123], a[52:55], v[20:23]
    s_add_u32 s38, s34, 16384
    buffer_load_dwordx4 a[128:131], v3, s[8:11], s38 offen offset:0 sc1
    v_mfma_f32_16x16x32_bf16 v[28:31], v[124:127], a[52:55], v[28:31]
    ds_read_b128 v[116:119], v5 offset:33792
    v_mfma_f32_16x16x32_bf16 v[24:27], v[124:127], a[48:51], v[24:27]
    s_waitcnt lgkmcnt(6)
    v_mfma_f32_16x16x32_bf16 v[32:35], v[128:131], a[48:51], v[32:35]
    ds_read_b128 v[120:123], v5 offset:34816
    v_mfma_f32_16x16x32_bf16 v[36:39], v[128:131], a[52:55], v[36:39]
    s_add_u32 s39, s34, 36864
    buffer_load_dwordx4 a[132:135], v3, s[8:11], s39 offen offset:0 sc1
    v_mfma_f32_16x16x32_bf16 v[44:47], v[132:135], a[52:55], v[44:47]
    ds_read_b128 v[124:127], v5 offset:35840
    v_mfma_f32_16x16x32_bf16 v[40:43], v[132:135], a[48:51], v[40:43]
    s_waitcnt vmcnt(14)
    s_waitcnt lgkmcnt(6)
    v_mfma_f32_16x16x32_bf16 v[48:51], v[136:139], a[48:51], v[48:51]
    ds_read_b128 v[128:131], v5 offset:36864
    v_add_f32 v160, v160, v162
    v_mfma_f32_16x16x32_bf16 v[52:55], v[136:139], a[52:55], v[52:55]
    buffer_load_dwordx4 a[136:139], v3, s[8:11], s38 offen offset:1024 sc1
    v_add_f32 v161, v161, v163
    v_add_f32 v164, v164, v166
    v_mfma_f32_16x16x32_bf16 v[60:63], v[140:143], a[52:55], v[60:63]
    ds_read_b128 v[132:135], v5 offset:37888
    v_add_f32 v165, v165, v167
    v_mfma_f32_16x16x32_bf16 v[56:59], v[140:143], a[48:51], v[56:59]
    v_add_f32 v160, v160, v164
    v_add_f32 v161, v161, v165
    s_waitcnt lgkmcnt(6)
    v_mfma_f32_16x16x32_bf16 v[64:67], v[144:147], a[48:51], v[64:67]
    ds_read_b128 v[136:139], v5 offset:38912
    v_add_f32 v168, v168, v170
    v_mfma_f32_16x16x32_bf16 v[68:71], v[144:147], a[52:55], v[68:71]
    buffer_load_dwordx4 a[140:143], v3, s[8:11], s39 offen offset:1024 sc1
    v_add_f32 v169, v169, v171
    v_add_f32 v172, v172, v174
    v_mfma_f32_16x16x32_bf16 v[76:79], v[148:151], a[52:55], v[76:79]
    ds_read_b128 v[140:143], v5 offset:39936
    v_add_f32 v173, v173, v175
    v_mfma_f32_16x16x32_bf16 v[72:75], v[148:151], a[48:51], v[72:75]
    v_add_f32 v168, v168, v172
    v_add_f32 v169, v169, v173
    s_waitcnt lgkmcnt(6)
    v_mfma_f32_16x16x32_bf16 v[80:83], v[112:115], a[48:51], v[80:83]
    ds_read_b128 v[144:147], v5 offset:40960
    v_mov_b32 v176, v160
    v_mfma_f32_16x16x32_bf16 v[84:87], v[112:115], a[52:55], v[84:87]
    buffer_load_dwordx4 a[144:147], v3, s[8:11], s38 offen offset:2048 sc1
    v_mov_b32 v177, v161
    v_mov_b32 v178, v168
    v_mfma_f32_16x16x32_bf16 v[92:95], v[116:119], a[52:55], v[92:95]
    ds_read_b128 v[148:151], v5 offset:41984
    v_mov_b32 v179, v169
    v_mfma_f32_16x16x32_bf16 v[88:91], v[116:119], a[48:51], v[88:91]
    v_permlane16_swap_b32 v160, v176
    v_permlane16_swap_b32 v161, v177
    s_waitcnt lgkmcnt(6)
    v_mfma_f32_16x16x32_bf16 v[96:99], v[120:123], a[48:51], v[96:99]
    ds_read_b128 v[112:115], v5 offset:43008
    v_permlane16_swap_b32 v168, v178
    v_mfma_f32_16x16x32_bf16 v[100:103], v[120:123], a[52:55], v[100:103]
    buffer_load_dwordx4 a[148:151], v3, s[8:11], s39 offen offset:2048 sc1
    v_permlane16_swap_b32 v169, v179
    v_add_f32 v160, v160, v176
    v_mfma_f32_16x16x32_bf16 v[108:111], v[124:127], a[52:55], v[108:111]
    ds_read_b128 v[116:119], v5 offset:44032
    v_add_f32 v161, v161, v177
    v_mfma_f32_16x16x32_bf16 v[104:107], v[124:127], a[48:51], v[104:107]
    v_add_f32 v168, v168, v178
    v_add_f32 v169, v169, v179
    s_waitcnt vmcnt(30)
    s_waitcnt lgkmcnt(6)
    v_mfma_f32_16x16x32_bf16 v[16:19], v[128:131], a[56:59], v[16:19]
    ds_read_b128 v[120:123], v5 offset:45056
    v_mov_b32 v176, v160
    v_mfma_f32_16x16x32_bf16 v[20:23], v[128:131], a[60:63], v[20:23]
    buffer_load_dwordx4 a[152:155], v3, s[8:11], s38 offen offset:3072 sc1
    v_mov_b32 v177, v161
    v_mov_b32 v178, v168
    v_mfma_f32_16x16x32_bf16 v[28:31], v[132:135], a[60:63], v[28:31]
    ds_read_b128 v[124:127], v5 offset:46080
    v_mov_b32 v179, v169
    v_mfma_f32_16x16x32_bf16 v[24:27], v[132:135], a[56:59], v[24:27]
    v_permlane32_swap_b32 v160, v176
    v_permlane32_swap_b32 v161, v177
    s_waitcnt lgkmcnt(6)
    v_mfma_f32_16x16x32_bf16 v[32:35], v[136:139], a[56:59], v[32:35]
    ds_read_b128 v[128:131], v5 offset:47104
    v_permlane32_swap_b32 v168, v178
    v_mfma_f32_16x16x32_bf16 v[36:39], v[136:139], a[60:63], v[36:39]
    buffer_load_dwordx4 a[156:159], v3, s[8:11], s39 offen offset:3072 sc1
    v_permlane32_swap_b32 v169, v179
    v_add_f32 v160, v160, v176
    v_mfma_f32_16x16x32_bf16 v[44:47], v[140:143], a[60:63], v[44:47]
    ds_read_b128 v[132:135], v5 offset:48128
    v_add_f32 v161, v161, v177
    v_mfma_f32_16x16x32_bf16 v[40:43], v[140:143], a[56:59], v[40:43]
    v_add_f32 v168, v168, v178
    v_add_f32 v169, v169, v179
    s_waitcnt vmcnt(62)
    s_barrier
    s_waitcnt lgkmcnt(6)
    v_mfma_f32_16x16x32_bf16 v[48:51], v[144:147], a[56:59], v[48:51]
    ds_read_b128 v[136:139], v6 offset:0
    v_mul_f32 v160, 0x3acccccd, v160
    v_mfma_f32_16x16x32_bf16 v[52:55], v[144:147], a[60:63], v[52:55]
    v_mul_f32 v161, 0x3acccccd, v161
    v_mul_f32 v168, 0x3acccccd, v168
    v_mfma_f32_16x16x32_bf16 v[60:63], v[148:151], a[60:63], v[60:63]
    ds_read_b128 v[140:143], v6 offset:1024
    v_mul_f32 v169, 0x3acccccd, v169
    v_mfma_f32_16x16x32_bf16 v[56:59], v[148:151], a[56:59], v[56:59]
    v_fma_f32 v161, -v160, v160, v161
    v_fma_f32 v169, -v168, v168, v169
    s_waitcnt lgkmcnt(6)
    v_mfma_f32_16x16x32_bf16 v[64:67], v[112:115], a[56:59], v[64:67]
    ds_read_b128 v[144:147], v6 offset:2048
    v_max_f32 v161, 0, v161
    v_mfma_f32_16x16x32_bf16 v[68:71], v[112:115], a[60:63], v[68:71]
    v_max_f32 v169, 0, v169
    v_cvt_pk_bf16_f32 v161, v161, v161
    v_mfma_f32_16x16x32_bf16 v[76:79], v[116:119], a[60:63], v[76:79]
    ds_read_b128 v[148:151], v6 offset:3072
    v_lshlrev_b32 v161, 16, v161
    v_mfma_f32_16x16x32_bf16 v[72:75], v[116:119], a[56:59], v[72:75]
    v_cvt_pk_bf16_f32 v169, v169, v169
    v_lshlrev_b32 v169, 16, v169
    s_waitcnt lgkmcnt(6)
    v_mfma_f32_16x16x32_bf16 v[80:83], v[120:123], a[56:59], v[80:83]
    ds_read_b128 v[112:115], v6 offset:4096
    v_add_f32 v161, 0x3727c5ac, v161
    v_mfma_f32_16x16x32_bf16 v[84:87], v[120:123], a[60:63], v[84:87]
    v_add_f32 v169, 0x3727c5ac, v169
    v_cvt_pk_bf16_f32 v161, v161, v161
    v_mfma_f32_16x16x32_bf16 v[92:95], v[124:127], a[60:63], v[92:95]
    ds_read_b128 v[116:119], v6 offset:5120
    v_lshlrev_b32 v161, 16, v161
    v_mfma_f32_16x16x32_bf16 v[88:91], v[124:127], a[56:59], v[88:91]
    v_cvt_pk_bf16_f32 v169, v169, v169
    v_lshlrev_b32 v169, 16, v169
    s_waitcnt lgkmcnt(6)
    v_mfma_f32_16x16x32_bf16 v[96:99], v[128:131], a[56:59], v[96:99]
    ds_read_b128 v[120:123], v6 offset:6144
    v_sqrt_f32 v161, v161
    v_mfma_f32_16x16x32_bf16 v[100:103], v[128:131], a[60:63], v[100:103]
    v_sqrt_f32 v169, v169
    v_cvt_pk_bf16_f32 v161, v161, v161
    v_mfma_f32_16x16x32_bf16 v[108:111], v[132:135], a[60:63], v[108:111]
    ds_read_b128 v[124:127], v6 offset:7168
    v_lshlrev_b32 v161, 16, v161
    v_mfma_f32_16x16x32_bf16 v[104:107], v[132:135], a[56:59], v[104:107]
    v_cvt_pk_bf16_f32 v169, v169, v169
    v_lshlrev_b32 v169, 16, v169
    s_waitcnt vmcnt(30)
    s_waitcnt lgkmcnt(6)
    v_mfma_f32_16x16x32_bf16 v[16:19], v[136:139], a[64:67], v[16:19]
    ds_read_b128 v[128:131], v6 offset:8192
    v_cvt_pk_bf16_f32 v162, -v160, -v160
    v_mfma_f32_16x16x32_bf16 v[20:23], v[136:139], a[68:71], v[20:23]
    v_rcp_f32 v160, v161
    v_cndmask_b32 v164, 0, v162, s[46:47]
    v_mfma_f32_16x16x32_bf16 v[28:31], v[140:143], a[68:71], v[28:31]
    ds_read_b128 v[132:135], v6 offset:9216
    v_mov_b32 v165, 0
    v_mfma_f32_16x16x32_bf16 v[24:27], v[140:143], a[64:67], v[24:27]
    v_mov_b32 v166, 0
    v_mov_b32 v167, 0
    s_waitcnt vmcnt(28)
    s_waitcnt lgkmcnt(6)
    v_mfma_f32_16x16x32_bf16 v[16:19], v[144:147], a[72:75], v[16:19]
    ds_read_b128 v[136:139], v6 offset:10240
    v_mul_f32 v160, 0xbfb8aa3b, v160
    v_mfma_f32_16x16x32_bf16 v[20:23], v[144:147], a[76:79], v[20:23]
    s_add_u32 s27, s25, 147456
    s_add_u32 m0, s26, 0
    s_nop 0
    buffer_load_dwordx4 v3, s[8:11], s27 offen offset:0 sc1 lds
    v_cvt_pk_bf16_f32 v170, -v168, -v168
    v_rcp_f32 v168, v169
    v_mfma_f32_16x16x32_bf16 v[28:31], v[148:151], a[76:79], v[28:31]
    ds_read_b128 v[140:143], v6 offset:11264
    v_cndmask_b32 v172, 0, v170, s[46:47]
    v_mfma_f32_16x16x32_bf16 v[24:27], v[148:151], a[72:75], v[24:27]
    buffer_load_dwordx4 v3, s[8:11], s27 offen offset:1024 sc1 lds
    v_mov_b32 v173, 0
    v_mov_b32 v174, 0
    s_waitcnt vmcnt(20)
    s_waitcnt lgkmcnt(6)
    v_mfma_f32_16x16x32_bf16 v[16:19], v[112:115], a[80:83], v[16:19]
    ds_read_b128 v[144:147], v6 offset:12288
    v_mov_b32 v175, 0
    v_mfma_f32_16x16x32_bf16 v[20:23], v[112:115], a[84:87], v[20:23]
    buffer_load_dwordx4 v3, s[8:11], s27 offen offset:2048 sc1 lds
    v_mul_f32 v168, 0xbfb8aa3b, v168
    v_mfma_f32_16x16x32_bf16 v[28:31], v[116:119], a[84:87], v[28:31]
    ds_read_b128 v[148:151], v6 offset:13312
    v_mfma_f32_16x16x32_bf16 v[24:27], v[116:119], a[80:83], v[24:27]
    buffer_load_dwordx4 v3, s[8:11], s27 offen offset:3072 sc1 lds
    s_waitcnt vmcnt(20)
    s_waitcnt lgkmcnt(6)
    v_mfma_f32_16x16x32_bf16 v[16:19], v[120:123], a[88:91], v[16:19]
    ds_read_b128 v[112:115], v6 offset:14336
    v_mfma_f32_16x16x32_bf16 v[20:23], v[120:123], a[92:95], v[20:23]
    s_add_u32 s27, s27, 4096
    s_add_u32 m0, s26, 4096
    s_nop 0
    buffer_load_dwordx4 v3, s[8:11], s27 offen offset:0 sc1 lds
    v_mfma_f32_16x16x32_bf16 v[28:31], v[124:127], a[92:95], v[28:31]
    ds_read_b128 v[116:119], v6 offset:15360
    v_mfma_f32_16x16x32_bf16 v[24:27], v[124:127], a[88:91], v[24:27]
    buffer_load_dwordx4 v3, s[8:11], s27 offen offset:1024 sc1 lds
    s_waitcnt vmcnt(20)
    s_waitcnt lgkmcnt(6)
    v_mfma_f32_16x16x32_bf16 v[16:19], v[128:131], a[96:99], v[16:19]
    ds_read_b128 v[120:123], v6 offset:16384
    v_mfma_f32_16x16x32_bf16 v[20:23], v[128:131], a[100:103], v[20:23]
    buffer_load_dwordx4 a[192:195], v3, s[8:11], s30 offen offset:3072 sc1
    v_mfma_f32_16x16x32_bf16 v[28:31], v[132:135], a[100:103], v[28:31]
    ds_read_b128 v[124:127], v6 offset:17408
    v_mfma_f32_16x16x32_bf16 v[24:27], v[132:135], a[96:99], v[24:27]
    s_add_u32 s30, s31, 19456
    buffer_load_dwordx4 a[196:199], v3, s[8:11], s30 offen offset:0 sc1
    s_waitcnt vmcnt(20)
    s_waitcnt lgkmcnt(6)
    v_mfma_f32_16x16x32_bf16 v[16:19], v[136:139], a[104:107], v[16:19]
    ds_read_b128 v[128:131], v6 offset:18432
    v_mfma_f32_16x16x32_bf16 v[20:23], v[136:139], a[108:111], v[20:23]
    s_add_u32 s30, s31, 30720
    buffer_load_dwordx4 a[200:203], v3, s[8:11], s30 offen offset:0 sc1
    v_mfma_f32_16x16x32_bf16 v[28:31], v[140:143], a[108:111], v[28:31]
    ds_read_b128 v[132:135], v6 offset:19456
    v_mfma_f32_16x16x32_bf16 v[24:27], v[140:143], a[104:107], v[24:27]
    buffer_load_dwordx4 a[204:207], v3, s[8:11], s30 offen offset:1024 sc1
    s_waitcnt vmcnt(20)
    s_waitcnt lgkmcnt(6)
    v_mfma_f32_16x16x32_bf16 v[16:19], v[144:147], a[112:115], v[16:19]
    ds_read_b128 v[136:139], v6 offset:20480
    v_mfma_f32_16x16x32_bf16 v[20:23], v[144:147], a[116:119], v[20:23]
    buffer_load_dwordx4 a[208:211], v3, s[8:11], s30 offen offset:2048 sc1
    v_mfma_f32_16x16x32_bf16 v[28:31], v[148:151], a[116:119], v[28:31]
    ds_read_b128 v[140:143], v6 offset:21504
    v_mfma_f32_16x16x32_bf16 v[24:27], v[148:151], a[112:115], v[24:27]
    buffer_load_dwordx4 a[212:215], v3, s[8:11], s30 offen offset:3072 sc1
    s_waitcnt vmcnt(20)
    s_waitcnt lgkmcnt(6)
    v_mfma_f32_16x16x32_bf16 v[16:19], v[112:115], a[120:123], v[16:19]
    ds_read_b128 v[144:147], v6 offset:22528
    v_mfma_f32_16x16x32_bf16 v[20:23], v[112:115], a[124:127], v[20:23]
    s_add_u32 s30, s31, 34816
    buffer_load_dwordx4 a[216:219], v3, s[8:11], s30 offen offset:0 sc1
    v_mfma_f32_16x16x32_bf16 v[28:31], v[116:119], a[124:127], v[28:31]
    ds_read_b128 v[148:151], v6 offset:23552
    v_mfma_f32_16x16x32_bf16 v[24:27], v[116:119], a[120:123], v[24:27]
    s_add_u32 s30, s31, 46080
    buffer_load_dwordx4 a[220:223], v3, s[8:11], s30 offen offset:0 sc1
    s_waitcnt vmcnt(20)
    s_waitcnt lgkmcnt(6)
    v_mfma_f32_16x16x32_bf16 v[16:19], v[120:123], a[128:131], v[16:19]
    ds_read_b128 v[112:115], v14 offset:0
    v_mfma_f32_16x16x32_bf16 v[20:23], v[120:123], a[132:135], v[20:23]
    buffer_load_dwordx4 a[224:227], v3, s[8:11], s30 offen offset:1024 sc1
    v_mfma_f32_16x16x32_bf16 v[28:31], v[124:127], a[132:135], v[28:31]
    ds_read_b128 v[116:119], v14 offset:256
    v_mfma_f32_16x16x32_bf16 v[24:27], v[124:127], a[128:131], v[24:27]
    buffer_load_dwordx4 a[228:231], v3, s[8:11], s30 offen offset:2048 sc1
    s_waitcnt vmcnt(63)
    s_barrier
    s_waitcnt vmcnt(20)
    s_waitcnt lgkmcnt(6)
    v_mfma_f32_16x16x32_bf16 v[16:19], v[128:131], a[136:139], v[16:19]
    ds_read_b128 v[120:123], v6 offset:24576
    v_mfma_f32_16x16x32_bf16 v[20:23], v[128:131], a[140:143], v[20:23]
    buffer_load_dwordx4 a[232:235], v3, s[8:11], s30 offen offset:3072 sc1
    v_mfma_f32_16x16x32_bf16 v[28:31], v[132:135], a[140:143], v[28:31]
    ds_read_b128 v[124:127], v6 offset:25600
    v_mfma_f32_16x16x32_bf16 v[24:27], v[132:135], a[136:139], v[24:27]
    s_add_u32 s30, s31, 50176
    buffer_load_dwordx4 a[236:239], v3, s[8:11], s30 offen offset:0 sc1
    s_waitcnt vmcnt(20)
    s_waitcnt lgkmcnt(6)
    v_mfma_f32_16x16x32_bf16 v[16:19], v[136:139], a[144:147], v[16:19]
    ds_read_b128 v[128:131], v6 offset:26624
    v_mfma_f32_16x16x32_bf16 v[20:23], v[136:139], a[148:151], v[20:23]
    s_add_u32 s30, s31, 5120
    buffer_load_dwordx4 a[240:243], v3, s[8:11], s30 offen offset:0 sc1
    v_mfma_f32_16x16x32_bf16 v[28:31], v[140:143], a[148:151], v[28:31]
    ds_read_b128 v[132:135], v6 offset:27648
    v_mfma_f32_16x16x32_bf16 v[24:27], v[140:143], a[144:147], v[24:27]
    s_add_u32 s27, s25, 172032
    s_add_u32 m0, s26, 24576
    s_nop 0
    buffer_load_dwordx4 v3, s[8:11], s27 offen offset:0 sc1 lds
    s_waitcnt vmcnt(20)
    s_waitcnt lgkmcnt(6)
    v_mfma_f32_16x16x32_bf16 v[16:19], v[144:147], a[152:155], v[16:19]
    ds_read_b128 v[136:139], v6 offset:28672
    v_mfma_f32_16x16x32_bf16 v[20:23], v[144:147], a[156:159], v[20:23]
    buffer_load_dwordx4 v3, s[8:11], s27 offen offset:1024 sc1 lds
    v_mfma_f32_16x16x32_bf16 v[28:31], v[148:151], a[156:159], v[28:31]
    ds_read_b128 v[140:143], v6 offset:29696
    v_mfma_f32_16x16x32_bf16 v[24:27], v[148:151], a[152:155], v[24:27]
    buffer_load_dwordx4 v3, s[8:11], s27 offen offset:2048 sc1 lds
    s_waitcnt lgkmcnt(6)
    v_mfma_f32_16x16x32_bf16 v[16:19], v[112:115], v[164:167], v[16:19]
    ds_read_b128 v[144:147], v6 offset:30720
    v_mfma_f32_16x16x32_bf16 v[20:23], v[112:115], v[172:175], v[20:23]
    v_mfma_f32_16x16x32_bf16 v[28:31], v[116:119], v[172:175], v[28:31]
    ds_read_b128 v[148:151], v6 offset:31744
    v_mfma_f32_16x16x32_bf16 v[24:27], v[116:119], v[164:167], v[24:27]
    s_waitcnt lgkmcnt(6)
    v_mfma_f32_16x16x32_bf16 v[32:35], v[120:123], a[64:67], v[32:35]
    ds_read_b128 v[112:115], v6 offset:32768
    v_mfma_f32_16x16x32_bf16 v[36:39], v[120:123], a[68:71], v[36:39]
    buffer_load_dwordx4 v3, s[8:11], s27 offen offset:3072 sc1 lds
    v_mfma_f32_16x16x32_bf16 v[44:47], v[124:127], a[68:71], v[44:47]
    ds_read_b128 v[116:119], v6 offset:33792
    v_mfma_f32_16x16x32_bf16 v[40:43], v[124:127], a[64:67], v[40:43]
    s_add_u32 s27, s27, 4096
    s_add_u32 m0, s26, 28672
    s_nop 0
    buffer_load_dwordx4 v3, s[8:11], s27 offen offset:0 sc1 lds
    s_waitcnt lgkmcnt(6)
    v_mfma_f32_16x16x32_bf16 v[32:35], v[128:131], a[72:75], v[32:35]
    ds_read_b128 v[120:123], v6 offset:34816
    v_mfma_f32_16x16x32_bf16 v[36:39], v[128:131], a[76:79], v[36:39]
    buffer_load_dwordx4 v3, s[8:11], s27 offen offset:1024 sc1 lds
    v_mul_f32 v16, v160, v16
    v_mul_f32 v17, v160, v17
    v_mfma_f32_16x16x32_bf16 v[44:47], v[132:135], a[76:79], v[44:47]
    ds_read_b128 v[124:127], v6 offset:35840
    v_mul_f32 v18, v160, v18
    v_mfma_f32_16x16x32_bf16 v[40:43], v[132:135], a[72:75], v[40:43]
    buffer_load_dwordx4 a[244:247], v3, s[8:11], s30 offen offset:1024 sc1
    v_mul_f32 v19, v160, v19
    v_exp_f32 v16, v16
    s_waitcnt lgkmcnt(6)
    v_mfma_f32_16x16x32_bf16 v[32:35], v[136:139], a[80:83], v[32:35]
    ds_read_b128 v[128:131], v6 offset:36864
    v_exp_f32 v17, v17
    v_mfma_f32_16x16x32_bf16 v[36:39], v[136:139], a[84:87], v[36:39]
    buffer_load_dwordx4 a[248:251], v3, s[8:11], s30 offen offset:2048 sc1
    v_exp_f32 v18, v18
    v_exp_f32 v19, v19
    v_mfma_f32_16x16x32_bf16 v[44:47], v[140:143], a[84:87], v[44:47]
    ds_read_b128 v[132:135], v6 offset:37888
    v_fma_f32 v16, v16, v161, v161
    v_mfma_f32_16x16x32_bf16 v[40:43], v[140:143], a[80:83], v[40:43]
    buffer_load_dwordx4 a[252:255], v3, s[8:11], s30 offen offset:3072 sc1
    v_fma_f32 v17, v17, v161, v161
    v_fma_f32 v18, v18, v161, v161
    s_waitcnt lgkmcnt(6)
    v_mfma_f32_16x16x32_bf16 v[32:35], v[144:147], a[88:91], v[32:35]
    ds_read_b128 v[136:139], v6 offset:38912
    v_fma_f32 v19, v19, v161, v161
    v_mfma_f32_16x16x32_bf16 v[36:39], v[144:147], a[92:95], v[36:39]
    s_add_u32 s30, s31, 9216
    buffer_load_dwordx4 v[196:199], v3, s[8:11], s30 offen offset:0 sc1
    v_rcp_f32 v16, v16
    v_rcp_f32 v17, v17
    v_mfma_f32_16x16x32_bf16 v[44:47], v[148:151], a[92:95], v[44:47]
    ds_read_b128 v[140:143], v6 offset:39936
    v_rcp_f32 v18, v18
    v_mfma_f32_16x16x32_bf16 v[40:43], v[148:151], a[88:91], v[40:43]
    s_add_u32 s30, s31, 20480
    buffer_load_dwordx4 v[200:203], v3, s[8:11], s30 offen offset:0 sc1
    v_rcp_f32 v19, v19
    v_mul_f32 v16, v16, v24
    s_waitcnt lgkmcnt(6)
    v_mfma_f32_16x16x32_bf16 v[32:35], v[112:115], a[96:99], v[32:35]
    ds_read_b128 v[144:147], v6 offset:40960
    v_mul_f32 v17, v17, v25
    v_mfma_f32_16x16x32_bf16 v[36:39], v[112:115], a[100:103], v[36:39]
    buffer_load_dwordx4 v[204:207], v3, s[8:11], s30 offen offset:1024 sc1
    v_mul_f32 v18, v18, v26
    v_mul_f32 v19, v19, v27
    v_mfma_f32_16x16x32_bf16 v[44:47], v[116:119], a[100:103], v[44:47]
    ds_read_b128 v[148:151], v6 offset:41984
    v_cvt_pk_bf16_f32 v152, v16, v17
    v_mfma_f32_16x16x32_bf16 v[40:43], v[116:119], a[96:99], v[40:43]
    buffer_load_dwordx4 v[208:211], v3, s[8:11], s30 offen offset:2048 sc1
    v_cvt_pk_bf16_f32 v153, v18, v19
    v_mul_f32 v20, v168, v20
    s_waitcnt lgkmcnt(6)
    v_mfma_f32_16x16x32_bf16 v[32:35], v[120:123], a[104:107], v[32:35]
    ds_read_b128 v[112:115], v6 offset:43008
    v_mul_f32 v21, v168, v21
    v_mfma_f32_16x16x32_bf16 v[36:39], v[120:123], a[108:111], v[36:39]
    buffer_load_dwordx4 v[212:215], v3, s[8:11], s30 offen offset:3072 sc1
    v_mul_f32 v22, v168, v22
    v_mul_f32 v23, v168, v23
    v_mfma_f32_16x16x32_bf16 v[44:47], v[124:127], a[108:111], v[44:47]
    ds_read_b128 v[116:119], v6 offset:44032
    v_exp_f32 v20, v20
    v_mfma_f32_16x16x32_bf16 v[40:43], v[124:127], a[104:107], v[40:43]
    s_add_u32 s30, s31, 24576
    buffer_load_dwordx4 v[216:219], v3, s[8:11], s30 offen offset:0 sc1
    v_exp_f32 v21, v21
    v_exp_f32 v22, v22
    s_waitcnt lgkmcnt(6)
    v_mfma_f32_16x16x32_bf16 v[32:35], v[128:131], a[112:115], v[32:35]
    ds_read_b128 v[120:123], v6 offset:45056
    v_exp_f32 v23, v23
    v_mfma_f32_16x16x32_bf16 v[36:39], v[128:131], a[116:119], v[36:39]
    s_add_u32 s30, s31, 35840
    buffer_load_dwordx4 v[220:223], v3, s[8:11], s30 offen offset:0 sc1
    v_fma_f32 v20, v20, v169, v169
    v_fma_f32 v21, v21, v169, v169
    v_mfma_f32_16x16x32_bf16 v[44:47], v[132:135], a[116:119], v[44:47]
    ds_read_b128 v[124:127], v6 offset:46080
    v_fma_f32 v22, v22, v169, v169
    v_mfma_f32_16x16x32_bf16 v[40:43], v[132:135], a[112:115], v[40:43]
    buffer_load_dwordx4 v[224:227], v3, s[8:11], s30 offen offset:1024 sc1
    v_fma_f32 v23, v23, v169, v169
    v_rcp_f32 v20, v20
    s_waitcnt lgkmcnt(6)
    v_mfma_f32_16x16x32_bf16 v[32:35], v[136:139], a[120:123], v[32:35]
    ds_read_b128 v[128:131], v6 offset:47104
    v_rcp_f32 v21, v21
    v_mfma_f32_16x16x32_bf16 v[36:39], v[136:139], a[124:127], v[36:39]
    buffer_load_dwordx4 v[228:231], v3, s[8:11], s30 offen offset:2048 sc1
    v_rcp_f32 v22, v22
    v_rcp_f32 v23, v23
    v_mfma_f32_16x16x32_bf16 v[44:47], v[140:143], a[124:127], v[44:47]
    ds_read_b128 v[132:135], v6 offset:48128
    v_mul_f32 v20, v20, v28
    v_mfma_f32_16x16x32_bf16 v[40:43], v[140:143], a[120:123], v[40:43]
    buffer_load_dwordx4 v[232:235], v3, s[8:11], s30 offen offset:3072 sc1
    v_mul_f32 v21, v21, v29
    v_mul_f32 v22, v22, v30
    s_waitcnt lgkmcnt(6)
    v_mfma_f32_16x16x32_bf16 v[32:35], v[144:147], a[128:131], v[32:35]
    ds_read_b128 v[136:139], v14 offset:512
    v_mul_f32 v23, v23, v31
    v_mfma_f32_16x16x32_bf16 v[36:39], v[144:147], a[132:135], v[36:39]
    s_add_u32 s30, s31, 39936
    buffer_load_dwordx4 v[236:239], v3, s[8:11], s30 offen offset:0 sc1
    v_cvt_pk_bf16_f32 v156, v20, v21
    v_cvt_pk_bf16_f32 v157, v22, v23
    v_mfma_f32_16x16x32_bf16 v[44:47], v[148:151], a[132:135], v[44:47]
    ds_read_b128 v[140:143], v14 offset:768
    v_mfma_f32_16x16x32_bf16 v[40:43], v[148:151], a[128:131], v[40:43]
    s_add_u32 s27, s25, 196608
    s_add_u32 m0, s26, 49152
    s_nop 0
    buffer_load_dwordx4 v3, s[8:11], s27 offen offset:0 sc1 lds
    s_waitcnt vmcnt(34)
    s_barrier
    s_waitcnt lgkmcnt(6)
    v_mfma_f32_16x16x32_bf16 v[32:35], v[112:115], a[136:139], v[32:35]
    ds_read_b128 v[144:147], v3 offset:0
    v_mfma_f32_16x16x32_bf16 v[36:39], v[112:115], a[140:143], v[36:39]
    buffer_load_dwordx4 v3, s[8:11], s27 offen offset:1024 sc1 lds
    v_mfma_f32_16x16x32_bf16 v[44:47], v[116:119], a[140:143], v[44:47]
    ds_read_b128 v[148:151], v3 offset:1024
    v_mfma_f32_16x16x32_bf16 v[40:43], v[116:119], a[136:139], v[40:43]
    buffer_load_dwordx4 v3, s[8:11], s27 offen offset:2048 sc1 lds
    s_waitcnt lgkmcnt(6)
    v_mfma_f32_16x16x32_bf16 v[32:35], v[120:123], a[144:147], v[32:35]
    ds_read_b128 v[112:115], v3 offset:2048
    v_mfma_f32_16x16x32_bf16 v[36:39], v[120:123], a[148:151], v[36:39]
    buffer_load_dwordx4 v3, s[8:11], s27 offen offset:3072 sc1 lds
    v_mfma_f32_16x16x32_bf16 v[44:47], v[124:127], a[148:151], v[44:47]
    ds_read_b128 v[116:119], v3 offset:3072
    v_mfma_f32_16x16x32_bf16 v[40:43], v[124:127], a[144:147], v[40:43]
    s_add_u32 s27, s27, 4096
    s_add_u32 m0, s26, 53248
    s_nop 0
    buffer_load_dwordx4 v3, s[8:11], s27 offen offset:0 sc1 lds
    s_waitcnt lgkmcnt(6)
    v_mfma_f32_16x16x32_bf16 v[32:35], v[128:131], a[152:155], v[32:35]
    ds_read_b128 v[120:123], v3 offset:4096
    v_mfma_f32_16x16x32_bf16 v[36:39], v[128:131], a[156:159], v[36:39]
    buffer_load_dwordx4 v3, s[8:11], s27 offen offset:1024 sc1 lds
    v_mfma_f32_16x16x32_bf16 v[44:47], v[132:135], a[156:159], v[44:47]
    ds_read_b128 v[124:127], v3 offset:5120
    v_mfma_f32_16x16x32_bf16 v[40:43], v[132:135], a[152:155], v[40:43]
    s_waitcnt lgkmcnt(6)
    v_mfma_f32_16x16x32_bf16 v[32:35], v[136:139], v[164:167], v[32:35]
    ds_read_b128 v[128:131], v3 offset:6144
    v_mfma_f32_16x16x32_bf16 v[36:39], v[136:139], v[172:175], v[36:39]
    v_mfma_f32_16x16x32_bf16 v[44:47], v[140:143], v[172:175], v[44:47]
    ds_read_b128 v[132:135], v3 offset:7168
    v_mfma_f32_16x16x32_bf16 v[40:43], v[140:143], v[164:167], v[40:43]
    s_waitcnt lgkmcnt(6)
    v_mfma_f32_16x16x32_bf16 v[48:51], v[144:147], a[64:67], v[48:51]
    ds_read_b128 v[136:139], v3 offset:8192
    v_mfma_f32_16x16x32_bf16 v[52:55], v[144:147], a[68:71], v[52:55]
    v_mfma_f32_16x16x32_bf16 v[60:63], v[148:151], a[68:71], v[60:63]
    ds_read_b128 v[140:143], v3 offset:9216
    v_mfma_f32_16x16x32_bf16 v[56:59], v[148:151], a[64:67], v[56:59]
    s_waitcnt lgkmcnt(6)
    v_mfma_f32_16x16x32_bf16 v[48:51], v[112:115], a[72:75], v[48:51]
    ds_read_b128 v[144:147], v3 offset:10240
    v_mfma_f32_16x16x32_bf16 v[52:55], v[112:115], a[76:79], v[52:55]
    s_add_u32 s30, s31, 51200
    buffer_load_dwordx4 a[0:3], v3, s[8:11], s30 offen offset:0 sc1
    v_mul_f32 v32, v160, v32
    v_mul_f32 v33, v160, v33
    v_mfma_f32_16x16x32_bf16 v[60:63], v[116:119], a[76:79], v[60:63]
    ds_read_b128 v[148:151], v3 offset:11264
    v_mul_f32 v34, v160, v34
    v_mfma_f32_16x16x32_bf16 v[56:59], v[116:119], a[72:75], v[56:59]
    v_mul_f32 v35, v160, v35
    v_exp_f32 v32, v32
    s_waitcnt lgkmcnt(6)
    v_mfma_f32_16x16x32_bf16 v[48:51], v[120:123], a[80:83], v[48:51]
    ds_read_b128 v[112:115], v3 offset:12288
    v_exp_f32 v33, v33
    v_mfma_f32_16x16x32_bf16 v[52:55], v[120:123], a[84:87], v[52:55]
    buffer_load_dwordx4 a[4:7], v3, s[8:11], s30 offen offset:1024 sc1
    v_exp_f32 v34, v34
    v_exp_f32 v35, v35
    v_mfma_f32_16x16x32_bf16 v[60:63], v[124:127], a[84:87], v[60:63]
    ds_read_b128 v[116:119], v3 offset:13312
    v_fma_f32 v32, v32, v161, v161
    v_mfma_f32_16x16x32_bf16 v[56:59], v[124:127], a[80:83], v[56:59]
    v_fma_f32 v33, v33, v161, v161
    v_fma_f32 v34, v34, v161, v161
    s_waitcnt lgkmcnt(6)
    v_mfma_f32_16x16x32_bf16 v[48:51], v[128:131], a[88:91], v[48:51]
    ds_read_b128 v[120:123], v3 offset:14336
    v_fma_f32 v35, v35, v161, v161
    v_mfma_f32_16x16x32_bf16 v[52:55], v[128:131], a[92:95], v[52:55]
    v_rcp_f32 v32, v32
    v_rcp_f32 v33, v33
    v_mfma_f32_16x16x32_bf16 v[60:63], v[132:135], a[92:95], v[60:63]
    ds_read_b128 v[124:127], v3 offset:15360
    v_rcp_f32 v34, v34
    v_mfma_f32_16x16x32_bf16 v[56:59], v[132:135], a[88:91], v[56:59]
    buffer_load_dwordx4 a[8:11], v3, s[8:11], s30 offen offset:2048 sc1
    v_rcp_f32 v35, v35
    v_mul_f32 v32, v32, v40
    s_waitcnt lgkmcnt(6)
    v_mfma_f32_16x16x32_bf16 v[48:51], v[136:139], a[96:99], v[48:51]
    ds_read_b128 v[128:131], v3 offset:16384
    v_mul_f32 v33, v33, v41
    v_mfma_f32_16x16x32_bf16 v[52:55], v[136:139], a[100:103], v[52:55]
    v_mul_f32 v34, v34, v42
    v_mul_f32 v35, v35, v43
    v_mfma_f32_16x16x32_bf16 v[60:63], v[140:143], a[100:103], v[60:63]
    ds_read_b128 v[132:135], v3 offset:17408
    v_cvt_pk_bf16_f32 v154, v32, v33
    v_mfma_f32_16x16x32_bf16 v[56:59], v[140:143], a[96:99], v[56:59]
    buffer_load_dwordx4 a[12:15], v3, s[8:11], s30 offen offset:3072 sc1
    v_cvt_pk_bf16_f32 v155, v34, v35
    buffer_store_dwordx4 v[152:155], v3, s[8:11], s40 offen offset:0 sc1
    s_waitcnt lgkmcnt(6)
    v_mfma_f32_16x16x32_bf16 v[48:51], v[144:147], a[104:107], v[48:51]
    ds_read_b128 v[136:139], v3 offset:18432
    v_mul_f32 v36, v168, v36
    v_mfma_f32_16x16x32_bf16 v[52:55], v[144:147], a[108:111], v[52:55]
    v_mul_f32 v37, v168, v37
    v_mul_f32 v38, v168, v38
    v_mfma_f32_16x16x32_bf16 v[60:63], v[148:151], a[108:111], v[60:63]
    ds_read_b128 v[140:143], v3 offset:19456
    v_mul_f32 v39, v168, v39
    v_mfma_f32_16x16x32_bf16 v[56:59], v[148:151], a[104:107], v[56:59]
    v_exp_f32 v36, v36
    v_exp_f32 v37, v37
    s_waitcnt lgkmcnt(6)
    v_mfma_f32_16x16x32_bf16 v[48:51], v[112:115], a[112:115], v[48:51]
    ds_read_b128 v[144:147], v3 offset:20480
    v_exp_f32 v38, v38
    v_mfma_f32_16x16x32_bf16 v[52:55], v[112:115], a[116:119], v[52:55]
    s_add_u32 s30, s31, 55296
    buffer_load_dwordx4 a[16:19], v3, s[8:11], s30 offen offset:0 sc1
    v_exp_f32 v39, v39
    v_fma_f32 v36, v36, v169, v169
    v_mfma_f32_16x16x32_bf16 v[60:63], v[116:119], a[116:119], v[60:63]
    ds_read_b128 v[148:151], v3 offset:21504
    v_fma_f32 v37, v37, v169, v169
    v_mfma_f32_16x16x32_bf16 v[56:59], v[116:119], a[112:115], v[56:59]
    v_fma_f32 v38, v38, v169, v169
    v_fma_f32 v39, v39, v169, v169
    s_waitcnt lgkmcnt(6)
    v_mfma_f32_16x16x32_bf16 v[48:51], v[120:123], a[120:123], v[48:51]
    ds_read_b128 v[112:115], v3 offset:22528
    v_rcp_f32 v36, v36
    v_mfma_f32_16x16x32_bf16 v[52:55], v[120:123], a[124:127], v[52:55]
    s_add_u32 s27, s25, 221184
    s_add_u32 m0, s26, 73728
    s_nop 0
    buffer_load_dwordx4 v3, s[8:11], s27 offen offset:0 sc1 lds
    v_rcp_f32 v37, v37
    v_rcp_f32 v38, v38
    v_mfma_f32_16x16x32_bf16 v[60:63], v[124:127], a[124:127], v[60:63]
    ds_read_b128 v[116:119], v3 offset:23552
    v_rcp_f32 v39, v39
    v_mfma_f32_16x16x32_bf16 v[56:59], v[124:127], a[120:123], v[56:59]
    v_mul_f32 v36, v36, v44
    v_mul_f32 v37, v37, v45
    s_waitcnt lgkmcnt(6)
    v_mfma_f32_16x16x32_bf16 v[48:51], v[128:131], a[128:131], v[48:51]
    ds_read_b128 v[120:123], v14 offset:1024
    v_mul_f32 v38, v38, v46
    v_mfma_f32_16x16x32_bf16 v[52:55], v[128:131], a[132:135], v[52:55]
    v_mul_f32 v39, v39, v47
    v_cvt_pk_bf16_f32 v158, v36, v37
    v_mfma_f32_16x16x32_bf16 v[60:63], v[132:135], a[132:135], v[60:63]
    ds_read_b128 v[124:127], v14 offset:1280
    v_cvt_pk_bf16_f32 v159, v38, v39
    v_mfma_f32_16x16x32_bf16 v[56:59], v[132:135], a[128:131], v[56:59]
    buffer_load_dwordx4 v3, s[8:11], s27 offen offset:1024 sc1 lds
    buffer_store_dwordx4 v[156:159], v3, s[8:11], s41 offen offset:0 sc1
    s_waitcnt vmcnt(29)
    s_barrier
    s_waitcnt lgkmcnt(6)
    v_mfma_f32_16x16x32_bf16 v[48:51], v[136:139], a[136:139], v[48:51]
    ds_read_b128 v[128:131], v3 offset:24576
    v_mfma_f32_16x16x32_bf16 v[52:55], v[136:139], a[140:143], v[52:55]
    v_mfma_f32_16x16x32_bf16 v[60:63], v[140:143], a[140:143], v[60:63]
    ds_read_b128 v[132:135], v3 offset:25600
    v_mfma_f32_16x16x32_bf16 v[56:59], v[140:143], a[136:139], v[56:59]
    buffer_load_dwordx4 v3, s[8:11], s27 offen offset:2048 sc1 lds
    s_waitcnt lgkmcnt(6)
    v_mfma_f32_16x16x32_bf16 v[48:51], v[144:147], a[144:147], v[48:51]
    ds_read_b128 v[136:139], v3 offset:26624
    v_mfma_f32_16x16x32_bf16 v[52:55], v[144:147], a[148:151], v[52:55]
    v_mfma_f32_16x16x32_bf16 v[60:63], v[148:151], a[148:151], v[60:63]
    ds_read_b128 v[140:143], v3 offset:27648
    v_mfma_f32_16x16x32_bf16 v[56:59], v[148:151], a[144:147], v[56:59]
    s_waitcnt lgkmcnt(6)
    v_mfma_f32_16x16x32_bf16 v[48:51], v[112:115], a[152:155], v[48:51]
    ds_read_b128 v[144:147], v3 offset:28672
    v_mfma_f32_16x16x32_bf16 v[52:55], v[112:115], a[156:159], v[52:55]
    buffer_load_dwordx4 v3, s[8:11], s27 offen offset:3072 sc1 lds
    v_mfma_f32_16x16x32_bf16 v[60:63], v[116:119], a[156:159], v[60:63]
    ds_read_b128 v[148:151], v3 offset:29696
    v_mfma_f32_16x16x32_bf16 v[56:59], v[116:119], a[152:155], v[56:59]
    s_waitcnt lgkmcnt(6)
    v_mfma_f32_16x16x32_bf16 v[48:51], v[120:123], v[164:167], v[48:51]
    ds_read_b128 v[112:115], v3 offset:30720
    v_mfma_f32_16x16x32_bf16 v[52:55], v[120:123], v[172:175], v[52:55]
    v_mfma_f32_16x16x32_bf16 v[60:63], v[124:127], v[172:175], v[60:63]
    ds_read_b128 v[116:119], v3 offset:31744
    v_mfma_f32_16x16x32_bf16 v[56:59], v[124:127], v[164:167], v[56:59]
    s_waitcnt lgkmcnt(6)
    v_mfma_f32_16x16x32_bf16 v[64:67], v[128:131], a[64:67], v[64:67]
    ds_read_b128 v[120:123], v3 offset:32768
    v_mfma_f32_16x16x32_bf16 v[68:71], v[128:131], a[68:71], v[68:71]
    s_add_u32 s27, s27, 4096
    s_add_u32 m0, s26, 77824
    s_nop 0
    buffer_load_dwordx4 v3, s[8:11], s27 offen offset:0 sc1 lds
    v_mfma_f32_16x16x32_bf16 v[76:79], v[132:135], a[68:71], v[76:79]
    ds_read_b128 v[124:127], v3 offset:33792
    v_mfma_f32_16x16x32_bf16 v[72:75], v[132:135], a[64:67], v[72:75]
    s_waitcnt lgkmcnt(6)
    v_mfma_f32_16x16x32_bf16 v[64:67], v[136:139], a[72:75], v[64:67]
    ds_read_b128 v[128:131], v3 offset:34816
    v_mfma_f32_16x16x32_bf16 v[68:71], v[136:139], a[76:79], v[68:71]
    v_mul_f32 v48, v160, v48
    v_mul_f32 v49, v160, v49
    v_mfma_f32_16x16x32_bf16 v[76:79], v[140:143], a[76:79], v[76:79]
    ds_read_b128 v[132:135], v3 offset:35840
    v_mul_f32 v50, v160, v50
    v_mfma_f32_16x16x32_bf16 v[72:75], v[140:143], a[72:75], v[72:75]
    buffer_load_dwordx4 v3, s[8:11], s27 offen offset:1024 sc1 lds
    v_mul_f32 v51, v160, v51
    v_exp_f32 v48, v48
    s_waitcnt lgkmcnt(6)
    v_mfma_f32_16x16x32_bf16 v[64:67], v[144:147], a[80:83], v[64:67]
    ds_read_b128 v[136:139], v3 offset:36864
    v_exp_f32 v49, v49
    v_mfma_f32_16x16x32_bf16 v[68:71], v[144:147], a[84:87], v[68:71]
    v_exp_f32 v50, v50
    v_exp_f32 v51, v51
    v_mfma_f32_16x16x32_bf16 v[76:79], v[148:151], a[84:87], v[76:79]
    ds_read_b128 v[140:143], v3 offset:37888
    v_fma_f32 v48, v48, v161, v161
    v_mfma_f32_16x16x32_bf16 v[72:75], v[148:151], a[80:83], v[72:75]
    s_add_u32 s30, s31, 10240
    s_add_u32 m0, s53, 98304
    s_nop 0
    buffer_load_dwordx4 v3, s[8:11], s30 offen sc1 lds
    v_fma_f32 v49, v49, v161, v161
    v_fma_f32 v50, v50, v161, v161
    s_waitcnt lgkmcnt(6)
    v_mfma_f32_16x16x32_bf16 v[64:67], v[112:115], a[88:91], v[64:67]
    ds_read_b128 v[144:147], v3 offset:38912
    v_fma_f32 v51, v51, v161, v161
    v_mfma_f32_16x16x32_bf16 v[68:71], v[112:115], a[92:95], v[68:71]
    v_rcp_f32 v48, v48
    v_rcp_f32 v49, v49
    v_mfma_f32_16x16x32_bf16 v[76:79], v[116:119], a[92:95], v[76:79]
    ds_read_b128 v[148:151], v3 offset:39936
    v_rcp_f32 v50, v50
    v_mfma_f32_16x16x32_bf16 v[72:75], v[116:119], a[88:91], v[72:75]
    v_rcp_f32 v51, v51
    v_mul_f32 v48, v48, v56
    s_waitcnt lgkmcnt(6)
    v_mfma_f32_16x16x32_bf16 v[64:67], v[120:123], a[96:99], v[64:67]
    ds_read_b128 v[112:115], v3 offset:40960
    v_mul_f32 v49, v49, v57
    v_mfma_f32_16x16x32_bf16 v[68:71], v[120:123], a[100:103], v[68:71]
    s_add_u32 s30, s31, 11264
    s_add_u32 m0, s53, 99328
    s_nop 0
    buffer_load_dwordx4 v3, s[8:11], s30 offen sc1 lds
    v_mul_f32 v50, v50, v58
    v_mul_f32 v51, v51, v59
    v_mfma_f32_16x16x32_bf16 v[76:79], v[124:127], a[100:103], v[76:79]
    ds_read_b128 v[116:119], v3 offset:41984
    v_cvt_pk_bf16_f32 v152, v48, v49
    v_mfma_f32_16x16x32_bf16 v[72:75], v[124:127], a[96:99], v[72:75]
    v_cvt_pk_bf16_f32 v153, v50, v51
    v_mul_f32 v52, v168, v52
    s_waitcnt lgkmcnt(6)
    v_mfma_f32_16x16x32_bf16 v[64:67], v[128:131], a[104:107], v[64:67]
    ds_read_b128 v[120:123], v3 offset:43008
    v_mul_f32 v53, v168, v53
    v_mfma_f32_16x16x32_bf16 v[68:71], v[128:131], a[108:111], v[68:71]
    s_add_u32 s30, s31, 12288
    s_add_u32 m0, s53, 100352
    s_nop 0
    buffer_load_dwordx4 v3, s[8:11], s30 offen sc1 lds
    v_mul_f32 v54, v168, v54
    v_mul_f32 v55, v168, v55
    s_waitcnt vmcnt(7)
    s_lshl_b32 s56, s20, 1
    s_lshr_b32 s57, s32, 1
    s_add_u32 s56, s56, s57
    s_and_b32 s57, s32, 1
    s_lshl_b32 s58, s21, 1
    s_add_u32 s57, s57, s58
    s_lshl_b32 s56, s56, 10
    s_lshl_b32 s57, s57, 5
    s_add_u32 s56, s56, s57
    s_add_u32 s56, s56, 37359616
    v_mov_b32 v250, s100
    v_mov_b32 v251, s101
    s_mov_b64 exec, 1
    buffer_store_dwordx2 v[250:251], v3, s[8:11], s56 offen sc1
    s_mov_b64 exec, -1
    v_mfma_f32_16x16x32_bf16 v[76:79], v[132:135], a[108:111], v[76:79]
    ds_read_b128 v[124:127], v3 offset:44032
    v_exp_f32 v52, v52
    v_mfma_f32_16x16x32_bf16 v[72:75], v[132:135], a[104:107], v[72:75]
    v_exp_f32 v53, v53
    v_exp_f32 v54, v54
    s_waitcnt lgkmcnt(6)
    v_mfma_f32_16x16x32_bf16 v[64:67], v[136:139], a[112:115], v[64:67]
    ds_read_b128 v[128:131], v3 offset:45056
    v_exp_f32 v55, v55
    v_mfma_f32_16x16x32_bf16 v[68:71], v[136:139], a[116:119], v[68:71]
    v_fma_f32 v52, v52, v169, v169
    v_fma_f32 v53, v53, v169, v169
    v_mfma_f32_16x16x32_bf16 v[76:79], v[140:143], a[116:119], v[76:79]
    ds_read_b128 v[132:135], v3 offset:46080
    v_fma_f32 v54, v54, v169, v169
    v_mfma_f32_16x16x32_bf16 v[72:75], v[140:143], a[112:115], v[72:75]
    s_add_u32 s30, s31, 13312
    s_add_u32 m0, s53, 101376
    s_nop 0
    buffer_load_dwordx4 v3, s[8:11], s30 offen sc1 lds
    v_fma_f32 v55, v55, v169, v169
    v_rcp_f32 v52, v52
    s_waitcnt lgkmcnt(6)
    v_mfma_f32_16x16x32_bf16 v[64:67], v[144:147], a[120:123], v[64:67]
    ds_read_b128 v[136:139], v3 offset:47104
    v_rcp_f32 v53, v53
    v_mfma_f32_16x16x32_bf16 v[68:71], v[144:147], a[124:127], v[68:71]
    v_rcp_f32 v54, v54
    v_rcp_f32 v55, v55
    v_mfma_f32_16x16x32_bf16 v[76:79], v[148:151], a[124:127], v[76:79]
    ds_read_b128 v[140:143], v3 offset:48128
    v_mul_f32 v52, v52, v60
    v_mfma_f32_16x16x32_bf16 v[72:75], v[148:151], a[120:123], v[72:75]
    s_add_u32 s30, s31, 14336
    s_add_u32 m0, s53, 102400
    s_nop 0
    buffer_load_dwordx4 v3, s[8:11], s30 offen sc1 lds
    v_mul_f32 v53, v53, v61
    v_mul_f32 v54, v54, v62
    s_waitcnt lgkmcnt(6)
    v_mfma_f32_16x16x32_bf16 v[64:67], v[112:115], a[128:131], v[64:67]
    ds_read_b128 v[144:147], v14 offset:1536
    v_mul_f32 v55, v55, v63
    v_mfma_f32_16x16x32_bf16 v[68:71], v[112:115], a[132:135], v[68:71]
    v_cvt_pk_bf16_f32 v156, v52, v53
    v_cvt_pk_bf16_f32 v157, v54, v55
    v_mfma_f32_16x16x32_bf16 v[76:79], v[116:119], a[132:135], v[76:79]
    ds_read_b128 v[148:151], v14 offset:1792
    v_mfma_f32_16x16x32_bf16 v[72:75], v[116:119], a[128:131], v[72:75]
    s_waitcnt vmcnt(19)
    s_barrier
    s_waitcnt lgkmcnt(6)
    v_mfma_f32_16x16x32_bf16 v[64:67], v[120:123], a[136:139], v[64:67]
    ds_read_b128 v[112:115], v5 offset:0
    v_mfma_f32_16x16x32_bf16 v[68:71], v[120:123], a[140:143], v[68:71]
    s_add_u32 s30, s31, 25600
    s_add_u32 m0, s53, 103424
    s_nop 0
    buffer_load_dwordx4 v3, s[8:11], s30 offen sc1 lds
    v_mfma_f32_16x16x32_bf16 v[76:79], v[124:127], a[140:143], v[76:79]
    ds_read_b128 v[116:119], v5 offset:1024
    v_mfma_f32_16x16x32_bf16 v[72:75], v[124:127], a[136:139], v[72:75]
    s_waitcnt lgkmcnt(6)
    v_mfma_f32_16x16x32_bf16 v[64:67], v[128:131], a[144:147], v[64:67]
    ds_read_b128 v[120:123], v5 offset:2048
    v_mfma_f32_16x16x32_bf16 v[68:71], v[128:131], a[148:151], v[68:71]
    s_add_u32 s30, s31, 26624
    s_add_u32 m0, s53, 104448
    s_nop 0
    buffer_load_dwordx4 v3, s[8:11], s30 offen sc1 lds
    v_mfma_f32_16x16x32_bf16 v[76:79], v[132:135], a[148:151], v[76:79]
    ds_read_b128 v[124:127], v5 offset:3072
    v_mfma_f32_16x16x32_bf16 v[72:75], v[132:135], a[144:147], v[72:75]
    s_waitcnt lgkmcnt(6)
    v_mfma_f32_16x16x32_bf16 v[64:67], v[136:139], a[152:155], v[64:67]
    ds_read_b128 v[128:131], v5 offset:4096
    v_mfma_f32_16x16x32_bf16 v[68:71], v[136:139], a[156:159], v[68:71]
    v_mfma_f32_16x16x32_bf16 v[76:79], v[140:143], a[156:159], v[76:79]
    ds_read_b128 v[132:135], v5 offset:5120
    v_mfma_f32_16x16x32_bf16 v[72:75], v[140:143], a[152:155], v[72:75]
    s_add_u32 s30, s31, 27648
    s_add_u32 m0, s53, 105472
    s_nop 0
    buffer_load_dwordx4 v3, s[8:11], s30 offen sc1 lds
    s_waitcnt lgkmcnt(6)
    v_mfma_f32_16x16x32_bf16 v[64:67], v[144:147], v[164:167], v[64:67]
    ds_read_b128 v[136:139], v5 offset:6144
    v_mfma_f32_16x16x32_bf16 v[68:71], v[144:147], v[172:175], v[68:71]
    v_mfma_f32_16x16x32_bf16 v[76:79], v[148:151], v[172:175], v[76:79]
    ds_read_b128 v[140:143], v5 offset:7168
    v_mfma_f32_16x16x32_bf16 v[72:75], v[148:151], v[164:167], v[72:75]
    s_waitcnt lgkmcnt(6)
    v_mfma_f32_16x16x32_bf16 v[80:83], v[112:115], a[64:67], v[80:83]
    ds_read_b128 v[144:147], v5 offset:8192
    v_mfma_f32_16x16x32_bf16 v[84:87], v[112:115], a[68:71], v[84:87]
    v_mfma_f32_16x16x32_bf16 v[92:95], v[116:119], a[68:71], v[92:95]
    ds_read_b128 v[148:151], v5 offset:9216
    v_mfma_f32_16x16x32_bf16 v[88:91], v[116:119], a[64:67], v[88:91]
    s_add_u32 s30, s31, 28672
    s_add_u32 m0, s53, 106496
    s_nop 0
    buffer_load_dwordx4 v3, s[8:11], s30 offen sc1 lds
    s_waitcnt lgkmcnt(6)
    v_mfma_f32_16x16x32_bf16 v[80:83], v[120:123], a[72:75], v[80:83]
    ds_read_b128 v[112:115], v5 offset:10240
    v_mfma_f32_16x16x32_bf16 v[84:87], v[120:123], a[76:79], v[84:87]
    v_mul_f32 v64, v160, v64
    v_mul_f32 v65, v160, v65
    v_mfma_f32_16x16x32_bf16 v[92:95], v[124:127], a[76:79], v[92:95]
    ds_read_b128 v[116:119], v5 offset:11264
    v_mul_f32 v66, v160, v66
    v_mfma_f32_16x16x32_bf16 v[88:91], v[124:127], a[72:75], v[88:91]
    v_mul_f32 v67, v160, v67
    v_exp_f32 v64, v64
    s_waitcnt lgkmcnt(6)
    v_mfma_f32_16x16x32_bf16 v[80:83], v[128:131], a[80:83], v[80:83]
    ds_read_b128 v[120:123], v5 offset:12288
    v_exp_f32 v65, v65
    v_mfma_f32_16x16x32_bf16 v[84:87], v[128:131], a[84:87], v[84:87]
    s_add_u32 s30, s31, 29696
    s_add_u32 m0, s53, 107520
    s_nop 0
    buffer_load_dwordx4 v3, s[8:11], s30 offen sc1 lds
    v_exp_f32 v66, v66
    v_exp_f32 v67, v67
    v_mfma_f32_16x16x32_bf16 v[92:95], v[132:135], a[84:87], v[92:95]
    ds_read_b128 v[124:127], v5 offset:13312
    v_fma_f32 v64, v64, v161, v161
    v_mfma_f32_16x16x32_bf16 v[88:91], v[132:135], a[80:83], v[88:91]
    v_fma_f32 v65, v65, v161, v161
    v_fma_f32 v66, v66, v161, v161
    s_waitcnt lgkmcnt(6)
    v_mfma_f32_16x16x32_bf16 v[80:83], v[136:139], a[88:91], v[80:83]
    ds_read_b128 v[128:131], v5 offset:14336
    v_fma_f32 v67, v67, v161, v161
    v_mfma_f32_16x16x32_bf16 v[84:87], v[136:139], a[92:95], v[84:87]
    s_add_u32 s30, s31, 40960
    s_add_u32 m0, s53, 108544
    s_nop 0
    buffer_load_dwordx4 v3, s[8:11], s30 offen sc1 lds
    v_rcp_f32 v64, v64
    v_rcp_f32 v65, v65
    v_mfma_f32_16x16x32_bf16 v[92:95], v[140:143], a[92:95], v[92:95]
    ds_read_b128 v[132:135], v5 offset:15360
    v_rcp_f32 v66, v66
    v_mfma_f32_16x16x32_bf16 v[88:91], v[140:143], a[88:91], v[88:91]
    v_rcp_f32 v67, v67
    v_mul_f32 v64, v64, v72
    s_waitcnt lgkmcnt(6)
    v_mfma_f32_16x16x32_bf16 v[80:83], v[144:147], a[96:99], v[80:83]
    ds_read_b128 v[136:139], v5 offset:16384
    v_mul_f32 v65, v65, v73
    v_mfma_f32_16x16x32_bf16 v[84:87], v[144:147], a[100:103], v[84:87]
    v_mul_f32 v66, v66, v74
    v_mul_f32 v67, v67, v75
    v_mfma_f32_16x16x32_bf16 v[92:95], v[148:151], a[100:103], v[92:95]
    ds_read_b128 v[140:143], v5 offset:17408
    v_cvt_pk_bf16_f32 v154, v64, v65
    v_mfma_f32_16x16x32_bf16 v[88:91], v[148:151], a[96:99], v[88:91]
    s_add_u32 s30, s31, 41984
    s_add_u32 m0, s53, 109568
    s_nop 0
    buffer_load_dwordx4 v3, s[8:11], s30 offen sc1 lds
    v_cvt_pk_bf16_f32 v155, v66, v67
    buffer_store_dwordx4 v[152:155], v3, s[8:11], s40 offen offset:1024 sc1
    s_waitcnt lgkmcnt(6)
    v_mfma_f32_16x16x32_bf16 v[80:83], v[112:115], a[104:107], v[80:83]
    ds_read_b128 v[144:147], v5 offset:18432
    v_mul_f32 v68, v168, v68
    v_mfma_f32_16x16x32_bf16 v[84:87], v[112:115], a[108:111], v[84:87]
    v_mul_f32 v69, v168, v69
    v_mul_f32 v70, v168, v70
    v_mfma_f32_16x16x32_bf16 v[92:95], v[116:119], a[108:111], v[92:95]
    ds_read_b128 v[148:151], v5 offset:19456
    v_mul_f32 v71, v168, v71
    v_mfma_f32_16x16x32_bf16 v[88:91], v[116:119], a[104:107], v[88:91]
    v_exp_f32 v68, v68
    v_exp_f32 v69, v69
    s_waitcnt lgkmcnt(6)
    v_mfma_f32_16x16x32_bf16 v[80:83], v[120:123], a[112:115], v[80:83]
    ds_read_b128 v[112:115], v5 offset:20480
    v_exp_f32 v70, v70
    v_mfma_f32_16x16x32_bf16 v[84:87], v[120:123], a[116:119], v[84:87]
    v_exp_f32 v71, v71
    v_fma_f32 v68, v68, v169, v169
    v_mfma_f32_16x16x32_bf16 v[92:95], v[124:127], a[116:119], v[92:95]
    ds_read_b128 v[116:119], v5 offset:21504
    v_fma_f32 v69, v69, v169, v169
    v_mfma_f32_16x16x32_bf16 v[88:91], v[124:127], a[112:115], v[88:91]
    v_fma_f32 v70, v70, v169, v169
    v_fma_f32 v71, v71, v169, v169
    s_waitcnt lgkmcnt(6)
    v_mfma_f32_16x16x32_bf16 v[80:83], v[128:131], a[120:123], v[80:83]
    ds_read_b128 v[120:123], v5 offset:22528
    v_rcp_f32 v68, v68
    v_mfma_f32_16x16x32_bf16 v[84:87], v[128:131], a[124:127], v[84:87]
    v_rcp_f32 v69, v69
    v_rcp_f32 v70, v70
    s_add_u32 s57, s60, 0
    s_lshl_b32 s58, s32, 3
    s_lshl_b32 s57, s57, 10
    s_lshl_b32 s58, s58, 5
    s_add_u32 s57, s57, s58
    s_add_u32 s59, s57, 37359616
    v_lshlrev_b32 v254, 5, v2
    s_mov_b64 exec, 0xff
    buffer_load_dwordx2 v[252:253], v254, s[8:11], s59 offen sc1
    s_mov_b64 exec, -1
    v_mfma_f32_16x16x32_bf16 v[92:95], v[132:135], a[124:127], v[92:95]
    ds_read_b128 v[124:127], v5 offset:23552
    v_rcp_f32 v71, v71
    v_mfma_f32_16x16x32_bf16 v[88:91], v[132:135], a[120:123], v[88:91]
    v_mul_f32 v68, v68, v76
    v_mul_f32 v69, v69, v77
    s_waitcnt lgkmcnt(6)
    v_mfma_f32_16x16x32_bf16 v[80:83], v[136:139], a[128:131], v[80:83]
    ds_read_b128 v[128:131], v14 offset:2048
    v_mul_f32 v70, v70, v78
    v_mfma_f32_16x16x32_bf16 v[84:87], v[136:139], a[132:135], v[84:87]
    v_mul_f32 v71, v71, v79
    v_cvt_pk_bf16_f32 v158, v68, v69
    v_mfma_f32_16x16x32_bf16 v[92:95], v[140:143], a[132:135], v[92:95]
    ds_read_b128 v[132:135], v14 offset:2304
    v_cvt_pk_bf16_f32 v159, v70, v71
    v_mfma_f32_16x16x32_bf16 v[88:91], v[140:143], a[128:131], v[88:91]
    buffer_store_dwordx4 v[156:159], v3, s[8:11], s41 offen offset:1024 sc1
    s_waitcnt vmcnt(16)
    s_barrier
    s_waitcnt lgkmcnt(6)
    v_mfma_f32_16x16x32_bf16 v[80:83], v[144:147], a[136:139], v[80:83]
    ds_read_b128 v[136:139], v5 offset:24576
    v_mfma_f32_16x16x32_bf16 v[84:87], v[144:147], a[140:143], v[84:87]
    v_mfma_f32_16x16x32_bf16 v[92:95], v[148:151], a[140:143], v[92:95]
    ds_read_b128 v[140:143], v5 offset:25600
    v_mfma_f32_16x16x32_bf16 v[88:91], v[148:151], a[136:139], v[88:91]
    s_waitcnt lgkmcnt(6)
    v_mfma_f32_16x16x32_bf16 v[80:83], v[112:115], a[144:147], v[80:83]
    ds_read_b128 v[144:147], v5 offset:26624
    v_mfma_f32_16x16x32_bf16 v[84:87], v[112:115], a[148:151], v[84:87]
    v_mfma_f32_16x16x32_bf16 v[92:95], v[116:119], a[148:151], v[92:95]
    ds_read_b128 v[148:151], v5 offset:27648
    v_mfma_f32_16x16x32_bf16 v[88:91], v[116:119], a[144:147], v[88:91]
    s_waitcnt lgkmcnt(6)
    v_mfma_f32_16x16x32_bf16 v[80:83], v[120:123], a[152:155], v[80:83]
    ds_read_b128 v[112:115], v5 offset:28672
    v_mfma_f32_16x16x32_bf16 v[84:87], v[120:123], a[156:159], v[84:87]
    v_mfma_f32_16x16x32_bf16 v[92:95], v[124:127], a[156:159], v[92:95]
    ds_read_b128 v[116:119], v5 offset:29696
    v_mfma_f32_16x16x32_bf16 v[88:91], v[124:127], a[152:155], v[88:91]
    s_waitcnt lgkmcnt(6)
    v_mfma_f32_16x16x32_bf16 v[80:83], v[128:131], v[164:167], v[80:83]
    ds_read_b128 v[120:123], v5 offset:30720
    v_mfma_f32_16x16x32_bf16 v[84:87], v[128:131], v[172:175], v[84:87]
    v_mfma_f32_16x16x32_bf16 v[92:95], v[132:135], v[172:175], v[92:95]
    ds_read_b128 v[124:127], v5 offset:31744
    v_mfma_f32_16x16x32_bf16 v[88:91], v[132:135], v[164:167], v[88:91]
    s_waitcnt lgkmcnt(6)
    v_mfma_f32_16x16x32_bf16 v[96:99], v[136:139], a[64:67], v[96:99]
    ds_read_b128 v[128:131], v5 offset:32768
    v_mfma_f32_16x16x32_bf16 v[100:103], v[136:139], a[68:71], v[100:103]
    v_mfma_f32_16x16x32_bf16 v[108:111], v[140:143], a[68:71], v[108:111]
    ds_read_b128 v[132:135], v5 offset:33792
    v_mfma_f32_16x16x32_bf16 v[104:107], v[140:143], a[64:67], v[104:107]
    s_waitcnt lgkmcnt(6)
    v_mfma_f32_16x16x32_bf16 v[96:99], v[144:147], a[72:75], v[96:99]
    ds_read_b128 v[136:139], v5 offset:34816
    v_mfma_f32_16x16x32_bf16 v[100:103], v[144:147], a[76:79], v[100:103]
    v_mul_f32 v80, v160, v80
    v_mul_f32 v81, v160, v81
    v_mfma_f32_16x16x32_bf16 v[108:111], v[148:151], a[76:79], v[108:111]
    ds_read_b128 v[140:143], v5 offset:35840
    v_mul_f32 v82, v160, v82
    v_mfma_f32_16x16x32_bf16 v[104:107], v[148:151], a[72:75], v[104:107]
    v_mul_f32 v83, v160, v83
    v_exp_f32 v80, v80
    s_waitcnt lgkmcnt(6)
    v_mfma_f32_16x16x32_bf16 v[96:99], v[112:115], a[80:83], v[96:99]
    ds_read_b128 v[144:147], v5 offset:36864
    v_exp_f32 v81, v81
    v_mfma_f32_16x16x32_bf16 v[100:103], v[112:115], a[84:87], v[100:103]
    v_exp_f32 v82, v82
    v_exp_f32 v83, v83
    s_waitcnt vmcnt(1)
    s_mov_b64 exec, 0xff
    v_cmp_ne_u64 vcc, s[100:101], v[252:253]
    s_mov_b64 exec, -1
    s_cbranch_vccz chk_8
    s_mov_b64 exec, 0xff
    s_mov_b32 s58, 0x40000
sync_9_p:
    buffer_load_dwordx2 v[252:253], v254, s[8:11], s59 offen sc1
    s_sub_u32 s58, s58, 1
    s_waitcnt vmcnt(0)
    v_cmp_ne_u64 vcc, s[100:101], v[252:253]
    s_cbranch_scc1 sync_9_x
    s_cbranch_vccnz sync_9_p
sync_9_x:
    s_mov_b64 exec, -1
chk_8:
    v_mfma_f32_16x16x32_bf16 v[108:111], v[116:119], a[84:87], v[108:111]
    ds_read_b128 v[148:151], v5 offset:37888
    v_fma_f32 v80, v80, v161, v161
    v_mfma_f32_16x16x32_bf16 v[104:107], v[116:119], a[80:83], v[104:107]
    s_add_u32 s17, s48, 0
    buffer_load_dwordx4 v[16:19], v3, s[8:11], s17 offen sc1
    v_fma_f32 v81, v81, v161, v161
    v_fma_f32 v82, v82, v161, v161
    s_waitcnt lgkmcnt(6)
    v_mfma_f32_16x16x32_bf16 v[96:99], v[120:123], a[88:91], v[96:99]
    ds_read_b128 v[112:115], v5 offset:38912
    v_fma_f32 v83, v83, v161, v161
    v_mfma_f32_16x16x32_bf16 v[100:103], v[120:123], a[92:95], v[100:103]
    s_add_u32 s17, s49, 0
    buffer_load_dwordx4 v[20:23], v3, s[8:11], s17 offen sc1
    v_rcp_f32 v80, v80
    v_rcp_f32 v81, v81
    v_mfma_f32_16x16x32_bf16 v[108:111], v[124:127], a[92:95], v[108:111]
    ds_read_b128 v[116:119], v5 offset:39936
    v_rcp_f32 v82, v82
    v_mfma_f32_16x16x32_bf16 v[104:107], v[124:127], a[88:91], v[104:107]
    s_add_u32 s17, s50, 0
    buffer_load_dwordx4 v[24:27], v3, s[8:11], s17 offen sc1
    v_rcp_f32 v83, v83
    v_mul_f32 v80, v80, v88
    s_waitcnt lgkmcnt(6)
    v_mfma_f32_16x16x32_bf16 v[96:99], v[128:131], a[96:99], v[96:99]
    ds_read_b128 v[120:123], v5 offset:40960
    v_mul_f32 v81, v81, v89
    v_mfma_f32_16x16x32_bf16 v[100:103], v[128:131], a[100:103], v[100:103]
    s_add_u32 s17, s51, 0
    buffer_load_dwordx4 v[28:31], v3, s[8:11], s17 offen sc1
    v_mul_f32 v82, v82, v90
    v_mul_f32 v83, v83, v91
    v_mfma_f32_16x16x32_bf16 v[108:111], v[132:135], a[100:103], v[108:111]
    ds_read_b128 v[124:127], v5 offset:41984
    v_cvt_pk_bf16_f32 v152, v80, v81
    v_mfma_f32_16x16x32_bf16 v[104:107], v[132:135], a[96:99], v[104:107]
    s_add_u32 s17, s48, 3072
    buffer_load_dwordx4 v[32:35], v3, s[8:11], s17 offen sc1
    v_cvt_pk_bf16_f32 v153, v82, v83
    v_mul_f32 v84, v168, v84
    s_waitcnt lgkmcnt(6)
    v_mfma_f32_16x16x32_bf16 v[96:99], v[136:139], a[104:107], v[96:99]
    ds_read_b128 v[128:131], v5 offset:43008
    v_mul_f32 v85, v168, v85
    v_mfma_f32_16x16x32_bf16 v[100:103], v[136:139], a[108:111], v[100:103]
    s_add_u32 s17, s49, 3072
    buffer_load_dwordx4 v[36:39], v3, s[8:11], s17 offen sc1
    v_mul_f32 v86, v168, v86
    v_mul_f32 v87, v168, v87
    s_waitcnt vmcnt(6)
    s_lshl_b32 s56, s20, 1
    s_lshr_b32 s57, s32, 1
    s_add_u32 s56, s56, s57
    s_and_b32 s57, s32, 1
    s_lshl_b32 s58, s21, 1
    s_add_u32 s57, s57, s58
    s_add_u32 s56, s56, 32
    s_lshl_b32 s56, s56, 10
    s_lshl_b32 s57, s57, 5
    s_add_u32 s56, s56, s57
    s_add_u32 s56, s56, 37359616
    v_mov_b32 v250, s100
    v_mov_b32 v251, s101
    s_mov_b64 exec, 1
    buffer_store_dwordx2 v[250:251], v3, s[8:11], s56 offen sc1
    s_mov_b64 exec, -1
    v_mfma_f32_16x16x32_bf16 v[108:111], v[140:143], a[108:111], v[108:111]
    ds_read_b128 v[132:135], v5 offset:44032
    v_exp_f32 v84, v84
    v_mfma_f32_16x16x32_bf16 v[104:107], v[140:143], a[104:107], v[104:107]
    s_add_u32 s17, s50, 3072
    buffer_load_dwordx4 v[40:43], v3, s[8:11], s17 offen sc1
    v_exp_f32 v85, v85
    v_exp_f32 v86, v86
    s_waitcnt lgkmcnt(6)
    v_mfma_f32_16x16x32_bf16 v[96:99], v[144:147], a[112:115], v[96:99]
    ds_read_b128 v[136:139], v5 offset:45056
    v_exp_f32 v87, v87
    v_mfma_f32_16x16x32_bf16 v[100:103], v[144:147], a[116:119], v[100:103]
    s_add_u32 s17, s51, 3072
    buffer_load_dwordx4 v[44:47], v3, s[8:11], s17 offen sc1
    v_fma_f32 v84, v84, v169, v169
    v_fma_f32 v85, v85, v169, v169
    v_mfma_f32_16x16x32_bf16 v[108:111], v[148:151], a[116:119], v[108:111]
    ds_read_b128 v[140:143], v5 offset:46080
    v_fma_f32 v86, v86, v169, v169
    v_mfma_f32_16x16x32_bf16 v[104:107], v[148:151], a[112:115], v[104:107]
    s_add_u32 s17, s48, 6144
    buffer_load_dwordx4 v[48:51], v3, s[8:11], s17 offen sc1
    v_fma_f32 v87, v87, v169, v169
    v_rcp_f32 v84, v84
    s_waitcnt lgkmcnt(6)
    v_mfma_f32_16x16x32_bf16 v[96:99], v[112:115], a[120:123], v[96:99]
    ds_read_b128 v[144:147], v5 offset:47104
    v_rcp_f32 v85, v85
    v_mfma_f32_16x16x32_bf16 v[100:103], v[112:115], a[124:127], v[100:103]
    s_add_u32 s17, s49, 6144
    buffer_load_dwordx4 v[52:55], v3, s[8:11], s17 offen sc1
    v_rcp_f32 v86, v86
    v_rcp_f32 v87, v87
    v_mfma_f32_16x16x32_bf16 v[108:111], v[116:119], a[124:127], v[108:111]
    ds_read_b128 v[148:151], v5 offset:48128
    v_mul_f32 v84, v84, v92
    v_mfma_f32_16x16x32_bf16 v[104:107], v[116:119], a[120:123], v[104:107]
    s_add_u32 s17, s50, 6144
    buffer_load_dwordx4 v[56:59], v3, s[8:11], s17 offen sc1
    v_mul_f32 v85, v85, v93
    v_mul_f32 v86, v86, v94
    s_waitcnt lgkmcnt(6)
    v_mfma_f32_16x16x32_bf16 v[96:99], v[120:123], a[128:131], v[96:99]
    ds_read_b128 v[112:115], v14 offset:2560
    v_mul_f32 v87, v87, v95
    v_mfma_f32_16x16x32_bf16 v[100:103], v[120:123], a[132:135], v[100:103]
    s_add_u32 s17, s51, 6144
    buffer_load_dwordx4 v[60:63], v3, s[8:11], s17 offen sc1
    v_cvt_pk_bf16_f32 v156, v84, v85
    v_cvt_pk_bf16_f32 v157, v86, v87
    v_mfma_f32_16x16x32_bf16 v[108:111], v[124:127], a[132:135], v[108:111]
    ds_read_b128 v[116:119], v14 offset:2816
    v_mfma_f32_16x16x32_bf16 v[104:107], v[124:127], a[128:131], v[104:107]
    s_add_u32 s17, s48, 9216
    buffer_load_dwordx4 v[64:67], v3, s[8:11], s17 offen sc1
    s_waitcnt lgkmcnt(6)
    v_mfma_f32_16x16x32_bf16 v[96:99], v[128:131], a[136:139], v[96:99]
    v_mfma_f32_16x16x32_bf16 v[100:103], v[128:131], a[140:143], v[100:103]
    s_add_u32 s17, s49, 9216
    buffer_load_dwordx4 v[68:71], v3, s[8:11], s17 offen sc1
    v_mfma_f32_16x16x32_bf16 v[108:111], v[132:135], a[140:143], v[108:111]
    v_mfma_f32_16x16x32_bf16 v[104:107], v[132:135], a[136:139], v[104:107]
    s_add_u32 s17, s50, 9216
    buffer_load_dwordx4 v[72:75], v3, s[8:11], s17 offen sc1
    s_waitcnt lgkmcnt(4)
    v_mfma_f32_16x16x32_bf16 v[96:99], v[136:139], a[144:147], v[96:99]
    v_mfma_f32_16x16x32_bf16 v[100:103], v[136:139], a[148:151], v[100:103]
    s_add_u32 s17, s51, 9216
    buffer_load_dwordx4 v[76:79], v3, s[8:11], s17 offen sc1
    v_mfma_f32_16x16x32_bf16 v[108:111], v[140:143], a[148:151], v[108:111]
    v_mfma_f32_16x16x32_bf16 v[104:107], v[140:143], a[144:147], v[104:107]
    s_waitcnt lgkmcnt(2)
    v_mfma_f32_16x16x32_bf16 v[96:99], v[144:147], a[152:155], v[96:99]
    v_mfma_f32_16x16x32_bf16 v[100:103], v[144:147], a[156:159], v[100:103]
    v_mfma_f32_16x16x32_bf16 v[108:111], v[148:151], a[156:159], v[108:111]
    v_mfma_f32_16x16x32_bf16 v[104:107], v[148:151], a[152:155], v[104:107]
    s_waitcnt lgkmcnt(0)
    v_mfma_f32_16x16x32_bf16 v[96:99], v[112:115], v[164:167], v[96:99]
    v_mfma_f32_16x16x32_bf16 v[100:103], v[112:115], v[172:175], v[100:103]
    v_mfma_f32_16x16x32_bf16 v[108:111], v[116:119], v[172:175], v[108:111]
    v_mfma_f32_16x16x32_bf16 v[104:107], v[116:119], v[164:167], v[104:107]
    s_add_u32 s57, s60, 32
    s_lshl_b32 s58, s32, 3
    s_lshl_b32 s57, s57, 10
    s_lshl_b32 s58, s58, 5
    s_add_u32 s57, s57, s58
    s_add_u32 s59, s57, 37359616
    v_lshlrev_b32 v254, 5, v2
    s_mov_b64 exec, 0xff
    buffer_load_dwordx2 v[252:253], v254, s[8:11], s59 offen sc1
    s_mov_b64 exec, -1
    v_mul_f32 v96, v160, v96
    v_mul_f32 v97, v160, v97
    v_mul_f32 v98, v160, v98
    v_mul_f32 v99, v160, v99
    v_exp_f32 v96, v96
    v_exp_f32 v97, v97
    v_exp_f32 v98, v98
    v_exp_f32 v99, v99
    v_fma_f32 v96, v96, v161, v161
    v_fma_f32 v97, v97, v161, v161
    v_fma_f32 v98, v98, v161, v161
    v_fma_f32 v99, v99, v161, v161
    v_rcp_f32 v96, v96
    v_rcp_f32 v97, v97
    v_rcp_f32 v98, v98
    v_rcp_f32 v99, v99
    v_mul_f32 v96, v96, v104
    v_mul_f32 v97, v97, v105
    v_mul_f32 v98, v98, v106
    v_mul_f32 v99, v99, v107
    v_cvt_pk_bf16_f32 v154, v96, v97
    v_cvt_pk_bf16_f32 v155, v98, v99
    buffer_store_dwordx4 v[152:155], v3, s[8:11], s40 offen offset:2048 sc1
    v_mul_f32 v100, v168, v100
    v_mul_f32 v101, v168, v101
    v_mul_f32 v102, v168, v102
    v_mul_f32 v103, v168, v103
    v_exp_f32 v100, v100
    v_exp_f32 v101, v101
    v_exp_f32 v102, v102
    v_exp_f32 v103, v103
    v_fma_f32 v100, v100, v169, v169
    v_fma_f32 v101, v101, v169, v169
    v_fma_f32 v102, v102, v169, v169
    v_fma_f32 v103, v103, v169, v169
    v_rcp_f32 v100, v100
    v_rcp_f32 v101, v101
    v_rcp_f32 v102, v102
    v_rcp_f32 v103, v103
    v_mul_f32 v100, v100, v108
    v_mul_f32 v101, v101, v109
    v_mul_f32 v102, v102, v110
    v_mul_f32 v103, v103, v111
    v_cvt_pk_bf16_f32 v158, v100, v101
    v_cvt_pk_bf16_f32 v159, v102, v103
    buffer_store_dwordx4 v[156:159], v3, s[8:11], s41 offen offset:2048 sc1
    s_waitcnt vmcnt(16)
    v_mfma_f32_16x16x32_bf16 v[116:119], a[160:163], v[20:23], 0
    s_add_u32 s45, s52, 7340032
    v_lshrrev_b32 v5, 1, v4
    v_mfma_f32_16x16x32_bf16 v[120:123], a[164:167], v[20:23], 0
    v_lshlrev_b32 v5, 8, v5
    v_lshl_add_u32 v5, v8, 4, v5
    v_mfma_f32_16x16x32_bf16 v[124:127], a[168:171], v[20:23], 0
    v_and_b32 v6, 1, v4
    v_lshl_add_u32 v5, v6, 3, v5
    v_mfma_f32_16x16x32_bf16 v[128:131], a[172:175], v[20:23], 0
    s_add_u32 s33, s32, 1
    s_and_b32 s33, s33, 3
    v_mfma_f32_16x16x32_bf16 v[132:135], a[176:179], v[20:23], 0
    s_mul_i32 s33, s33, 15360
    s_add_u32 s33, s33, 10240
    v_mfma_f32_16x16x32_bf16 v[152:155], a[176:179], v[24:27], 0
    v_add_u32 v10, s33, v3
    s_add_u32 s33, s32, 2
    v_mfma_f32_16x16x32_bf16 v[148:151], a[172:175], v[24:27], 0
    s_and_b32 s33, s33, 3
    s_mul_i32 s33, s33, 15360
    v_mfma_f32_16x16x32_bf16 v[144:147], a[168:171], v[24:27], 0
    s_add_u32 s33, s33, 5120
    v_add_u32 v11, s33, v3
    v_mfma_f32_16x16x32_bf16 v[140:143], a[164:167], v[24:27], 0
    s_add_u32 s33, s32, 3
    s_and_b32 s33, s33, 3
    v_mfma_f32_16x16x32_bf16 v[136:139], a[160:163], v[24:27], 0
    s_mul_i32 s33, s33, 15360
    s_add_u32 s33, s33, 0
    v_mfma_f32_16x16x32_bf16 v[156:159], a[160:163], v[28:31], 0
    v_add_u32 v12, s33, v3
    s_mul_i32 s33, s32, 15360
    v_mfma_f32_16x16x32_bf16 v[160:163], a[164:167], v[28:31], 0
    v_add_u32 v13, s33, v3
    v_add_u32 v14, 61440, v3
    v_mfma_f32_16x16x32_bf16 v[164:167], a[168:171], v[28:31], 0
    v_add_u32 v15, 98304, v3
    s_add_u32 s44, s52, 27262976
    v_mfma_f32_16x16x32_bf16 v[168:171], a[172:175], v[28:31], 0
    v_mfma_f32_16x16x32_bf16 v[172:175], a[176:179], v[28:31], 0
    v_mfma_f32_16x16x32_bf16 v[112:115], a[176:179], v[16:19], 0
    v_mfma_f32_16x16x32_bf16 v[108:111], a[172:175], v[16:19], 0
    v_mfma_f32_16x16x32_bf16 v[104:107], a[168:171], v[16:19], 0
    v_mfma_f32_16x16x32_bf16 v[100:103], a[164:167], v[16:19], 0
    v_mfma_f32_16x16x32_bf16 v[96:99], a[160:163], v[16:19], 0
    s_waitcnt vmcnt(2)
    s_mov_b64 exec, 0xff
    v_cmp_ne_u64 vcc, s[100:101], v[252:253]
    s_mov_b64 exec, -1
    s_cbranch_vccz chk_10
    s_mov_b64 exec, 0xff
    s_mov_b32 s58, 0x40000
sync_11_p:
    buffer_load_dwordx2 v[252:253], v254, s[8:11], s59 offen sc1
    s_sub_u32 s58, s58, 1
    s_waitcnt vmcnt(0)
    v_cmp_ne_u64 vcc, s[100:101], v[252:253]
    s_cbranch_scc1 sync_11_x
    s_cbranch_vccnz sync_11_p
sync_11_x:
    s_mov_b64 exec, -1
chk_10:
    s_waitcnt vmcnt(11)
    v_mfma_f32_16x16x32_bf16 v[116:119], a[180:183], v[36:39], v[116:119]
    s_add_u32 s17, s48, 1024
    buffer_load_dwordx4 a[96:99], v3, s[8:11], s17 offen sc1
    v_mfma_f32_16x16x32_bf16 v[120:123], a[184:187], v[36:39], v[120:123]
    v_mfma_f32_16x16x32_bf16 v[124:127], a[188:191], v[36:39], v[124:127]
    s_add_u32 s17, s49, 1024
    buffer_load_dwordx4 a[100:103], v3, s[8:11], s17 offen sc1
    v_mfma_f32_16x16x32_bf16 v[128:131], a[192:195], v[36:39], v[128:131]
    v_mfma_f32_16x16x32_bf16 v[132:135], a[196:199], v[36:39], v[132:135]
    s_add_u32 s17, s50, 1024
    buffer_load_dwordx4 a[104:107], v3, s[8:11], s17 offen sc1
    v_mfma_f32_16x16x32_bf16 v[152:155], a[196:199], v[40:43], v[152:155]
    v_mfma_f32_16x16x32_bf16 v[148:151], a[192:195], v[40:43], v[148:151]
    s_add_u32 s17, s51, 1024
    buffer_load_dwordx4 a[108:111], v3, s[8:11], s17 offen sc1
    v_mfma_f32_16x16x32_bf16 v[144:147], a[188:191], v[40:43], v[144:147]
    v_mfma_f32_16x16x32_bf16 v[140:143], a[184:187], v[40:43], v[140:143]
    s_add_u32 s17, s48, 4096
    buffer_load_dwordx4 a[112:115], v3, s[8:11], s17 offen sc1
    v_mfma_f32_16x16x32_bf16 v[136:139], a[180:183], v[40:43], v[136:139]
    v_mfma_f32_16x16x32_bf16 v[156:159], a[180:183], v[44:47], v[156:159]
    s_add_u32 s17, s49, 4096
    buffer_load_dwordx4 a[116:119], v3, s[8:11], s17 offen sc1
    v_mfma_f32_16x16x32_bf16 v[160:163], a[184:187], v[44:47], v[160:163]
    v_mfma_f32_16x16x32_bf16 v[164:167], a[188:191], v[44:47], v[164:167]
    s_add_u32 s17, s50, 4096
    buffer_load_dwordx4 a[120:123], v3, s[8:11], s17 offen sc1
    v_mfma_f32_16x16x32_bf16 v[168:171], a[192:195], v[44:47], v[168:171]
    v_mfma_f32_16x16x32_bf16 v[172:175], a[196:199], v[44:47], v[172:175]
    s_add_u32 s17, s51, 4096
    buffer_load_dwordx4 a[124:127], v3, s[8:11], s17 offen sc1
    v_mfma_f32_16x16x32_bf16 v[112:115], a[196:199], v[32:35], v[112:115]
    v_mfma_f32_16x16x32_bf16 v[108:111], a[192:195], v[32:35], v[108:111]
    v_mfma_f32_16x16x32_bf16 v[104:107], a[188:191], v[32:35], v[104:107]
    v_mfma_f32_16x16x32_bf16 v[100:103], a[184:187], v[32:35], v[100:103]
    v_mfma_f32_16x16x32_bf16 v[96:99], a[180:183], v[32:35], v[96:99]
    s_waitcnt vmcnt(15)
    v_mfma_f32_16x16x32_bf16 v[116:119], a[200:203], v[52:55], v[116:119]
    s_add_u32 s17, s48, 7168
    buffer_load_dwordx4 a[128:131], v3, s[8:11], s17 offen sc1
    v_mfma_f32_16x16x32_bf16 v[120:123], a[204:207], v[52:55], v[120:123]
    v_mfma_f32_16x16x32_bf16 v[124:127], a[208:211], v[52:55], v[124:127]
    s_add_u32 s17, s49, 7168
    buffer_load_dwordx4 a[132:135], v3, s[8:11], s17 offen sc1
    v_mfma_f32_16x16x32_bf16 v[128:131], a[212:215], v[52:55], v[128:131]
    v_mfma_f32_16x16x32_bf16 v[132:135], a[216:219], v[52:55], v[132:135]
    s_add_u32 s17, s50, 7168
    buffer_load_dwordx4 a[136:139], v3, s[8:11], s17 offen sc1
    v_mfma_f32_16x16x32_bf16 v[152:155], a[216:219], v[56:59], v[152:155]
    v_mfma_f32_16x16x32_bf16 v[148:151], a[212:215], v[56:59], v[148:151]
    s_add_u32 s17, s51, 7168
    buffer_load_dwordx4 a[140:143], v3, s[8:11], s17 offen sc1
    v_mfma_f32_16x16x32_bf16 v[144:147], a[208:211], v[56:59], v[144:147]
    v_mfma_f32_16x16x32_bf16 v[140:143], a[204:207], v[56:59], v[140:143]
    s_add_u32 s17, s48, 10240
    buffer_load_dwordx4 a[144:147], v3, s[8:11], s17 offen sc1
    v_mfma_f32_16x16x32_bf16 v[136:139], a[200:203], v[56:59], v[136:139]
    v_mfma_f32_16x16x32_bf16 v[156:159], a[200:203], v[60:63], v[156:159]
    s_add_u32 s17, s49, 10240
    buffer_load_dwordx4 a[148:151], v3, s[8:11], s17 offen sc1
    v_mfma_f32_16x16x32_bf16 v[160:163], a[204:207], v[60:63], v[160:163]
    v_mfma_f32_16x16x32_bf16 v[164:167], a[208:211], v[60:63], v[164:167]
    s_add_u32 s17, s50, 10240
    buffer_load_dwordx4 a[152:155], v3, s[8:11], s17 offen sc1
    v_mfma_f32_16x16x32_bf16 v[168:171], a[212:215], v[60:63], v[168:171]
    v_mfma_f32_16x16x32_bf16 v[172:175], a[216:219], v[60:63], v[172:175]
    s_add_u32 s17, s51, 10240
    buffer_load_dwordx4 a[156:159], v3, s[8:11], s17 offen sc1
    v_mfma_f32_16x16x32_bf16 v[112:115], a[216:219], v[48:51], v[112:115]
    v_mfma_f32_16x16x32_bf16 v[108:111], a[212:215], v[48:51], v[108:111]
    v_mfma_f32_16x16x32_bf16 v[104:107], a[208:211], v[48:51], v[104:107]
    v_mfma_f32_16x16x32_bf16 v[100:103], a[204:207], v[48:51], v[100:103]
    v_mfma_f32_16x16x32_bf16 v[96:99], a[200:203], v[48:51], v[96:99]
    s_waitcnt vmcnt(19)
    s_barrier
    v_mfma_f32_16x16x32_bf16 v[116:119], a[220:223], v[68:71], v[116:119]
    s_add_u32 s30, s31, 43008
    s_add_u32 m0, s54, 61440
    s_nop 0
    buffer_load_dwordx4 v3, s[8:11], s30 offen sc1 lds
    v_mfma_f32_16x16x32_bf16 v[120:123], a[224:227], v[68:71], v[120:123]
    v_mfma_f32_16x16x32_bf16 v[124:127], a[228:231], v[68:71], v[124:127]
    s_add_u32 s30, s31, 44032
    s_add_u32 m0, s54, 62464
    s_nop 0
    buffer_load_dwordx4 v3, s[8:11], s30 offen sc1 lds
    v_mfma_f32_16x16x32_bf16 v[128:131], a[232:235], v[68:71], v[128:131]
    v_mfma_f32_16x16x32_bf16 v[132:135], a[236:239], v[68:71], v[132:135]
    s_add_u32 s30, s31, 45056
    s_add_u32 m0, s54, 63488
    s_nop 0
    buffer_load_dwordx4 v3, s[8:11], s30 offen sc1 lds
    v_mfma_f32_16x16x32_bf16 v[152:155], a[236:239], v[72:75], v[152:155]
    v_mfma_f32_16x16x32_bf16 v[148:151], a[232:235], v[72:75], v[148:151]
    s_add_u32 s30, s31, 56320
    s_add_u32 m0, s54, 64512
    s_nop 0
    buffer_load_dwordx4 v3, s[8:11], s30 offen sc1 lds
    v_mfma_f32_16x16x32_bf16 v[144:147], a[228:231], v[72:75], v[144:147]
    v_mfma_f32_16x16x32_bf16 v[140:143], a[224:227], v[72:75], v[140:143]
    s_add_u32 s30, s31, 57344
    s_add_u32 m0, s54, 65536
    s_nop 0
    buffer_load_dwordx4 v3, s[8:11], s30 offen sc1 lds
    v_mfma_f32_16x16x32_bf16 v[136:139], a[220:223], v[72:75], v[136:139]
    v_mfma_f32_16x16x32_bf16 v[156:159], a[220:223], v[76:79], v[156:159]
    s_add_u32 s30, s31, 58368
    s_add_u32 m0, s54, 66560
    s_nop 0
    buffer_load_dwordx4 v3, s[8:11], s30 offen sc1 lds
    v_mfma_f32_16x16x32_bf16 v[160:163], a[224:227], v[76:79], v[160:163]
    v_mfma_f32_16x16x32_bf16 v[164:167], a[228:231], v[76:79], v[164:167]
    s_add_u32 s30, s31, 59392
    s_add_u32 m0, s54, 67584
    s_nop 0
    buffer_load_dwordx4 v3, s[8:11], s30 offen sc1 lds
    v_mfma_f32_16x16x32_bf16 v[168:171], a[232:235], v[76:79], v[168:171]
    v_mfma_f32_16x16x32_bf16 v[172:175], a[236:239], v[76:79], v[172:175]
    s_add_u32 s30, s31, 60416
    s_add_u32 m0, s54, 68608
    s_nop 0
    buffer_load_dwordx4 v3, s[8:11], s30 offen sc1 lds
    v_mfma_f32_16x16x32_bf16 v[112:115], a[236:239], v[64:67], v[112:115]
    v_mfma_f32_16x16x32_bf16 v[108:111], a[232:235], v[64:67], v[108:111]
    v_mfma_f32_16x16x32_bf16 v[104:107], a[228:231], v[64:67], v[104:107]
    v_mfma_f32_16x16x32_bf16 v[100:103], a[224:227], v[64:67], v[100:103]
    v_mfma_f32_16x16x32_bf16 v[96:99], a[220:223], v[64:67], v[96:99]
    s_waitcnt vmcnt(24)
    s_lshl_b32 s56, s20, 2
    s_add_u32 s56, s56, s32
    s_add_u32 s56, s56, 64
    s_mov_b32 s57, s21
    s_lshl_b32 s56, s56, 10
    s_lshl_b32 s57, s57, 5
    s_add_u32 s56, s56, s57
    s_add_u32 s56, s56, 37359616
    v_mov_b32 v250, s100
    v_mov_b32 v251, s101
    s_mov_b64 exec, 1
    buffer_store_dwordx2 v[250:251], v3, s[8:11], s56 offen sc1
    s_mov_b64 exec, -1
    s_waitcnt vmcnt(21)
    v_mfma_f32_16x16x32_bf16 v[116:119], a[240:243], a[100:103], v[116:119]
    v_mfma_f32_16x16x32_bf16 v[120:123], a[244:247], a[100:103], v[120:123]
    v_mfma_f32_16x16x32_bf16 v[124:127], a[248:251], a[100:103], v[124:127]
    v_mfma_f32_16x16x32_bf16 v[128:131], a[252:255], a[100:103], v[128:131]
    v_mfma_f32_16x16x32_bf16 v[132:135], v[196:199], a[100:103], v[132:135]
    v_mfma_f32_16x16x32_bf16 v[152:155], v[196:199], a[104:107], v[152:155]
    v_mfma_f32_16x16x32_bf16 v[148:151], a[252:255], a[104:107], v[148:151]
    v_mfma_f32_16x16x32_bf16 v[144:147], a[248:251], a[104:107], v[144:147]
    v_mfma_f32_16x16x32_bf16 v[140:143], a[244:247], a[104:107], v[140:143]
    v_mfma_f32_16x16x32_bf16 v[136:139], a[240:243], a[104:107], v[136:139]
    v_mfma_f32_16x16x32_bf16 v[156:159], a[240:243], a[108:111], v[156:159]
    v_mfma_f32_16x16x32_bf16 v[160:163], a[244:247], a[108:111], v[160:163]
    v_mfma_f32_16x16x32_bf16 v[164:167], a[248:251], a[108:111], v[164:167]
    v_mfma_f32_16x16x32_bf16 v[168:171], a[252:255], a[108:111], v[168:171]
    v_mfma_f32_16x16x32_bf16 v[172:175], v[196:199], a[108:111], v[172:175]
    v_mfma_f32_16x16x32_bf16 v[112:115], v[196:199], a[96:99], v[112:115]
    v_mfma_f32_16x16x32_bf16 v[108:111], a[252:255], a[96:99], v[108:111]
    v_mfma_f32_16x16x32_bf16 v[104:107], a[248:251], a[96:99], v[104:107]
    v_mfma_f32_16x16x32_bf16 v[100:103], a[244:247], a[96:99], v[100:103]
    v_mfma_f32_16x16x32_bf16 v[96:99], a[240:243], a[96:99], v[96:99]
    s_waitcnt vmcnt(17)
    v_mfma_f32_16x16x32_bf16 v[116:119], v[200:203], a[116:119], v[116:119]
    buffer_load_dwordx4 v[240:243], v3, s[8:11], s45 offen sc1
    v_mfma_f32_16x16x32_bf16 v[120:123], v[204:207], a[116:119], v[120:123]
    v_mfma_f32_16x16x32_bf16 v[124:127], v[208:211], a[116:119], v[124:127]
    buffer_load_dwordx4 v[244:247], v3, s[8:11], s45 offen offset:1024 sc1
    v_mfma_f32_16x16x32_bf16 v[128:131], v[212:215], a[116:119], v[128:131]
    v_mfma_f32_16x16x32_bf16 v[132:135], v[216:219], a[116:119], v[132:135]
    buffer_load_dwordx2 v[248:249], v5, s[8:11], s45 offen offset:2048 sc1
    v_mfma_f32_16x16x32_bf16 v[152:155], v[216:219], a[120:123], v[152:155]
    v_mfma_f32_16x16x32_bf16 v[148:151], v[212:215], a[120:123], v[148:151]
    v_mfma_f32_16x16x32_bf16 v[144:147], v[208:211], a[120:123], v[144:147]
    v_mfma_f32_16x16x32_bf16 v[140:143], v[204:207], a[120:123], v[140:143]
    v_mfma_f32_16x16x32_bf16 v[136:139], v[200:203], a[120:123], v[136:139]
    v_mfma_f32_16x16x32_bf16 v[156:159], v[200:203], a[124:127], v[156:159]
    v_mfma_f32_16x16x32_bf16 v[160:163], v[204:207], a[124:127], v[160:163]
    v_mfma_f32_16x16x32_bf16 v[164:167], v[208:211], a[124:127], v[164:167]
    v_mfma_f32_16x16x32_bf16 v[168:171], v[212:215], a[124:127], v[168:171]
    v_mfma_f32_16x16x32_bf16 v[172:175], v[216:219], a[124:127], v[172:175]
    s_waitcnt vmcnt(16)
    v_mfma_f32_16x16x32_bf16 v[116:119], v[220:223], a[132:135], v[116:119]
    v_mfma_f32_16x16x32_bf16 v[120:123], v[224:227], a[132:135], v[120:123]
    v_mfma_f32_16x16x32_bf16 v[124:127], v[228:231], a[132:135], v[124:127]
    v_mfma_f32_16x16x32_bf16 v[128:131], v[232:235], a[132:135], v[128:131]
    v_mfma_f32_16x16x32_bf16 v[132:135], v[236:239], a[132:135], v[132:135]
    v_mfma_f32_16x16x32_bf16 v[152:155], v[236:239], a[136:139], v[152:155]
    v_mfma_f32_16x16x32_bf16 v[148:151], v[232:235], a[136:139], v[148:151]
    v_mfma_f32_16x16x32_bf16 v[144:147], v[228:231], a[136:139], v[144:147]
    v_mfma_f32_16x16x32_bf16 v[140:143], v[224:227], a[136:139], v[140:143]
    v_mfma_f32_16x16x32_bf16 v[136:139], v[220:223], a[136:139], v[136:139]
    v_mfma_f32_16x16x32_bf16 v[156:159], v[220:223], a[140:143], v[156:159]
    v_mfma_f32_16x16x32_bf16 v[160:163], v[224:227], a[140:143], v[160:163]
    v_mfma_f32_16x16x32_bf16 v[164:167], v[228:231], a[140:143], v[164:167]
    v_mfma_f32_16x16x32_bf16 v[168:171], v[232:235], a[140:143], v[168:171]
    v_mfma_f32_16x16x32_bf16 v[172:175], v[236:239], a[140:143], v[172:175]
    s_waitcnt vmcnt(12)
    v_mfma_f32_16x16x32_bf16 v[116:119], a[0:3], a[148:151], v[116:119]
    v_mfma_f32_16x16x32_bf16 v[120:123], a[4:7], a[148:151], v[120:123]
    v_mfma_f32_16x16x32_bf16 v[124:127], a[8:11], a[148:151], v[124:127]
    v_mfma_f32_16x16x32_bf16 v[128:131], a[12:15], a[148:151], v[128:131]
    v_mfma_f32_16x16x32_bf16 v[132:135], a[16:19], a[148:151], v[132:135]
    v_mfma_f32_16x16x32_bf16 v[152:155], a[16:19], a[152:155], v[152:155]
    v_mfma_f32_16x16x32_bf16 v[148:151], a[12:15], a[152:155], v[148:151]
    v_mfma_f32_16x16x32_bf16 v[144:147], a[8:11], a[152:155], v[144:147]
    v_mfma_f32_16x16x32_bf16 v[140:143], a[4:7], a[152:155], v[140:143]
    v_mfma_f32_16x16x32_bf16 v[136:139], a[0:3], a[152:155], v[136:139]
    v_mfma_f32_16x16x32_bf16 v[156:159], a[0:3], a[156:159], v[156:159]
    v_mfma_f32_16x16x32_bf16 v[160:163], a[4:7], a[156:159], v[160:163]
    v_mfma_f32_16x16x32_bf16 v[164:167], a[8:11], a[156:159], v[164:167]
    v_mfma_f32_16x16x32_bf16 v[168:171], a[12:15], a[156:159], v[168:171]
    v_mfma_f32_16x16x32_bf16 v[172:175], a[16:19], a[156:159], v[172:175]
    s_lshl_b32 s57, s60, 1
    s_lshr_b32 s58, s32, 1
    s_add_u32 s57, s57, s58
    s_add_u32 s57, s57, 64
    s_mov_b32 s58, 0
    s_lshl_b32 s57, s57, 10
    s_lshl_b32 s58, s58, 5
    s_add_u32 s57, s57, s58
    s_add_u32 s59, s57, 37359616
    v_lshlrev_b32 v254, 5, v2
    s_mov_b64 exec, 0xffff
    buffer_load_dwordx2 v[252:253], v254, s[8:11], s59 offen sc1
    s_mov_b64 exec, -1
    v_mfma_f32_16x16x32_bf16 v[96:99], v[200:203], a[112:115], v[96:99]
    ds_write_b128 v10, v[116:119] offset:0
    v_mfma_f32_16x16x32_bf16 v[100:103], v[204:207], a[112:115], v[100:103]
    ds_write_b128 v10, v[120:123] offset:1024
    v_mfma_f32_16x16x32_bf16 v[104:107], v[208:211], a[112:115], v[104:107]
    ds_write_b128 v10, v[124:127] offset:2048
    v_mfma_f32_16x16x32_bf16 v[108:111], v[212:215], a[112:115], v[108:111]
    ds_write_b128 v10, v[128:131] offset:3072
    v_mfma_f32_16x16x32_bf16 v[112:115], v[216:219], a[112:115], v[112:115]
    ds_write_b128 v10, v[132:135] offset:4096
    v_mfma_f32_16x16x32_bf16 v[96:99], v[220:223], a[128:131], v[96:99]
    ds_write_b128 v11, v[136:139] offset:0
    v_mfma_f32_16x16x32_bf16 v[100:103], v[224:227], a[128:131], v[100:103]
    ds_write_b128 v11, v[140:143] offset:1024
    v_mfma_f32_16x16x32_bf16 v[104:107], v[228:231], a[128:131], v[104:107]
    ds_write_b128 v11, v[144:147] offset:2048
    v_mfma_f32_16x16x32_bf16 v[108:111], v[232:235], a[128:131], v[108:111]
    ds_write_b128 v11, v[148:151] offset:3072
    v_mfma_f32_16x16x32_bf16 v[112:115], v[236:239], a[128:131], v[112:115]
    ds_write_b128 v11, v[152:155] offset:4096
    v_mfma_f32_16x16x32_bf16 v[96:99], a[0:3], a[144:147], v[96:99]
    ds_write_b128 v12, v[156:159] offset:0
    v_mfma_f32_16x16x32_bf16 v[100:103], a[4:7], a[144:147], v[100:103]
    ds_write_b128 v12, v[160:163] offset:1024
    v_mfma_f32_16x16x32_bf16 v[104:107], a[8:11], a[144:147], v[104:107]
    ds_write_b128 v12, v[164:167] offset:2048
    v_mfma_f32_16x16x32_bf16 v[108:111], a[12:15], a[144:147], v[108:111]
    ds_write_b128 v12, v[168:171] offset:3072
    v_mfma_f32_16x16x32_bf16 v[112:115], a[16:19], a[144:147], v[112:115]
    ds_write_b128 v12, v[172:175] offset:4096
    s_waitcnt vmcnt(0)
    s_mov_b64 exec, 0xffff
    v_cmp_ne_u64 vcc, s[100:101], v[252:253]
    s_mov_b64 exec, -1
    s_cbranch_vccz chk_12
    s_mov_b64 exec, 0xffff
    s_mov_b32 s58, 0x40000
sync_13_p:
    buffer_load_dwordx2 v[252:253], v254, s[8:11], s59 offen sc1
    s_sub_u32 s58, s58, 1
    s_waitcnt vmcnt(0)
    v_cmp_ne_u64 vcc, s[100:101], v[252:253]
    s_cbranch_scc1 sync_13_x
    s_cbranch_vccnz sync_13_p
sync_13_x:
    s_mov_b64 exec, -1
chk_12:
    s_add_u32 s17, s55, 0
    buffer_load_dwordx4 v[16:19], v3, s[8:11], s17 offen sc1
    s_add_u32 s17, s55, 3072
    buffer_load_dwordx4 v[20:23], v3, s[8:11], s17 offen sc1
    s_add_u32 s17, s55, 6144
    buffer_load_dwordx4 v[24:27], v3, s[8:11], s17 offen sc1
    s_add_u32 s17, s55, 9216
    buffer_load_dwordx4 v[28:31], v3, s[8:11], s17 offen sc1
    s_add_u32 s17, s55, 12288
    buffer_load_dwordx4 v[32:35], v3, s[8:11], s17 offen sc1
    s_add_u32 s17, s55, 15360
    buffer_load_dwordx4 v[36:39], v3, s[8:11], s17 offen sc1
    s_add_u32 s17, s55, 18432
    buffer_load_dwordx4 v[40:43], v3, s[8:11], s17 offen sc1
    s_add_u32 s17, s55, 21504
    buffer_load_dwordx4 v[44:47], v3, s[8:11], s17 offen sc1
    s_add_u32 s17, s55, 24576
    buffer_load_dwordx4 v[48:51], v3, s[8:11], s17 offen sc1
    s_add_u32 s17, s55, 27648
    buffer_load_dwordx4 v[52:55], v3, s[8:11], s17 offen sc1
    s_add_u32 s17, s55, 30720
    buffer_load_dwordx4 v[56:59], v3, s[8:11], s17 offen sc1
    s_add_u32 s17, s55, 33792
    buffer_load_dwordx4 v[60:63], v3, s[8:11], s17 offen sc1
    s_add_u32 s17, s55, 36864
    buffer_load_dwordx4 v[64:67], v3, s[8:11], s17 offen sc1
    s_add_u32 s17, s55, 39936
    buffer_load_dwordx4 v[68:71], v3, s[8:11], s17 offen sc1
    s_add_u32 s17, s55, 43008
    buffer_load_dwordx4 v[72:75], v3, s[8:11], s17 offen sc1
    s_add_u32 s17, s55, 46080
    buffer_load_dwordx4 v[76:79], v3, s[8:11], s17 offen sc1
    s_waitcnt vmcnt(17)
    s_waitcnt lgkmcnt(0)
    s_barrier
    ds_read_b128 v[116:119], v13 offset:0
    ds_read_b128 v[120:123], v13 offset:1024
    ds_read_b128 v[124:127], v13 offset:2048
    ds_read_b128 v[128:131], v13 offset:3072
    ds_read_b128 v[132:135], v13 offset:4096
    ds_read_b128 v[136:139], v13 offset:5120
    ds_read_b128 v[140:143], v13 offset:6144
    ds_read_b128 v[144:147], v13 offset:7168
    ds_read_b128 v[148:151], v13 offset:8192
    ds_read_b128 v[152:155], v13 offset:9216
    ds_read_b128 v[156:159], v13 offset:10240
    ds_read_b128 v[160:163], v13 offset:11264
    ds_read_b128 v[164:167], v13 offset:12288
    ds_read_b128 v[168:171], v13 offset:13312
    ds_read_b128 v[172:175], v13 offset:14336
    v_lshlrev_b32 v250, 16, v240
    v_and_b32 v251, 0xffff0000, v240
    v_add_f32 v96, v96, v250
    v_add_f32 v97, v97, v251
    v_lshlrev_b32 v250, 16, v241
    v_and_b32 v251, 0xffff0000, v241
    v_add_f32 v98, v98, v250
    v_add_f32 v99, v99, v251
    v_lshlrev_b32 v250, 16, v242
    v_and_b32 v251, 0xffff0000, v242
    v_add_f32 v100, v100, v250
    v_add_f32 v101, v101, v251
    v_lshlrev_b32 v250, 16, v243
    v_and_b32 v251, 0xffff0000, v243
    v_add_f32 v102, v102, v250
    v_add_f32 v103, v103, v251
    v_lshlrev_b32 v250, 16, v244
    v_and_b32 v251, 0xffff0000, v244
    v_add_f32 v104, v104, v250
    v_add_f32 v105, v105, v251
    v_lshlrev_b32 v250, 16, v245
    v_and_b32 v251, 0xffff0000, v245
    v_add_f32 v106, v106, v250
    v_add_f32 v107, v107, v251
    v_lshlrev_b32 v250, 16, v246
    v_and_b32 v251, 0xffff0000, v246
    v_add_f32 v108, v108, v250
    v_add_f32 v109, v109, v251
    v_lshlrev_b32 v250, 16, v247
    v_and_b32 v251, 0xffff0000, v247
    v_add_f32 v110, v110, v250
    v_add_f32 v111, v111, v251
    v_lshlrev_b32 v250, 16, v248
    v_and_b32 v251, 0xffff0000, v248
    v_add_f32 v112, v112, v250
    v_add_f32 v113, v113, v251
    v_lshlrev_b32 v250, 16, v249
    v_and_b32 v251, 0xffff0000, v249
    v_add_f32 v114, v114, v250
    v_add_f32 v115, v115, v251
    s_waitcnt lgkmcnt(10)
    v_add_f32 v96, v96, v116
    v_add_f32 v97, v97, v117
    v_add_f32 v98, v98, v118
    v_add_f32 v99, v99, v119
    v_add_f32 v100, v100, v120
    v_add_f32 v101, v101, v121
    v_add_f32 v102, v102, v122
    v_add_f32 v103, v103, v123
    v_add_f32 v104, v104, v124
    v_add_f32 v105, v105, v125
    v_add_f32 v106, v106, v126
    v_add_f32 v107, v107, v127
    v_add_f32 v108, v108, v128
    v_add_f32 v109, v109, v129
    v_add_f32 v110, v110, v130
    v_add_f32 v111, v111, v131
    v_add_f32 v112, v112, v132
    v_add_f32 v113, v113, v133
    v_add_f32 v114, v114, v134
    v_add_f32 v115, v115, v135
    s_waitcnt lgkmcnt(5)
    v_add_f32 v96, v96, v136
    v_add_f32 v97, v97, v137
    v_add_f32 v98, v98, v138
    v_add_f32 v99, v99, v139
    v_add_f32 v100, v100, v140
    v_add_f32 v101, v101, v141
    v_add_f32 v102, v102, v142
    v_add_f32 v103, v103, v143
    v_add_f32 v104, v104, v144
    v_add_f32 v105, v105, v145
    v_add_f32 v106, v106, v146
    v_add_f32 v107, v107, v147
    v_add_f32 v108, v108, v148
    v_add_f32 v109, v109, v149
    v_add_f32 v110, v110, v150
    v_add_f32 v111, v111, v151
    v_add_f32 v112, v112, v152
    v_add_f32 v113, v113, v153
    v_add_f32 v114, v114, v154
    v_add_f32 v115, v115, v155
    s_waitcnt lgkmcnt(0)
    v_add_f32 v96, v96, v156
    v_add_f32 v97, v97, v157
    v_add_f32 v98, v98, v158
    v_add_f32 v99, v99, v159
    v_add_f32 v100, v100, v160
    v_add_f32 v101, v101, v161
    v_add_f32 v102, v102, v162
    v_add_f32 v103, v103, v163
    v_add_f32 v104, v104, v164
    v_add_f32 v105, v105, v165
    v_add_f32 v106, v106, v166
    v_add_f32 v107, v107, v167
    v_add_f32 v108, v108, v168
    v_add_f32 v109, v109, v169
    v_add_f32 v110, v110, v170
    v_add_f32 v111, v111, v171
    v_add_f32 v112, v112, v172
    v_add_f32 v113, v113, v173
    v_add_f32 v114, v114, v174
    v_add_f32 v115, v115, v175
    ds_read_b128 v[116:119], v15 offset:0
    ds_read_b128 v[120:123], v15 offset:1024
    ds_read_b128 v[124:127], v15 offset:2048
    ds_read_b128 v[128:131], v15 offset:3072
    ds_read_b128 v[132:135], v15 offset:4096
    ds_read_b128 v[136:139], v15 offset:5120
    ds_read_b128 v[140:143], v15 offset:6144
    ds_read_b128 v[144:147], v15 offset:7168
    ds_read_b128 v[148:151], v15 offset:8192
    ds_read_b128 v[152:155], v15 offset:9216
    s_waitcnt vmcnt(15)
    s_waitcnt lgkmcnt(9)
    v_mfma_f32_16x16x32_bf16 v[96:99], v[116:119], v[16:19], v[96:99]
    ds_read_b128 v[156:159], v15 offset:10240
    s_waitcnt lgkmcnt(9)
    v_mfma_f32_16x16x32_bf16 v[100:103], v[120:123], v[16:19], v[100:103]
    ds_read_b128 v[160:163], v15 offset:11264
    s_waitcnt lgkmcnt(9)
    v_mfma_f32_16x16x32_bf16 v[104:107], v[124:127], v[16:19], v[104:107]
    ds_read_b128 v[116:119], v14 offset:0
    s_waitcnt lgkmcnt(9)
    v_mfma_f32_16x16x32_bf16 v[108:111], v[128:131], v[16:19], v[108:111]
    ds_read_b128 v[120:123], v14 offset:1024
    s_waitcnt lgkmcnt(9)
    v_mfma_f32_16x16x32_bf16 v[112:115], v[132:135], v[16:19], v[112:115]
    ds_read_b128 v[124:127], v14 offset:2048
    s_waitcnt vmcnt(14)
    s_waitcnt lgkmcnt(9)
    v_mfma_f32_16x16x32_bf16 v[96:99], v[136:139], v[20:23], v[96:99]
    ds_read_b128 v[128:131], v14 offset:3072
    s_waitcnt lgkmcnt(9)
    v_mfma_f32_16x16x32_bf16 v[100:103], v[140:143], v[20:23], v[100:103]
    ds_read_b128 v[132:135], v14 offset:4096
    s_waitcnt lgkmcnt(9)
    v_mfma_f32_16x16x32_bf16 v[104:107], v[144:147], v[20:23], v[104:107]
    ds_read_b128 v[136:139], v14 offset:5120
    s_waitcnt lgkmcnt(9)
    v_mfma_f32_16x16x32_bf16 v[108:111], v[148:151], v[20:23], v[108:111]
    ds_read_b128 v[140:143], v14 offset:6144
    s_waitcnt lgkmcnt(9)
    v_mfma_f32_16x16x32_bf16 v[112:115], v[152:155], v[20:23], v[112:115]
    ds_read_b128 v[144:147], v14 offset:7168
    s_waitcnt vmcnt(13)
    s_waitcnt lgkmcnt(9)
    v_mfma_f32_16x16x32_bf16 v[96:99], v[156:159], v[24:27], v[96:99]
    ds_read_b128 v[148:151], v15 offset:12288
    s_waitcnt lgkmcnt(9)
    v_mfma_f32_16x16x32_bf16 v[100:103], v[160:163], v[24:27], v[100:103]
    ds_read_b128 v[152:155], v15 offset:13312
    s_waitcnt lgkmcnt(9)
    v_mfma_f32_16x16x32_bf16 v[104:107], v[116:119], v[24:27], v[104:107]
    ds_read_b128 v[156:159], v15 offset:14336
    s_waitcnt lgkmcnt(9)
    v_mfma_f32_16x16x32_bf16 v[108:111], v[120:123], v[24:27], v[108:111]
    ds_read_b128 v[160:163], v15 offset:15360
    s_waitcnt lgkmcnt(9)
    v_mfma_f32_16x16x32_bf16 v[112:115], v[124:127], v[24:27], v[112:115]
    ds_read_b128 v[116:119], v15 offset:16384
    s_waitcnt vmcnt(12)
    s_waitcnt lgkmcnt(9)
    v_mfma_f32_16x16x32_bf16 v[96:99], v[128:131], v[28:31], v[96:99]
    ds_read_b128 v[120:123], v15 offset:17408
    s_waitcnt lgkmcnt(9)
    v_mfma_f32_16x16x32_bf16 v[100:103], v[132:135], v[28:31], v[100:103]
    ds_read_b128 v[124:127], v15 offset:18432
    s_waitcnt lgkmcnt(9)
    v_mfma_f32_16x16x32_bf16 v[104:107], v[136:139], v[28:31], v[104:107]
    ds_read_b128 v[128:131], v15 offset:19456
    s_waitcnt lgkmcnt(9)
    v_mfma_f32_16x16x32_bf16 v[108:111], v[140:143], v[28:31], v[108:111]
    ds_read_b128 v[132:135], v15 offset:20480
    s_waitcnt lgkmcnt(9)
    v_mfma_f32_16x16x32_bf16 v[112:115], v[144:147], v[28:31], v[112:115]
    ds_read_b128 v[136:139], v15 offset:21504
    s_waitcnt vmcnt(11)
    s_waitcnt lgkmcnt(9)
    v_mfma_f32_16x16x32_bf16 v[96:99], v[148:151], v[32:35], v[96:99]
    ds_read_b128 v[140:143], v15 offset:22528
    s_waitcnt lgkmcnt(9)
    v_mfma_f32_16x16x32_bf16 v[100:103], v[152:155], v[32:35], v[100:103]
    ds_read_b128 v[144:147], v15 offset:23552
    s_waitcnt lgkmcnt(9)
    v_mfma_f32_16x16x32_bf16 v[104:107], v[156:159], v[32:35], v[104:107]
    ds_read_b128 v[148:151], v14 offset:8192
    s_waitcnt lgkmcnt(9)
    v_mfma_f32_16x16x32_bf16 v[108:111], v[160:163], v[32:35], v[108:111]
    ds_read_b128 v[152:155], v14 offset:9216
    s_waitcnt lgkmcnt(9)
    v_mfma_f32_16x16x32_bf16 v[112:115], v[116:119], v[32:35], v[112:115]
    ds_read_b128 v[156:159], v14 offset:10240
    s_waitcnt vmcnt(10)
    s_waitcnt lgkmcnt(9)
    v_mfma_f32_16x16x32_bf16 v[96:99], v[120:123], v[36:39], v[96:99]
    ds_read_b128 v[160:163], v14 offset:11264
    s_waitcnt lgkmcnt(9)
    v_mfma_f32_16x16x32_bf16 v[100:103], v[124:127], v[36:39], v[100:103]
    ds_read_b128 v[116:119], v14 offset:12288
    s_waitcnt lgkmcnt(9)
    v_mfma_f32_16x16x32_bf16 v[104:107], v[128:131], v[36:39], v[104:107]
    ds_read_b128 v[120:123], v14 offset:13312
    s_waitcnt lgkmcnt(9)
    v_mfma_f32_16x16x32_bf16 v[108:111], v[132:135], v[36:39], v[108:111]
    ds_read_b128 v[124:127], v14 offset:14336
    s_waitcnt lgkmcnt(9)
    v_mfma_f32_16x16x32_bf16 v[112:115], v[136:139], v[36:39], v[112:115]
    ds_read_b128 v[128:131], v14 offset:15360
    s_waitcnt vmcnt(9)
    s_waitcnt lgkmcnt(9)
    v_mfma_f32_16x16x32_bf16 v[96:99], v[140:143], v[40:43], v[96:99]
    ds_read_b128 v[132:135], v15 offset:24576
    s_waitcnt lgkmcnt(9)
    v_mfma_f32_16x16x32_bf16 v[100:103], v[144:147], v[40:43], v[100:103]
    ds_read_b128 v[136:139], v15 offset:25600
    s_waitcnt lgkmcnt(9)
    v_mfma_f32_16x16x32_bf16 v[104:107], v[148:151], v[40:43], v[104:107]
    ds_read_b128 v[140:143], v15 offset:26624
    s_waitcnt lgkmcnt(9)
    v_mfma_f32_16x16x32_bf16 v[108:111], v[152:155], v[40:43], v[108:111]
    ds_read_b128 v[144:147], v15 offset:27648
    s_waitcnt lgkmcnt(9)
    v_mfma_f32_16x16x32_bf16 v[112:115], v[156:159], v[40:43], v[112:115]
    ds_read_b128 v[148:151], v15 offset:28672
    s_waitcnt vmcnt(8)
    s_waitcnt lgkmcnt(9)
    v_mfma_f32_16x16x32_bf16 v[96:99], v[160:163], v[44:47], v[96:99]
    ds_read_b128 v[152:155], v15 offset:29696
    s_waitcnt lgkmcnt(9)
    v_mfma_f32_16x16x32_bf16 v[100:103], v[116:119], v[44:47], v[100:103]
    ds_read_b128 v[156:159], v15 offset:30720
    s_waitcnt lgkmcnt(9)
    v_mfma_f32_16x16x32_bf16 v[104:107], v[120:123], v[44:47], v[104:107]
    ds_read_b128 v[160:163], v15 offset:31744
    s_waitcnt lgkmcnt(9)
    v_mfma_f32_16x16x32_bf16 v[108:111], v[124:127], v[44:47], v[108:111]
    ds_read_b128 v[116:119], v15 offset:32768
    s_waitcnt lgkmcnt(9)
    v_mfma_f32_16x16x32_bf16 v[112:115], v[128:131], v[44:47], v[112:115]
    ds_read_b128 v[120:123], v15 offset:33792
    s_waitcnt vmcnt(7)
    s_waitcnt lgkmcnt(9)
    v_mfma_f32_16x16x32_bf16 v[96:99], v[132:135], v[48:51], v[96:99]
    ds_read_b128 v[124:127], v15 offset:34816
    s_waitcnt lgkmcnt(9)
    v_mfma_f32_16x16x32_bf16 v[100:103], v[136:139], v[48:51], v[100:103]
    ds_read_b128 v[128:131], v15 offset:35840
    s_waitcnt lgkmcnt(9)
    v_mfma_f32_16x16x32_bf16 v[104:107], v[140:143], v[48:51], v[104:107]
    ds_read_b128 v[132:135], v14 offset:16384
    s_waitcnt lgkmcnt(9)
    v_mfma_f32_16x16x32_bf16 v[108:111], v[144:147], v[48:51], v[108:111]
    ds_read_b128 v[136:139], v14 offset:17408
    s_waitcnt lgkmcnt(9)
    v_mfma_f32_16x16x32_bf16 v[112:115], v[148:151], v[48:51], v[112:115]
    ds_read_b128 v[140:143], v14 offset:18432
    s_waitcnt vmcnt(6)
    s_waitcnt lgkmcnt(9)
    v_mfma_f32_16x16x32_bf16 v[96:99], v[152:155], v[52:55], v[96:99]
    ds_read_b128 v[144:147], v14 offset:19456
    s_waitcnt lgkmcnt(9)
    v_mfma_f32_16x16x32_bf16 v[100:103], v[156:159], v[52:55], v[100:103]
    ds_read_b128 v[148:151], v14 offset:20480
    s_waitcnt lgkmcnt(9)
    v_mfma_f32_16x16x32_bf16 v[104:107], v[160:163], v[52:55], v[104:107]
    ds_read_b128 v[152:155], v14 offset:21504
    s_waitcnt lgkmcnt(9)
    v_mfma_f32_16x16x32_bf16 v[108:111], v[116:119], v[52:55], v[108:111]
    ds_read_b128 v[156:159], v14 offset:22528
    s_waitcnt lgkmcnt(9)
    v_mfma_f32_16x16x32_bf16 v[112:115], v[120:123], v[52:55], v[112:115]
    ds_read_b128 v[160:163], v14 offset:23552
    s_waitcnt vmcnt(5)
    s_waitcnt lgkmcnt(9)
    v_mfma_f32_16x16x32_bf16 v[96:99], v[124:127], v[56:59], v[96:99]
    ds_read_b128 v[116:119], v15 offset:36864
    s_waitcnt lgkmcnt(9)
    v_mfma_f32_16x16x32_bf16 v[100:103], v[128:131], v[56:59], v[100:103]
    ds_read_b128 v[120:123], v15 offset:37888
    s_waitcnt lgkmcnt(9)
    v_mfma_f32_16x16x32_bf16 v[104:107], v[132:135], v[56:59], v[104:107]
    ds_read_b128 v[124:127], v15 offset:38912
    s_waitcnt lgkmcnt(9)
    v_mfma_f32_16x16x32_bf16 v[108:111], v[136:139], v[56:59], v[108:111]
    ds_read_b128 v[128:131], v15 offset:39936
    s_waitcnt lgkmcnt(9)
    v_mfma_f32_16x16x32_bf16 v[112:115], v[140:143], v[56:59], v[112:115]
    ds_read_b128 v[132:135], v15 offset:40960
    s_waitcnt vmcnt(4)
    s_waitcnt lgkmcnt(9)
    v_mfma_f32_16x16x32_bf16 v[96:99], v[144:147], v[60:63], v[96:99]
    ds_read_b128 v[136:139], v15 offset:41984
    s_waitcnt lgkmcnt(9)
    v_mfma_f32_16x16x32_bf16 v[100:103], v[148:151], v[60:63], v[100:103]
    ds_read_b128 v[140:143], v15 offset:43008
    s_waitcnt lgkmcnt(9)
    v_mfma_f32_16x16x32_bf16 v[104:107], v[152:155], v[60:63], v[104:107]
    ds_read_b128 v[144:147], v15 offset:44032
    s_waitcnt lgkmcnt(9)
    v_mfma_f32_16x16x32_bf16 v[108:111], v[156:159], v[60:63], v[108:111]
    ds_read_b128 v[148:151], v15 offset:45056
    s_waitcnt lgkmcnt(9)
    v_mfma_f32_16x16x32_bf16 v[112:115], v[160:163], v[60:63], v[112:115]
    ds_read_b128 v[152:155], v15 offset:46080
    s_waitcnt vmcnt(3)
    s_waitcnt lgkmcnt(9)
    v_mfma_f32_16x16x32_bf16 v[96:99], v[116:119], v[64:67], v[96:99]
    ds_read_b128 v[156:159], v15 offset:47104
    s_waitcnt lgkmcnt(9)
    v_mfma_f32_16x16x32_bf16 v[100:103], v[120:123], v[64:67], v[100:103]
    ds_read_b128 v[160:163], v15 offset:48128
    s_waitcnt lgkmcnt(9)
    v_mfma_f32_16x16x32_bf16 v[104:107], v[124:127], v[64:67], v[104:107]
    ds_read_b128 v[116:119], v14 offset:24576
    s_waitcnt lgkmcnt(9)
    v_mfma_f32_16x16x32_bf16 v[108:111], v[128:131], v[64:67], v[108:111]
    ds_read_b128 v[120:123], v14 offset:25600
    s_waitcnt lgkmcnt(9)
    v_mfma_f32_16x16x32_bf16 v[112:115], v[132:135], v[64:67], v[112:115]
    ds_read_b128 v[124:127], v14 offset:26624
    s_waitcnt vmcnt(2)
    s_waitcnt lgkmcnt(9)
    v_mfma_f32_16x16x32_bf16 v[96:99], v[136:139], v[68:71], v[96:99]
    ds_read_b128 v[128:131], v14 offset:27648
    s_waitcnt lgkmcnt(9)
    v_mfma_f32_16x16x32_bf16 v[100:103], v[140:143], v[68:71], v[100:103]
    ds_read_b128 v[132:135], v14 offset:28672
    s_waitcnt lgkmcnt(9)
    v_mfma_f32_16x16x32_bf16 v[104:107], v[144:147], v[68:71], v[104:107]
    ds_read_b128 v[136:139], v14 offset:29696
    s_waitcnt lgkmcnt(9)
    v_mfma_f32_16x16x32_bf16 v[108:111], v[148:151], v[68:71], v[108:111]
    ds_read_b128 v[140:143], v14 offset:30720
    s_waitcnt lgkmcnt(9)
    v_mfma_f32_16x16x32_bf16 v[112:115], v[152:155], v[68:71], v[112:115]
    ds_read_b128 v[144:147], v14 offset:31744
    s_waitcnt vmcnt(1)
    s_waitcnt lgkmcnt(9)
    v_mfma_f32_16x16x32_bf16 v[96:99], v[156:159], v[72:75], v[96:99]
    s_waitcnt lgkmcnt(8)
    v_mfma_f32_16x16x32_bf16 v[100:103], v[160:163], v[72:75], v[100:103]
    s_waitcnt lgkmcnt(7)
    v_mfma_f32_16x16x32_bf16 v[104:107], v[116:119], v[72:75], v[104:107]
    s_waitcnt lgkmcnt(6)
    v_mfma_f32_16x16x32_bf16 v[108:111], v[120:123], v[72:75], v[108:111]
    s_waitcnt lgkmcnt(5)
    v_mfma_f32_16x16x32_bf16 v[112:115], v[124:127], v[72:75], v[112:115]
    s_waitcnt vmcnt(0)
    s_waitcnt lgkmcnt(4)
    v_mfma_f32_16x16x32_bf16 v[96:99], v[128:131], v[76:79], v[96:99]
    s_waitcnt lgkmcnt(3)
    v_mfma_f32_16x16x32_bf16 v[100:103], v[132:135], v[76:79], v[100:103]
    s_waitcnt lgkmcnt(2)
    v_mfma_f32_16x16x32_bf16 v[104:107], v[136:139], v[76:79], v[104:107]
    s_waitcnt lgkmcnt(1)
    v_mfma_f32_16x16x32_bf16 v[108:111], v[140:143], v[76:79], v[108:111]
    s_waitcnt lgkmcnt(0)
    v_mfma_f32_16x16x32_bf16 v[112:115], v[144:147], v[76:79], v[112:115]
    v_cvt_pk_bf16_f32 v240, v96, v97
    v_cvt_pk_bf16_f32 v241, v98, v99
    v_cvt_pk_bf16_f32 v242, v100, v101
    v_cvt_pk_bf16_f32 v243, v102, v103
    v_cvt_pk_bf16_f32 v244, v104, v105
    v_cvt_pk_bf16_f32 v245, v106, v107
    v_cvt_pk_bf16_f32 v246, v108, v109
    v_cvt_pk_bf16_f32 v247, v110, v111
    v_cvt_pk_bf16_f32 v248, v112, v113
    v_cvt_pk_bf16_f32 v249, v114, v115
    buffer_store_dwordx4 v[240:243], v3, s[8:11], s44 offen sc1
    buffer_store_dwordx4 v[244:247], v3, s[8:11], s44 offen offset:1024 sc1
    buffer_store_dwordx2 v[248:249], v5, s[8:11], s44 offen offset:2048 sc1
    v_mov_b32 v82, 0x3f803f80
    v_dot2_f32_bf16 v80, v240, v82, 0
    v_dot2_f32_bf16 v81, v240, v240, 0
    v_dot2_f32_bf16 v80, v241, v82, v80
    v_dot2_f32_bf16 v81, v241, v241, v81
    v_dot2_f32_bf16 v80, v242, v82, v80
    v_dot2_f32_bf16 v81, v242, v242, v81
    v_dot2_f32_bf16 v80, v243, v82, v80
    v_dot2_f32_bf16 v81, v243, v243, v81
    v_dot2_f32_bf16 v80, v244, v82, v80
    v_dot2_f32_bf16 v81, v244, v244, v81
    v_dot2_f32_bf16 v80, v245, v82, v80
    v_dot2_f32_bf16 v81, v245, v245, v81
    v_dot2_f32_bf16 v80, v246, v82, v80
    v_dot2_f32_bf16 v81, v246, v246, v81
    v_dot2_f32_bf16 v80, v247, v82, v80
    v_dot2_f32_bf16 v81, v247, v247, v81
    v_dot2_f32_bf16 v80, v248, v82, v80
    v_dot2_f32_bf16 v81, v248, v248, v81
    v_dot2_f32_bf16 v80, v249, v82, v80
    v_dot2_f32_bf16 v81, v249, v249, v81
    s_lshl_b32 s33, s60, 2
    s_add_u32 s33, s33, s32
    s_lshl_b32 s33, s33, 3
    s_add_u32 s33, s33, s61
    s_lshl_b32 s33, s33, 7
    s_add_u32 s33, s33, 13893632
    v_lshlrev_b32 v83, 3, v8
    v_mov_b32 v84, v80
    v_mov_b32 v85, v81
    s_nop 0
    v_permlane16_swap_b32 v80, v84
    v_permlane16_swap_b32 v81, v85
    v_add_f32 v80, v80, v84
    v_add_f32 v81, v81, v85
    v_mov_b32 v84, v80
    v_mov_b32 v85, v81
    s_nop 0
    v_permlane32_swap_b32 v80, v84
    v_permlane32_swap_b32 v81, v85
    v_add_f32 v80, v80, v84
    v_add_f32 v81, v81, v85
    s_mov_b64 exec, 0xffff
    buffer_store_dwordx2 v[80:81], v83, s[8:11], s33 offen sc1
    s_mov_b64 exec, -1
    s_barrier
    v_lshrrev_b32 v23, 2, v8
    v_bfe_u32 v24, v8, 1, 1
    v_and_b32 v25, 1, v8
    s_mul_i32 s43, s24, 40
    s_add_u32 s43, s43, 1
    v_lshlrev_b32 v26, 3, v23
    v_add3_u32 v26, v26, v24, s43
    v_lshlrev_b32 v27, 1, v23
    v_add3_u32 v27, v27, v24, s43
    v_add_u32 v27, 32, v27
    v_cvt_f32_u32 v26, v26
    v_cvt_f32_u32 v27, v27
    v_add_f32 v28, 0x00000000, v26
    v_mul_f32 v12, 0x3acccccd, v28
    v_add_f32 v28, 0x40000000, v26
    v_mul_f32 v13, 0x3acccccd, v28
    v_add_f32 v28, 0x40800000, v26
    v_mul_f32 v14, 0x3acccccd, v28
    v_add_f32 v28, 0x40c00000, v26
    v_mul_f32 v15, 0x3acccccd, v28
    v_mul_f32 v16, 0x3acccccd, v27
    v_cvt_f32_u32 v17, v25
    v_mul_f32 v17, 0x3e800000, v17
    v_lshlrev_b32 v28, 3, v4
    v_lshl_add_u32 v28, v1, 1, v28
    v_cvt_f32_u32 v28, v28
    v_add_f32 v18, 0x00000000, v28
    v_add_f32 v19, 0x42000000, v28
    v_add_f32 v20, 0x42800000, v28
    v_add_f32 v21, 0x42c00000, v28
    v_add_f32 v22, 0x43000000, v28
    v_lshl_add_u32 v27, v1, 2, v3
    v_add_u32 v27, 98304, v27
    v_fma_f32 v28, v12, v18, v17
    v_add_f32 v29, v28, v12
    v_cos_f32 v28, v28
    v_cos_f32 v29, v29
    s_nop 0
    v_cvt_pk_bf16_f32 v30, v28, v29
    ds_write_b32 v27, v30 offset:0
    v_fma_f32 v31, v12, v19, v17
    v_add_f32 v32, v31, v12
    v_cos_f32 v31, v31
    v_cos_f32 v32, v32
    s_nop 0
    v_cvt_pk_bf16_f32 v33, v31, v32
    ds_write_b32 v27, v33 offset:1024
    v_fma_f32 v34, v12, v20, v17
    v_add_f32 v35, v34, v12
    v_cos_f32 v34, v34
    v_cos_f32 v35, v35
    s_nop 0
    v_cvt_pk_bf16_f32 v36, v34, v35
    ds_write_b32 v27, v36 offset:2048
    v_fma_f32 v37, v12, v21, v17
    v_add_f32 v38, v37, v12
    v_cos_f32 v37, v37
    v_cos_f32 v38, v38
    s_nop 0
    v_cvt_pk_bf16_f32 v39, v37, v38
    ds_write_b32 v27, v39 offset:3072
    v_fma_f32 v28, v12, v22, v17
    v_add_f32 v29, v28, v12
    v_cos_f32 v28, v28
    v_cos_f32 v29, v29
    s_nop 0
    v_cvt_pk_bf16_f32 v30, v28, v29
    ds_write_b32 v27, v30 offset:4096
    v_fma_f32 v31, v13, v18, v17
    v_add_f32 v32, v31, v13
    v_cos_f32 v31, v31
    v_cos_f32 v32, v32
    s_nop 0
    v_cvt_pk_bf16_f32 v33, v31, v32
    ds_write_b32 v27, v33 offset:5120
    s_waitcnt vmcnt(0)
    s_lshl_b32 s56, s60, 2
    s_add_u32 s56, s56, s32
    s_mov_b32 s57, s61
    s_lshl_b32 s56, s56, 10
    s_lshl_b32 s57, s57, 5
    s_add_u32 s56, s56, s57
    s_add_u32 s56, s56, 37490688
    v_mov_b32 v252, s100
    v_mov_b32 v253, s101
    s_mov_b64 exec, 1
    buffer_store_dwordx2 v[252:253], v3, s[8:11], s56 offen sc1
    s_mov_b64 exec, -1
    v_fma_f32 v34, v13, v19, v17
    v_add_f32 v35, v34, v13
    v_cos_f32 v34, v34
    v_cos_f32 v35, v35
    s_nop 0
    v_cvt_pk_bf16_f32 v36, v34, v35
    ds_write_b32 v27, v36 offset:6144
    v_fma_f32 v37, v13, v20, v17
    v_add_f32 v38, v37, v13
    v_cos_f32 v37, v37
    v_cos_f32 v38, v38
    s_nop 0
    v_cvt_pk_bf16_f32 v39, v37, v38
    ds_write_b32 v27, v39 offset:7168
    v_fma_f32 v28, v13, v21, v17
    v_add_f32 v29, v28, v13
    v_cos_f32 v28, v28
    v_cos_f32 v29, v29
    s_nop 0
    v_cvt_pk_bf16_f32 v30, v28, v29
    ds_write_b32 v27, v30 offset:8192
    v_fma_f32 v31, v13, v22, v17
    v_add_f32 v32, v31, v13
    v_cos_f32 v31, v31
    v_cos_f32 v32, v32
    s_nop 0
    v_cvt_pk_bf16_f32 v33, v31, v32
    ds_write_b32 v27, v33 offset:9216
    v_fma_f32 v34, v14, v18, v17
    v_add_f32 v35, v34, v14
    v_cos_f32 v34, v34
    v_cos_f32 v35, v35
    s_nop 0
    v_cvt_pk_bf16_f32 v36, v34, v35
    ds_write_b32 v27, v36 offset:10240
    v_fma_f32 v37, v14, v19, v17
    v_add_f32 v38, v37, v14
    v_cos_f32 v37, v37
    v_cos_f32 v38, v38
    s_nop 0
    v_cvt_pk_bf16_f32 v39, v37, v38
    ds_write_b32 v27, v39 offset:11264
    v_fma_f32 v28, v14, v20, v17
    v_add_f32 v29, v28, v14
    v_cos_f32 v28, v28
    v_cos_f32 v29, v29
    s_nop 0
    v_cvt_pk_bf16_f32 v30, v28, v29
    ds_write_b32 v27, v30 offset:12288
    v_fma_f32 v31, v14, v21, v17
    v_add_f32 v32, v31, v14
    v_cos_f32 v31, v31
    v_cos_f32 v32, v32
    s_nop 0
    v_cvt_pk_bf16_f32 v33, v31, v32
    ds_write_b32 v27, v33 offset:13312
    v_fma_f32 v34, v14, v22, v17
    v_add_f32 v35, v34, v14
    v_cos_f32 v34, v34
    v_cos_f32 v35, v35
    s_nop 0
    v_cvt_pk_bf16_f32 v36, v34, v35
    ds_write_b32 v27, v36 offset:14336
    v_fma_f32 v37, v15, v18, v17
    v_add_f32 v38, v37, v15
    v_cos_f32 v37, v37
    v_cos_f32 v38, v38
    s_nop 0
    v_cvt_pk_bf16_f32 v39, v37, v38
    ds_write_b32 v27, v39 offset:15360
    v_fma_f32 v28, v15, v19, v17
    v_add_f32 v29, v28, v15
    v_cos_f32 v28, v28
    v_cos_f32 v29, v29
    s_nop 0
    v_cvt_pk_bf16_f32 v30, v28, v29
    ds_write_b32 v27, v30 offset:16384
    v_fma_f32 v31, v15, v20, v17
    v_add_f32 v32, v31, v15
    v_cos_f32 v31, v31
    v_cos_f32 v32, v32
    s_nop 0
    v_cvt_pk_bf16_f32 v33, v31, v32
    ds_write_b32 v27, v33 offset:17408
    v_fma_f32 v34, v15, v21, v17
    v_add_f32 v35, v34, v15
    v_cos_f32 v34, v34
    v_cos_f32 v35, v35
    s_nop 0
    v_cvt_pk_bf16_f32 v36, v34, v35
    ds_write_b32 v27, v36 offset:18432
    v_fma_f32 v37, v15, v22, v17
    v_add_f32 v38, v37, v15
    v_cos_f32 v37, v37
    v_cos_f32 v38, v38
    s_nop 0
    v_cvt_pk_bf16_f32 v39, v37, v38
    ds_write_b32 v27, v39 offset:19456
    v_fma_f32 v28, v16, v18, v17
    v_add_f32 v29, v28, v16
    v_cos_f32 v28, v28
    v_cos_f32 v29, v29
    s_nop 0
    v_cvt_pk_bf16_f32 v30, v28, v29
    ds_write_b32 v27, v30 offset:20480
    v_fma_f32 v31, v16, v19, v17
    v_add_f32 v32, v31, v16
    v_cos_f32 v31, v31
    v_cos_f32 v32, v32
    s_nop 0
    v_cvt_pk_bf16_f32 v33, v31, v32
    ds_write_b32 v27, v33 offset:21504
    v_fma_f32 v34, v16, v20, v17
    v_add_f32 v35, v34, v16
    v_cos_f32 v34, v34
    v_cos_f32 v35, v35
    s_nop 0
    v_cvt_pk_bf16_f32 v36, v34, v35
    ds_write_b32 v27, v36 offset:22528
    v_fma_f32 v37, v16, v21, v17
    v_add_f32 v38, v37, v16
    v_cos_f32 v37, v37
    v_cos_f32 v38, v38
    s_nop 0
    v_cvt_pk_bf16_f32 v39, v37, v38
    ds_write_b32 v27, v39 offset:23552
    v_fma_f32 v28, v16, v22, v17
    v_add_f32 v29, v28, v16
    v_cos_f32 v28, v28
    v_cos_f32 v29, v29
    s_nop 0
    v_cvt_pk_bf16_f32 v30, v28, v29
    ds_write_b32 v27, v30 offset:24576
    v_lshlrev_b32 v26, 31, v24
    v_xor_b32 v16, 0xbf800000, v26
    v_or_b32 v26, v24, v25
    v_lshlrev_b32 v26, 31, v26
    v_xor_b32 v17, 1.0, v26
    v_xor_b32 v18, 0xbf800000, v26
    v_lshlrev_b32 v26, 31, v23
    v_xor_b32 v19, v17, v26
    v_lshl_add_u32 v28, v1, 4, v8
    v_cvt_f32_u32 v28, v28
    v_mul_f32 v28, 0x3c800000, v28
    v_lshlrev_b32 v29, 4, v4
    v_cvt_f32_u32 v29, v29
    v_mul_f32 v29, v29, v28
    v_add_f32 v36, v28, v28
    s_mov_b32 s58, 0x00000000
    v_fma_f32 v30, v28, s58, v29
    v_add_f32 v31, v30, v36
    v_cos_f32 v32, v30
    v_cos_f32 v33, v31
    v_sin_f32 v34, v30
    v_sin_f32 v35, v31
    v_cvt_pk_bf16_f32 v32, v32, v33
    v_cvt_pk_bf16_f32 v34, -v34, -v35
    v_accvgpr_write_b32 a100, v32
    v_accvgpr_write_b32 a108, v34
    s_mov_b32 s58, 0x40800000
    v_fma_f32 v30, v28, s58, v29
    v_add_f32 v31, v30, v36
    v_cos_f32 v32, v30
    v_cos_f32 v33, v31
    v_sin_f32 v34, v30
    v_sin_f32 v35, v31
    v_cvt_pk_bf16_f32 v32, v32, v33
    v_cvt_pk_bf16_f32 v34, -v34, -v35
    v_accvgpr_write_b32 a101, v32
    v_accvgpr_write_b32 a109, v34
    s_mov_b32 s58, 0x41000000
    v_fma_f32 v30, v28, s58, v29
    v_add_f32 v31, v30, v36
    v_cos_f32 v32, v30
    v_cos_f32 v33, v31
    v_sin_f32 v34, v30
    v_sin_f32 v35, v31
    v_cvt_pk_bf16_f32 v32, v32, v33
    v_cvt_pk_bf16_f32 v34, -v34, -v35
    v_accvgpr_write_b32 a102, v32
    v_accvgpr_write_b32 a110, v34
    s_mov_b32 s58, 0x41400000
    v_fma_f32 v30, v28, s58, v29
    v_add_f32 v31, v30, v36
    v_cos_f32 v32, v30
    v_cos_f32 v33, v31
    v_sin_f32 v34, v30
    v_sin_f32 v35, v31
    v_cvt_pk_bf16_f32 v32, v32, v33
    v_cvt_pk_bf16_f32 v34, -v34, -v35
    v_accvgpr_write_b32 a103, v32
    v_accvgpr_write_b32 a111, v34
    s_mov_b32 s58, 0x3f800000
    v_fma_f32 v30, v28, s58, v29
    v_add_f32 v31, v30, v36
    v_cos_f32 v32, v30
    v_cos_f32 v33, v31
    v_sin_f32 v34, v30
    v_sin_f32 v35, v31
    v_cvt_pk_bf16_f32 v32, v32, v33
    v_cvt_pk_bf16_f32 v34, -v34, -v35
    v_accvgpr_write_b32 a104, v32
    v_accvgpr_write_b32 a112, v34
    s_mov_b32 s58, 0x40a00000
    v_fma_f32 v30, v28, s58, v29
    v_add_f32 v31, v30, v36
    v_cos_f32 v32, v30
    v_cos_f32 v33, v31
    v_sin_f32 v34, v30
    v_sin_f32 v35, v31
    v_cvt_pk_bf16_f32 v32, v32, v33
    v_cvt_pk_bf16_f32 v34, -v34, -v35
    v_accvgpr_write_b32 a105, v32
    v_accvgpr_write_b32 a113, v34
    s_mov_b32 s58, 0x41100000
    v_fma_f32 v30, v28, s58, v29
    v_add_f32 v31, v30, v36
    v_cos_f32 v32, v30
    v_cos_f32 v33, v31
    v_sin_f32 v34, v30
    v_sin_f32 v35, v31
    v_cvt_pk_bf16_f32 v32, v32, v33
    v_cvt_pk_bf16_f32 v34, -v34, -v35
    v_accvgpr_write_b32 a106, v32
    v_accvgpr_write_b32 a114, v34
    s_mov_b32 s58, 0x41500000
    v_fma_f32 v30, v28, s58, v29
    v_add_f32 v31, v30, v36
    v_cos_f32 v32, v30
    v_cos_f32 v33, v31
    v_sin_f32 v34, v30
    v_sin_f32 v35, v31
    v_cvt_pk_bf16_f32 v32, v32, v33
    v_cvt_pk_bf16_f32 v34, -v34, -v35
    v_accvgpr_write_b32 a107, v32
    v_accvgpr_write_b32 a115, v34
    v_mov_b32 v108, 0x3f803f80
    v_mov_b32 v109, 0x3f803f80
    v_mov_b32 v110, 0x3f803f80
    v_mov_b32 v111, 0x3f803f80
    v_mul_u32_u24 v10, 80, v4
    s_waitcnt lgkmcnt(0)
    s_barrier
    v_add_u32 v27, 98304, v3
    ds_read_b128 a[0:3], v27 offset:0
    ds_read_b128 a[4:7], v27 offset:1024
    ds_read_b128 a[8:11], v27 offset:2048
    ds_read_b128 a[12:15], v27 offset:3072
    ds_read_b128 a[16:19], v27 offset:4096
    ds_read_b128 a[20:23], v27 offset:5120
    ds_read_b128 a[24:27], v27 offset:6144
    ds_read_b128 a[28:31], v27 offset:7168
    ds_read_b128 a[32:35], v27 offset:8192
    ds_read_b128 a[36:39], v27 offset:9216
    ds_read_b128 a[40:43], v27 offset:10240
    ds_read_b128 a[44:47], v27 offset:11264
    ds_read_b128 a[48:51], v27 offset:12288
    ds_read_b128 a[52:55], v27 offset:13312
    ds_read_b128 a[56:59], v27 offset:14336
    ds_read_b128 a[60:63], v27 offset:15360
    ds_read_b128 a[64:67], v27 offset:16384
    ds_read_b128 a[68:71], v27 offset:17408
    ds_read_b128 a[72:75], v27 offset:18432
    ds_read_b128 a[76:79], v27 offset:19456
    ds_read_b128 a[80:83], v27 offset:20480
    ds_read_b128 a[84:87], v27 offset:21504
    ds_read_b128 a[88:91], v27 offset:22528
    ds_read_b128 a[92:95], v27 offset:23552
    ds_read_b128 a[96:99], v27 offset:24576
    s_lshl_b32 s33, s22, 2
    s_add_u32 s33, s33, s32
    s_mul_i32 s33, s33, 20480
    s_add_u32 s33, s33, 27262976
    s_and_b32 s35, s24, 1
    s_mul_i32 s35, s35, 10240
    s_add_u32 s34, s33, 10240
    s_sub_u32 s34, s34, s35
    s_add_u32 s33, s33, s35
    s_lshl_b32 s36, s22, 2
    s_add_u32 s36, s36, s32
    s_lshl_b32 s36, s36, 10
    s_add_u32 s36, s36, 13893632
    v_lshlrev_b32 v108, 3, v8
    v_lshl_add_u32 v108, v4, 8, v108
    v_lshlrev_b32 v10, 4, v4
    s_bitcmp1_b32 s24, 0
    s_cselect_b32 s44, 0x80000000, 0
    v_and_b32 v109, s44, v16
    s_lshl_b32 s57, s22, 2
    s_add_u32 s57, s57, s32
    s_mov_b32 s58, 0
    s_lshl_b32 s57, s57, 10
    s_lshl_b32 s58, s58, 5
    s_add_u32 s57, s57, s58
    s_add_u32 s59, s57, 37490688
    v_lshlrev_b32 v254, 5, v2
    s_mov_b64 exec, 0xff
    s_mov_b32 s58, 0x40000
sync_14_p:
    buffer_load_dwordx2 v[252:253], v254, s[8:11], s59 offen sc1
    s_sub_u32 s58, s58, 1
    s_waitcnt vmcnt(0)
    v_cmp_ne_u64 vcc, s[100:101], v[252:253]
    s_cbranch_scc1 sync_14_x
    s_cbranch_vccnz sync_14_p
sync_14_x:
    s_mov_b64 exec, -1
    buffer_load_dwordx2 v[100:101], v108, s[8:11], s36 offen offset:0 sc1
    buffer_load_dwordx2 v[102:103], v108, s[8:11], s36 offen offset:128 sc1
    s_add_u32 s35, s33, 0
    buffer_load_dwordx4 v[116:119], v3, s[8:11], s35 offen offset:0 sc1
    buffer_load_dwordx4 v[120:123], v3, s[8:11], s35 offen offset:1024 sc1
    buffer_load_dwordx4 v[124:127], v3, s[8:11], s35 offen offset:2048 sc1
    buffer_load_dwordx4 v[128:131], v3, s[8:11], s35 offen offset:3072 sc1
    s_add_u32 s35, s33, 4096
    buffer_load_dwordx4 v[132:135], v3, s[8:11], s35 offen offset:0 sc1
    buffer_load_dwordx4 v[136:139], v3, s[8:11], s35 offen offset:1024 sc1
    buffer_load_dwordx4 v[140:143], v3, s[8:11], s35 offen offset:2048 sc1
    buffer_load_dwordx4 v[144:147], v3, s[8:11], s35 offen offset:3072 sc1
    s_waitcnt lgkmcnt(0)
    s_waitcnt vmcnt(7)
    v_mfma_f32_16x16x32_bf16 v[20:23], v[116:119], a[0:3], 0
    s_add_u32 s35, s33, 8192
    buffer_load_dwordx4 v[148:151], v3, s[8:11], s35 offen offset:0 sc1
    v_mfma_f32_16x16x32_bf16 v[24:27], v[116:119], a[20:23], 0
    v_mfma_f32_16x16x32_bf16 v[28:31], v[116:119], a[40:43], 0
    v_mfma_f32_16x16x32_bf16 v[32:35], v[116:119], a[60:63], 0
    buffer_load_dwordx4 v[152:155], v3, s[8:11], s35 offen offset:1024 sc1
    v_mfma_f32_16x16x32_bf16 v[36:39], v[116:119], a[80:83], 0
    s_waitcnt vmcnt(8)
    v_mfma_f32_16x16x32_bf16 v[20:23], v[120:123], a[4:7], v[20:23]
    s_add_u32 s35, s34, 0
    buffer_load_dwordx4 v[156:159], v3, s[8:11], s35 offen offset:0 sc1
    v_mfma_f32_16x16x32_bf16 v[24:27], v[120:123], a[24:27], v[24:27]
    v_mfma_f32_16x16x32_bf16 v[28:31], v[120:123], a[44:47], v[28:31]
    v_mfma_f32_16x16x32_bf16 v[32:35], v[120:123], a[64:67], v[32:35]
    buffer_load_dwordx4 v[160:163], v3, s[8:11], s35 offen offset:1024 sc1
    v_mfma_f32_16x16x32_bf16 v[36:39], v[120:123], a[84:87], v[36:39]
    s_waitcnt vmcnt(9)
    v_mfma_f32_16x16x32_bf16 v[20:23], v[124:127], a[8:11], v[20:23]
    buffer_load_dwordx4 v[164:167], v3, s[8:11], s35 offen offset:2048 sc1
    v_mfma_f32_16x16x32_bf16 v[24:27], v[124:127], a[28:31], v[24:27]
    v_add_f32 v100, v100, v102
    v_mfma_f32_16x16x32_bf16 v[28:31], v[124:127], a[48:51], v[28:31]
    v_add_f32 v101, v101, v103
    v_mfma_f32_16x16x32_bf16 v[32:35], v[124:127], a[68:71], v[32:35]
    buffer_load_dwordx4 v[168:171], v3, s[8:11], s35 offen offset:3072 sc1
    v_mfma_f32_16x16x32_bf16 v[36:39], v[124:127], a[88:91], v[36:39]
    v_mov_b32 v104, v100
    s_waitcnt vmcnt(10)
    v_mfma_f32_16x16x32_bf16 v[20:23], v[128:131], a[12:15], v[20:23]
    s_add_u32 s35, s34, 4096
    buffer_load_dwordx4 v[172:175], v3, s[8:11], s35 offen offset:0 sc1
    v_mfma_f32_16x16x32_bf16 v[24:27], v[128:131], a[32:35], v[24:27]
    v_mov_b32 v105, v101
    v_mfma_f32_16x16x32_bf16 v[28:31], v[128:131], a[52:55], v[28:31]
    v_permlane16_swap_b32 v100, v104
    v_mfma_f32_16x16x32_bf16 v[32:35], v[128:131], a[72:75], v[32:35]
    buffer_load_dwordx4 v[176:179], v3, s[8:11], s35 offen offset:1024 sc1
    v_mfma_f32_16x16x32_bf16 v[36:39], v[128:131], a[92:95], v[36:39]
    v_permlane16_swap_b32 v101, v105
    s_waitcnt vmcnt(11)
    v_mfma_f32_16x16x32_bf16 v[20:23], v[132:135], a[16:19], v[20:23]
    buffer_load_dwordx4 v[180:183], v3, s[8:11], s35 offen offset:2048 sc1
    v_mfma_f32_16x16x32_bf16 v[24:27], v[132:135], a[36:39], v[24:27]
    v_add_f32 v100, v100, v104
    v_mfma_f32_16x16x32_bf16 v[28:31], v[132:135], a[56:59], v[28:31]
    v_add_f32 v101, v101, v105
    v_mfma_f32_16x16x32_bf16 v[32:35], v[132:135], a[76:79], v[32:35]
    buffer_load_dwordx4 v[184:187], v3, s[8:11], s35 offen offset:3072 sc1
    v_mfma_f32_16x16x32_bf16 v[36:39], v[132:135], a[96:99], v[36:39]
    v_mov_b32 v104, v100
    s_waitcnt vmcnt(12)
    v_mfma_f32_16x16x32_bf16 v[40:43], v[136:139], a[0:3], 0
    s_add_u32 s35, s34, 8192
    buffer_load_dwordx4 v[188:191], v3, s[8:11], s35 offen offset:0 sc1
    v_mfma_f32_16x16x32_bf16 v[44:47], v[136:139], a[20:23], 0
    v_mov_b32 v105, v101
    v_mfma_f32_16x16x32_bf16 v[48:51], v[136:139], a[40:43], 0
    v_permlane32_swap_b32 v100, v104
    v_mfma_f32_16x16x32_bf16 v[52:55], v[136:139], a[60:63], 0
    buffer_load_dwordx4 v[192:195], v3, s[8:11], s35 offen offset:1024 sc1
    v_mfma_f32_16x16x32_bf16 v[56:59], v[136:139], a[80:83], 0
    v_permlane32_swap_b32 v101, v105
    s_waitcnt vmcnt(13)
    v_mfma_f32_16x16x32_bf16 v[40:43], v[140:143], a[4:7], v[40:43]
    v_add_f32 v100, v100, v104
    v_mfma_f32_16x16x32_bf16 v[44:47], v[140:143], a[24:27], v[44:47]
    v_add_f32 v101, v101, v105
    v_mfma_f32_16x16x32_bf16 v[48:51], v[140:143], a[44:47], v[48:51]
    v_mul_f32 v100, 0x3acccccd, v100
    v_mfma_f32_16x16x32_bf16 v[52:55], v[140:143], a[64:67], v[52:55]
    v_mul_f32 v101, 0x3acccccd, v101
    v_mfma_f32_16x16x32_bf16 v[56:59], v[140:143], a[84:87], v[56:59]
    v_fma_f32 v101, -v100, v100, v101
    s_waitcnt vmcnt(12)
    v_mfma_f32_16x16x32_bf16 v[40:43], v[144:147], a[8:11], v[40:43]
    v_max_f32 v101, 0, v101
    v_mfma_f32_16x16x32_bf16 v[44:47], v[144:147], a[28:31], v[44:47]
    v_cvt_pk_bf16_f32 v101, v101, v101
    v_mfma_f32_16x16x32_bf16 v[48:51], v[144:147], a[48:51], v[48:51]
    v_lshlrev_b32 v101, 16, v101
    v_mfma_f32_16x16x32_bf16 v[52:55], v[144:147], a[68:71], v[52:55]
    v_add_f32 v101, 0x3727c5ac, v101
    v_mfma_f32_16x16x32_bf16 v[56:59], v[144:147], a[88:91], v[56:59]
    v_cvt_pk_bf16_f32 v101, v101, v101
    s_waitcnt vmcnt(11)
    v_mfma_f32_16x16x32_bf16 v[40:43], v[148:151], a[12:15], v[40:43]
    v_lshlrev_b32 v101, 16, v101
    v_mfma_f32_16x16x32_bf16 v[44:47], v[148:151], a[32:35], v[44:47]
    v_sqrt_f32 v101, v101
    v_mfma_f32_16x16x32_bf16 v[48:51], v[148:151], a[52:55], v[48:51]
    v_cvt_pk_bf16_f32 v101, v101, v101
    v_mfma_f32_16x16x32_bf16 v[52:55], v[148:151], a[72:75], v[52:55]
    v_lshlrev_b32 v101, 16, v101
    v_mfma_f32_16x16x32_bf16 v[56:59], v[148:151], a[92:95], v[56:59]
    v_rcp_f32 v101, v101
    s_waitcnt vmcnt(10)
    v_mfma_f32_16x16x32_bf16 v[40:43], v[152:155], a[16:19], v[40:43]
    ds_bpermute_b32 v112, v10, v101 offset:0
    v_mfma_f32_16x16x32_bf16 v[44:47], v[152:155], a[36:39], v[44:47]
    ds_bpermute_b32 v113, v10, v101 offset:4
    v_mfma_f32_16x16x32_bf16 v[48:51], v[152:155], a[56:59], v[48:51]
    ds_bpermute_b32 v114, v10, v101 offset:8
    v_mfma_f32_16x16x32_bf16 v[52:55], v[152:155], a[76:79], v[52:55]
    ds_bpermute_b32 v115, v10, v101 offset:12
    v_mfma_f32_16x16x32_bf16 v[56:59], v[152:155], a[96:99], v[56:59]
    s_waitcnt lgkmcnt(0)
    s_waitcnt vmcnt(9)
    v_mfma_f32_16x16x32_bf16 v[60:63], v[156:159], a[0:3], 0
    v_xor_b32 v112, v109, v112
    v_mfma_f32_16x16x32_bf16 v[64:67], v[156:159], a[20:23], 0
    v_xor_b32 v113, v109, v113
    v_mfma_f32_16x16x32_bf16 v[68:71], v[156:159], a[40:43], 0
    v_xor_b32 v114, v109, v114
    v_mfma_f32_16x16x32_bf16 v[72:75], v[156:159], a[60:63], 0
    v_xor_b32 v115, v109, v115
    v_mfma_f32_16x16x32_bf16 v[76:79], v[156:159], a[80:83], 0
    s_mov_b32 s45, 123904
    s_waitcnt vmcnt(8)
    v_mfma_f32_16x16x32_bf16 v[60:63], v[160:163], a[4:7], v[60:63]
    v_mul_u32_u24 v6, 144, v8
    v_mfma_f32_16x16x32_bf16 v[64:67], v[160:163], a[24:27], v[64:67]
    v_lshlrev_b32 v7, 3, v4
    v_mfma_f32_16x16x32_bf16 v[68:71], v[160:163], a[44:47], v[68:71]
    v_add3_u32 v6, v6, v7, s45
    v_mfma_f32_16x16x32_bf16 v[72:75], v[160:163], a[64:67], v[72:75]
    s_lshl_b32 s44, s32, 5
    v_mfma_f32_16x16x32_bf16 v[76:79], v[160:163], a[84:87], v[76:79]
    v_add_u32 v9, s44, v6
    s_waitcnt vmcnt(7)
    v_mfma_f32_16x16x32_bf16 v[60:63], v[164:167], a[8:11], v[60:63]
    v_add_u32 v6, v6, v7
    v_mfma_f32_16x16x32_bf16 v[64:67], v[164:167], a[28:31], v[64:67]
    s_mul_i32 s45, s32, 2560
    v_mfma_f32_16x16x32_bf16 v[68:71], v[164:167], a[48:51], v[68:71]
    s_add_u32 s45, s45, 98304
    v_mfma_f32_16x16x32_bf16 v[72:75], v[164:167], a[68:71], v[72:75]
    v_mul_u32_u24 v10, 160, v8
    v_mfma_f32_16x16x32_bf16 v[76:79], v[164:167], a[88:91], v[76:79]
    v_add_u32 v10, s45, v10
    s_waitcnt vmcnt(6)
    v_mfma_f32_16x16x32_bf16 v[60:63], v[168:171], a[12:15], v[60:63]
    v_add_u32 v12, s45, v3
    v_mfma_f32_16x16x32_bf16 v[64:67], v[168:171], a[32:35], v[64:67]
    v_lshl_add_u32 v11, v4, 2, v10
    v_mfma_f32_16x16x32_bf16 v[68:71], v[168:171], a[52:55], v[68:71]
    v_lshl_add_u32 v10, v4, 4, v10
    v_mfma_f32_16x16x32_bf16 v[72:75], v[168:171], a[72:75], v[72:75]
    s_mul_i32 s44, s23, 81920
    v_mfma_f32_16x16x32_bf16 v[76:79], v[168:171], a[92:95], v[76:79]
    s_mul_i32 s45, s24, 10240
    s_waitcnt vmcnt(5)
    v_mfma_f32_16x16x32_bf16 v[60:63], v[172:175], a[16:19], v[60:63]
    s_add_u32 s44, s44, s45
    v_mfma_f32_16x16x32_bf16 v[64:67], v[172:175], a[36:39], v[64:67]
    s_add_u32 s44, s44, 4194304
    v_mfma_f32_16x16x32_bf16 v[68:71], v[172:175], a[56:59], v[68:71]
    s_mul_i32 s45, s32, 2560
    v_mfma_f32_16x16x32_bf16 v[72:75], v[172:175], a[76:79], v[72:75]
    s_add_u32 s44, s44, s45
    v_mfma_f32_16x16x32_bf16 v[76:79], v[172:175], a[96:99], v[76:79]
    s_waitcnt vmcnt(4)
    v_mfma_f32_16x16x32_bf16 v[80:83], v[176:179], a[0:3], 0
    v_mfma_f32_16x16x32_bf16 v[84:87], v[176:179], a[20:23], 0
    v_mfma_f32_16x16x32_bf16 v[88:91], v[176:179], a[40:43], 0
    v_mfma_f32_16x16x32_bf16 v[92:95], v[176:179], a[60:63], 0
    v_mfma_f32_16x16x32_bf16 v[96:99], v[176:179], a[80:83], 0
    s_waitcnt vmcnt(3)
    v_mfma_f32_16x16x32_bf16 v[80:83], v[180:183], a[4:7], v[80:83]
    v_fmac_f32 v20, v16, v60
    v_mfma_f32_16x16x32_bf16 v[84:87], v[180:183], a[24:27], v[84:87]
    v_fmac_f32 v21, v16, v61
    v_mfma_f32_16x16x32_bf16 v[88:91], v[180:183], a[44:47], v[88:91]
    v_fmac_f32 v22, v16, v62
    v_mfma_f32_16x16x32_bf16 v[92:95], v[180:183], a[64:67], v[92:95]
    v_fmac_f32 v23, v16, v63
    v_mfma_f32_16x16x32_bf16 v[96:99], v[180:183], a[84:87], v[96:99]
    v_fmac_f32 v24, v16, v64
    s_waitcnt vmcnt(2)
    v_mfma_f32_16x16x32_bf16 v[80:83], v[184:187], a[8:11], v[80:83]
    v_fmac_f32 v25, v16, v65
    v_mfma_f32_16x16x32_bf16 v[84:87], v[184:187], a[28:31], v[84:87]
    v_fmac_f32 v26, v16, v66
    v_mfma_f32_16x16x32_bf16 v[88:91], v[184:187], a[48:51], v[88:91]
    v_fmac_f32 v27, v16, v67
    v_mfma_f32_16x16x32_bf16 v[92:95], v[184:187], a[68:71], v[92:95]
    v_fmac_f32 v28, v16, v68
    v_mfma_f32_16x16x32_bf16 v[96:99], v[184:187], a[88:91], v[96:99]
    v_fmac_f32 v29, v16, v69
    s_waitcnt vmcnt(1)
    v_mfma_f32_16x16x32_bf16 v[80:83], v[188:191], a[12:15], v[80:83]
    v_fmac_f32 v30, v16, v70
    v_mfma_f32_16x16x32_bf16 v[84:87], v[188:191], a[32:35], v[84:87]
    v_fmac_f32 v31, v16, v71
    v_mfma_f32_16x16x32_bf16 v[88:91], v[188:191], a[52:55], v[88:91]
    v_fmac_f32 v32, v16, v72
    v_mfma_f32_16x16x32_bf16 v[92:95], v[188:191], a[72:75], v[92:95]
    v_fmac_f32 v33, v16, v73
    v_mfma_f32_16x16x32_bf16 v[96:99], v[188:191], a[92:95], v[96:99]
    v_fmac_f32 v34, v16, v74
    s_waitcnt vmcnt(0)
    v_mfma_f32_16x16x32_bf16 v[80:83], v[192:195], a[16:19], v[80:83]
    v_fmac_f32 v35, v16, v75
    v_mfma_f32_16x16x32_bf16 v[84:87], v[192:195], a[36:39], v[84:87]
    v_fmac_f32 v36, v16, v76
    v_mfma_f32_16x16x32_bf16 v[88:91], v[192:195], a[56:59], v[88:91]
    v_fmac_f32 v37, v16, v77
    v_mfma_f32_16x16x32_bf16 v[92:95], v[192:195], a[76:79], v[92:95]
    v_fmac_f32 v38, v16, v78
    v_mfma_f32_16x16x32_bf16 v[96:99], v[192:195], a[96:99], v[96:99]
    v_fmac_f32 v39, v16, v79
    v_fmac_f32 v40, v16, v80
    v_fmac_f32 v41, v16, v81
    v_fmac_f32 v42, v16, v82
    v_fmac_f32 v43, v16, v83
    v_fmac_f32 v44, v16, v84
    v_fmac_f32 v45, v16, v85
    v_fmac_f32 v46, v16, v86
    v_fmac_f32 v47, v16, v87
    v_fmac_f32 v48, v16, v88
    v_fmac_f32 v49, v16, v89
    v_fmac_f32 v50, v16, v90
    v_fmac_f32 v51, v16, v91
    v_fmac_f32 v52, v16, v92
    v_fmac_f32 v53, v16, v93
    v_fmac_f32 v54, v16, v94
    v_fmac_f32 v55, v16, v95
    v_fmac_f32 v56, v16, v96
    v_fmac_f32 v57, v16, v97
    v_fmac_f32 v58, v16, v98
    v_fmac_f32 v59, v16, v99
    v_fmac_f32_dpp v20, v40, v17 quad_perm:[1,0,2,3] row_mask:0xf bank_mask:0xf
    v_fmac_f32_dpp v21, v41, v17 quad_perm:[1,0,2,3] row_mask:0xf bank_mask:0xf
    v_fmac_f32_dpp v22, v42, v17 quad_perm:[1,0,2,3] row_mask:0xf bank_mask:0xf
    v_fmac_f32_dpp v23, v43, v17 quad_perm:[1,0,2,3] row_mask:0xf bank_mask:0xf
    v_fmac_f32_dpp v24, v44, v18 quad_perm:[1,0,2,3] row_mask:0xf bank_mask:0xf
    v_fmac_f32_dpp v25, v45, v18 quad_perm:[1,0,2,3] row_mask:0xf bank_mask:0xf
    v_fmac_f32_dpp v26, v46, v18 quad_perm:[1,0,2,3] row_mask:0xf bank_mask:0xf
    v_fmac_f32_dpp v27, v47, v18 quad_perm:[1,0,2,3] row_mask:0xf bank_mask:0xf
    v_fmac_f32_dpp v28, v48, v17 quad_perm:[1,0,2,3] row_mask:0xf bank_mask:0xf
    v_fmac_f32_dpp v29, v49, v17 quad_perm:[1,0,2,3] row_mask:0xf bank_mask:0xf
    v_fmac_f32_dpp v30, v50, v17 quad_perm:[1,0,2,3] row_mask:0xf bank_mask:0xf
    v_fmac_f32_dpp v31, v51, v17 quad_perm:[1,0,2,3] row_mask:0xf bank_mask:0xf
    v_fmac_f32_dpp v32, v52, v18 quad_perm:[1,0,2,3] row_mask:0xf bank_mask:0xf
    v_fmac_f32_dpp v33, v53, v18 quad_perm:[1,0,2,3] row_mask:0xf bank_mask:0xf
    v_fmac_f32_dpp v34, v54, v18 quad_perm:[1,0,2,3] row_mask:0xf bank_mask:0xf
    v_fmac_f32_dpp v35, v55, v18 quad_perm:[1,0,2,3] row_mask:0xf bank_mask:0xf
    v_fmac_f32_dpp v36, v56, v19 quad_perm:[1,0,2,3] row_mask:0xf bank_mask:0xf
    v_fmac_f32_dpp v37, v57, v19 quad_perm:[1,0,2,3] row_mask:0xf bank_mask:0xf
    v_fmac_f32_dpp v38, v58, v19 quad_perm:[1,0,2,3] row_mask:0xf bank_mask:0xf
    v_fmac_f32_dpp v39, v59, v19 quad_perm:[1,0,2,3] row_mask:0xf bank_mask:0xf
    v_mul_f32 v20, v20, v112
    v_mul_f32 v21, v21, v113
    v_mul_f32 v22, v22, v114
    v_mul_f32 v23, v23, v115
    v_cvt_pk_bf16_f32 v40, v20, v21
    v_cvt_pk_bf16_f32 v41, v22, v23
    ds_write_b64 v9, v[40:41] offset:0
    v_mul_f32 v24, v24, v112
    v_mul_f32 v25, v25, v113
    v_mul_f32 v26, v26, v114
    v_mul_f32 v27, v27, v115
    v_cvt_pk_bf16_f32 v44, v24, v25
    v_cvt_pk_bf16_f32 v45, v26, v27
    ds_write_b64 v9, v[44:45] offset:2304
    v_mul_f32 v28, v28, v112
    v_mul_f32 v29, v29, v113
    v_mul_f32 v30, v30, v114
    v_mul_f32 v31, v31, v115
    v_cvt_pk_bf16_f32 v48, v28, v29
    v_cvt_pk_bf16_f32 v49, v30, v31
    ds_write_b64 v9, v[48:49] offset:4608
    v_mul_f32 v32, v32, v112
    v_mul_f32 v33, v33, v113
    v_mul_f32 v34, v34, v114
    v_mul_f32 v35, v35, v115
    v_cvt_pk_bf16_f32 v52, v32, v33
    v_cvt_pk_bf16_f32 v53, v34, v35
    ds_write_b64 v9, v[52:53] offset:6912
    v_mul_f32 v36, v36, v112
    v_mul_f32 v37, v37, v113
    v_mul_f32 v38, v38, v114
    v_mul_f32 v39, v39, v115
    v_cvt_pk_bf16_f32 v56, v36, v37
    v_cvt_pk_bf16_f32 v57, v38, v39
    ds_write_b64 v9, v[56:57] offset:9216
    s_waitcnt lgkmcnt(0)
    s_barrier
    ds_read_b128 v[120:123], v6 offset:0
    ds_read_b128 v[124:127], v6 offset:64
    ds_read_b128 v[128:131], v6 offset:2304
    ds_read_b128 v[132:135], v6 offset:2368
    ds_read_b128 v[136:139], v6 offset:4608
    ds_read_b128 v[140:143], v6 offset:4672
    ds_read_b128 v[144:147], v6 offset:6912
    ds_read_b128 v[148:151], v6 offset:6976
    ds_read_b128 v[152:155], v6 offset:9216
    ds_read_b128 v[156:159], v6 offset:9280
    s_waitcnt lgkmcnt(8)
    v_mfma_f32_16x16x32_bf16 v[20:23], v[120:123], a[100:103], 0
    v_mfma_f32_16x16x32_bf16 v[24:27], v[120:123], a[108:111], 0
    v_mfma_f32_16x16x32_bf16 v[20:23], v[124:127], a[104:107], v[20:23]
    v_mfma_f32_16x16x32_bf16 v[24:27], v[124:127], a[112:115], v[24:27]
    s_waitcnt lgkmcnt(6)
    v_mfma_f32_16x16x32_bf16 v[28:31], v[128:131], a[100:103], 0
    v_mfma_f32_16x16x32_bf16 v[32:35], v[128:131], a[108:111], 0
    v_mfma_f32_16x16x32_bf16 v[28:31], v[132:135], a[104:107], v[28:31]
    v_mfma_f32_16x16x32_bf16 v[32:35], v[132:135], a[112:115], v[32:35]
    s_waitcnt lgkmcnt(4)
    v_mfma_f32_16x16x32_bf16 v[36:39], v[136:139], a[100:103], 0
    v_mfma_f32_16x16x32_bf16 v[40:43], v[136:139], a[108:111], 0
    v_mfma_f32_16x16x32_bf16 v[36:39], v[140:143], a[104:107], v[36:39]
    v_mfma_f32_16x16x32_bf16 v[40:43], v[140:143], a[112:115], v[40:43]
    s_waitcnt lgkmcnt(2)
    v_mfma_f32_16x16x32_bf16 v[44:47], v[144:147], a[100:103], 0
    v_mfma_f32_16x16x32_bf16 v[48:51], v[144:147], a[108:111], 0
    v_mfma_f32_16x16x32_bf16 v[44:47], v[148:151], a[104:107], v[44:47]
    v_mfma_f32_16x16x32_bf16 v[48:51], v[148:151], a[112:115], v[48:51]
    s_waitcnt lgkmcnt(0)
    v_mfma_f32_16x16x32_bf16 v[52:55], v[152:155], a[100:103], 0
    v_mfma_f32_16x16x32_bf16 v[56:59], v[152:155], a[108:111], 0
    v_mfma_f32_16x16x32_bf16 v[52:55], v[156:159], a[104:107], v[52:55]
    v_mfma_f32_16x16x32_bf16 v[56:59], v[156:159], a[112:115], v[56:59]
    v_sub_f32 v76, v20, v25
    v_sub_f32 v77, v22, v27
    v_add_f32 v78, v24, v21
    v_add_f32 v79, v26, v23
    v_cvt_pk_bf16_f32 v60, v76, v77
    v_cvt_pk_bf16_f32 v68, v78, v79
    v_sub_f32 v80, v28, v33
    v_sub_f32 v81, v30, v35
    v_add_f32 v82, v32, v29
    v_add_f32 v83, v34, v31
    v_cvt_pk_bf16_f32 v61, v80, v81
    v_cvt_pk_bf16_f32 v69, v82, v83
    v_sub_f32 v76, v36, v41
    v_sub_f32 v77, v38, v43
    v_add_f32 v78, v40, v37
    v_add_f32 v79, v42, v39
    v_cvt_pk_bf16_f32 v62, v76, v77
    v_cvt_pk_bf16_f32 v70, v78, v79
    v_sub_f32 v80, v44, v49
    v_sub_f32 v81, v46, v51
    v_add_f32 v82, v48, v45
    v_add_f32 v83, v50, v47
    v_cvt_pk_bf16_f32 v63, v80, v81
    v_cvt_pk_bf16_f32 v71, v82, v83
    v_sub_f32 v76, v52, v57
    v_sub_f32 v77, v54, v59
    v_add_f32 v78, v56, v53
    v_add_f32 v79, v58, v55
    v_cvt_pk_bf16_f32 v64, v76, v77
    v_cvt_pk_bf16_f32 v72, v78, v79
    ds_write_b128 v10, v[60:63]
    ds_write_b128 v10, v[68:71] offset:80
    ds_write_b32 v11, v64 offset:64
    ds_write_b32 v11, v72 offset:144
    s_waitcnt lgkmcnt(0)
    ds_read_b128 v[84:87], v12 offset:0
    ds_read_b128 v[88:91], v12 offset:1024
    ds_read_b128 v[92:95], v12 offset:2048
    s_waitcnt lgkmcnt(2)
    buffer_store_dwordx4 v[84:87], v3, s[8:11], s44 offen offset:0 sc1
    s_waitcnt lgkmcnt(1)
    buffer_store_dwordx4 v[88:91], v3, s[8:11], s44 offen offset:1024 sc1
    s_waitcnt lgkmcnt(0)
    s_mov_b32 exec_hi, 0
    buffer_store_dwordx4 v[92:95], v3, s[8:11], s44 offen offset:2048 sc1
    s_mov_b32 exec_hi, -1
fb_l1:
    s_add_u32 s27, s25, 0
    s_add_u32 m0, s26, 0
    s_nop 0
    buffer_load_dwordx4 v3, s[8:11], s27 offen offset:0  lds
    buffer_load_dwordx4 v3, s[8:11], s27 offen offset:1024  lds
    buffer_load_dwordx4 v3, s[8:11], s27 offen offset:2048  lds
    buffer_load_dwordx4 v3, s[8:11], s27 offen offset:3072  lds
    s_add_u32 s27, s27, 4096
    s_add_u32 m0, s26, 4096
    s_nop 0
    buffer_load_dwordx4 v3, s[8:11], s27 offen offset:0  lds
    buffer_load_dwordx4 v3, s[8:11], s27 offen offset:1024  lds
    s_and_b32 s33, s21, 7
    s_lshr_b32 s34, s21, 3
    s_and_b32 s35, s32, 1
    s_xor_b32 s34, s34, s35
    s_sub_u32 s36, 32, s20
    s_cmp_eq_u32 s20, 0
    s_cselect_b32 s36, 16, s36
    s_cmp_eq_u32 s34, 0
    s_cselect_b32 s36, s20, s36
    s_lshl_b32 s37, s35, 5
    s_add_u32 s36, s36, s37
    s_sub_u32 s37, 64, s36
    s_and_b32 s37, s37, 63
    s_cmp_lt_u32 s32, 2
    s_cselect_b32 s37, s36, s37
    s_cselect_b32 s39, -2, 0
    s_lshl_b32 s38, s20, 1
    s_add_u32 s38, s38, s34
    s_lshl_b32 s38, s38, 1
    s_add_u32 s38, s38, s35
    s_lshl_b32 s38, s38, 1
    v_add_u32 v20, 0, v2
    v_mul_u32_u24 v21, 13108, v20
    v_lshrrev_b32 v21, 17, v21
    v_mul_u32_u24 v22, 81760, v21
    v_lshl_add_u32 v10, v20, 4, v22
    v_add_u32 v20, 64, v2
    v_mul_u32_u24 v21, 13108, v20
    v_lshrrev_b32 v21, 17, v21
    v_mul_u32_u24 v22, 81760, v21
    v_lshl_add_u32 v11, v20, 4, v22
    v_add_u32 v20, 128, v2
    v_mul_u32_u24 v21, 13108, v20
    v_lshrrev_b32 v21, 17, v21
    v_mul_u32_u24 v22, 81760, v21
    v_lshl_add_u32 v12, v20, 4, v22
    v_add_u32 v20, 192, v2
    v_mul_u32_u24 v21, 13108, v20
    v_lshrrev_b32 v21, 17, v21
    v_mul_u32_u24 v22, 81760, v21
    v_lshl_add_u32 v13, v20, 4, v22
    v_add_u32 v20, 256, v2
    v_mul_u32_u24 v21, 13108, v20
    v_lshrrev_b32 v21, 17, v21
    v_mul_u32_u24 v22, 81760, v21
    v_lshl_add_u32 v14, v20, 4, v22
    v_lshrrev_b32 v20, 1, v2
    v_mul_u32_u24 v20, 81920, v20
    v_and_b32 v21, 1, v2
    v_mul_u32_u24 v21, 80, v21
    v_add_u32 v47, v20, v21
    s_mul_i32 s40, s37, 160
    s_add_u32 s40, s40, s39
    s_mul_i32 s41, s33, 10240
    s_add_u32 s40, s40, s41
    s_add_u32 s40, s40, 4194304
    s_sub_u32 s41, s40, 10160
    s_mul_i32 s42, s32, 6144
    s_add_u32 s42, s42, 122880
    s_mul_i32 s43, s33, 5
    s_sub_u32 s44, 75, s43
    s_cmp_lt_u32 s32, 2
    s_cselect_b32 s43, s43, s44
    v_lshlrev_b32 v5, 4, v8
    v_lshl_add_u32 v5, v4, 3, v5
    s_mul_i32 s44, s38, 20480
    s_lshl_b32 s45, s43, 8
    s_add_u32 s44, s44, s45
    s_add_u32 s46, s44, 27262976
    s_add_u32 s47, s46, 20480
    v_lshlrev_b32 v36, 6, v8
    v_add_u32 v36, s36, v36
    v_cvt_f32_u32 v36, v36
    v_mul_f32 v36, 0x3a000000, v36
    v_lshlrev_b32 v38, 2, v4
    v_cvt_f32_u32 v38, v38
    s_cmp_lt_u32 s32, 2
    s_cselect_b32 s48, 0, 0x80000000
    v_mul_f32 v37, v38, v36
    s_mov_b32 s49, 0x00000000
    v_fma_f32 v40, v36, s49, v37
    v_cos_f32 v41, v40
    v_sin_f32 v42, v40
    s_nop 0
    v_xor_b32 v42, s48, v42
    v_cvt_pk_bf16_f32 v20, v41, v42
    s_mov_b32 s49, 0x3f800000
    v_fma_f32 v43, v36, s49, v37
    v_cos_f32 v44, v43
    v_sin_f32 v45, v43
    s_nop 0
    v_xor_b32 v45, s48, v45
    v_cvt_pk_bf16_f32 v21, v44, v45
    s_mov_b32 s49, 0x40000000
    v_fma_f32 v40, v36, s49, v37
    v_cos_f32 v41, v40
    v_sin_f32 v42, v40
    s_nop 0
    v_xor_b32 v42, s48, v42
    v_cvt_pk_bf16_f32 v22, v41, v42
    s_mov_b32 s49, 0x40400000
    v_fma_f32 v43, v36, s49, v37
    v_cos_f32 v44, v43
    v_sin_f32 v45, v43
    s_nop 0
    v_xor_b32 v45, s48, v45
    v_cvt_pk_bf16_f32 v23, v44, v45
    s_mov_b32 s49, 0x41800000
    v_fma_f32 v40, v36, s49, v37
    v_cos_f32 v41, v40
    v_sin_f32 v42, v40
    s_nop 0
    v_xor_b32 v42, s48, v42
    v_cvt_pk_bf16_f32 v24, v41, v42
    s_mov_b32 s49, 0x41880000
    v_fma_f32 v43, v36, s49, v37
    v_cos_f32 v44, v43
    v_sin_f32 v45, v43
    s_nop 0
    v_xor_b32 v45, s48, v45
    v_cvt_pk_bf16_f32 v25, v44, v45
    s_mov_b32 s49, 0x41900000
    v_fma_f32 v40, v36, s49, v37
    v_cos_f32 v41, v40
    v_sin_f32 v42, v40
    s_nop 0
    v_xor_b32 v42, s48, v42
    v_cvt_pk_bf16_f32 v26, v41, v42
    s_mov_b32 s49, 0x41980000
    v_fma_f32 v43, v36, s49, v37
    v_cos_f32 v44, v43
    v_sin_f32 v45, v43
    s_nop 0
    v_xor_b32 v45, s48, v45
    v_cvt_pk_bf16_f32 v27, v44, v45
    s_waitcnt vmcnt(6)
    s_lshl_b32 s56, s24, 2
    s_add_u32 s56, s56, s32
    s_mov_b32 s57, s22
    s_lshl_b32 s56, s56, 10
    s_lshl_b32 s57, s57, 5
    s_add_u32 s56, s56, s57
    s_add_u32 s56, s56, 38014976
    v_mov_b32 v252, s100
    v_mov_b32 v253, s101
    s_mov_b64 exec, 1
    buffer_store_dwordx2 v[252:253], v3, s[8:11], s56 offen sc1
    s_mov_b64 exec, -1
    s_add_u32 s27, s25, 24576
    s_add_u32 m0, s26, 24576
    s_nop 0
    buffer_load_dwordx4 v3, s[8:11], s27 offen offset:0  lds
    buffer_load_dwordx4 v3, s[8:11], s27 offen offset:1024  lds
    buffer_load_dwordx4 v3, s[8:11], s27 offen offset:2048  lds
    buffer_load_dwordx4 v3, s[8:11], s27 offen offset:3072  lds
    s_add_u32 s27, s27, 4096
    s_add_u32 m0, s26, 28672
    s_nop 0
    buffer_load_dwordx4 v3, s[8:11], s27 offen offset:0  lds
    buffer_load_dwordx4 v3, s[8:11], s27 offen offset:1024  lds
    s_add_u32 s27, s25, 49152
    s_add_u32 m0, s26, 49152
    s_nop 0
    buffer_load_dwordx4 v3, s[8:11], s27 offen offset:0  lds
    buffer_load_dwordx4 v3, s[8:11], s27 offen offset:1024  lds
    buffer_load_dwordx4 v3, s[8:11], s27 offen offset:2048  lds
    buffer_load_dwordx4 v3, s[8:11], s27 offen offset:3072  lds
    s_add_u32 s27, s27, 4096
    s_add_u32 m0, s26, 53248
    s_nop 0
    buffer_load_dwordx4 v3, s[8:11], s27 offen offset:0  lds
    buffer_load_dwordx4 v3, s[8:11], s27 offen offset:1024  lds
    s_add_u32 s27, s25, 73728
    s_add_u32 m0, s26, 73728
    s_nop 0
    buffer_load_dwordx4 v3, s[8:11], s27 offen offset:0  lds
    buffer_load_dwordx4 v3, s[8:11], s27 offen offset:1024  lds
    buffer_load_dwordx4 v3, s[8:11], s27 offen offset:2048  lds
    buffer_load_dwordx4 v3, s[8:11], s27 offen offset:3072  lds
    s_add_u32 s27, s27, 4096
    s_add_u32 m0, s26, 77824
    s_nop 0
    buffer_load_dwordx4 v3, s[8:11], s27 offen offset:0  lds
    buffer_load_dwordx4 v3, s[8:11], s27 offen offset:1024  lds
    v_add_f32 v36, 0.5, v36
    v_mul_f32 v37, v38, v36
    s_mov_b32 s49, 0x00000000
    v_fma_f32 v40, v36, s49, v37
    v_cos_f32 v41, v40
    v_sin_f32 v42, v40
    s_nop 0
    v_xor_b32 v42, s48, v42
    v_cvt_pk_bf16_f32 v28, v41, v42
    s_mov_b32 s49, 0x3f800000
    v_fma_f32 v43, v36, s49, v37
    v_cos_f32 v44, v43
    v_sin_f32 v45, v43
    s_nop 0
    v_xor_b32 v45, s48, v45
    v_cvt_pk_bf16_f32 v29, v44, v45
    s_mov_b32 s49, 0x40000000
    v_fma_f32 v40, v36, s49, v37
    v_cos_f32 v41, v40
    v_sin_f32 v42, v40
    s_nop 0
    v_xor_b32 v42, s48, v42
    v_cvt_pk_bf16_f32 v30, v41, v42
    s_mov_b32 s49, 0x40400000
    v_fma_f32 v43, v36, s49, v37
    v_cos_f32 v44, v43
    v_sin_f32 v45, v43
    s_nop 0
    v_xor_b32 v45, s48, v45
    v_cvt_pk_bf16_f32 v31, v44, v45
    s_mov_b32 s49, 0x41800000
    v_fma_f32 v40, v36, s49, v37
    v_cos_f32 v41, v40
    v_sin_f32 v42, v40
    s_nop 0
    v_xor_b32 v42, s48, v42
    v_cvt_pk_bf16_f32 v32, v41, v42
    s_mov_b32 s49, 0x41880000
    v_fma_f32 v43, v36, s49, v37
    v_cos_f32 v44, v43
    v_sin_f32 v45, v43
    s_nop 0
    v_xor_b32 v45, s48, v45
    v_cvt_pk_bf16_f32 v33, v44, v45
    s_mov_b32 s49, 0x41900000
    v_fma_f32 v40, v36, s49, v37
    v_cos_f32 v41, v40
    v_sin_f32 v42, v40
    s_nop 0
    v_xor_b32 v42, s48, v42
    v_cvt_pk_bf16_f32 v34, v41, v42
    s_mov_b32 s49, 0x41980000
    v_fma_f32 v43, v36, s49, v37
    v_cos_f32 v44, v43
    v_sin_f32 v45, v43
    s_nop 0
    v_xor_b32 v45, s48, v45
    v_cvt_pk_bf16_f32 v35, v44, v45
    v_bfe_u32 v15, v2, 2, 2
    v_and_b32 v16, 3, v2
    v_lshl_add_u32 v17, v4, 3, v15
    v_mul_u32_u24 v17, 80, v17
    v_add_u32 v17, s42, v17
    v_and_b32 v18, 1, v16
    v_add_u32 v96, s42, v3
    v_mul_u32_u24 v97, 80, v2
    v_add_u32 v97, s42, v97
    s_lshl_b32 s50, s38, 11
    s_lshl_b32 s51, s33, 8
    s_add_u32 s50, s50, s51
    s_lshr_b32 s51, s32, 1
    s_lshl_b32 s51, s51, 7
    s_add_u32 s50, s50, s51
    s_add_u32 s50, s50, 14155776
    s_add_u32 s44, s44, 10485760
    s_add_u32 s45, s44, 20480
    v_lshlrev_b32 v9, 3, v8
    v_lshl_add_u32 v9, v4, 11, v9
    v_mov_b32 v39, 0x3f803f80
    s_mov_b32 s52, -1
    s_mov_b32 s53, 0
    s_cmp_lt_u32 s32, 2
    s_cselect_b32 s57, 4096, 0
    s_cmp_eq_u32 s33, 0
    s_cselect_b32 s57, 0, s57
    v_lshrrev_b32 v252, 5, v2
    v_mul_lo_u32 v252, v252, s57
    v_and_b32 v254, 31, v2
    v_lshlrev_b32 v254, 5, v254
    v_sub_u32 v254, v254, v252
    v_add_u32 v254, 4096, v254
    s_lshl_b32 s57, s33, 12
    s_lshr_b32 s58, s37, 4
    s_lshl_b32 s58, s58, 10
    s_add_u32 s57, s57, s58
    s_add_u32 s59, s57, 38010880
    s_barrier
    s_mov_b32 s58, 0x40000
sync_15_p:
    buffer_load_dwordx2 v[252:253], v254, s[8:11], s59 offen sc1
    s_sub_u32 s58, s58, 1
    s_waitcnt vmcnt(0)
    v_cmp_ne_u64 vcc, s[100:101], v[252:253]
    s_cbranch_scc1 sync_15_x
    s_cbranch_vccnz sync_15_p
sync_15_x:
    s_mov_b64 exec, -1
    buffer_load_dwordx4 v[100:103], v3, s[8:11], s46 offen sc1
    buffer_load_dwordx2 v[104:105], v5, s[8:11], s46 offen offset:1024 sc1
    buffer_load_dwordx4 v[106:109], v3, s[8:11], s47 offen sc1
    buffer_load_dwordx2 v[110:111], v5, s[8:11], s47 offen offset:1024 sc1
    buffer_load_dwordx4 v[120:123], v10, s[8:11], s40 offen sc1
    buffer_load_dwordx4 v[124:127], v11, s[8:11], s40 offen sc1
    buffer_load_dwordx4 v[128:131], v12, s[8:11], s40 offen sc1
    buffer_load_dwordx4 v[132:135], v13, s[8:11], s40 offen sc1
    buffer_load_dwordx4 v[136:139], v14, s[8:11], s40 offen sc1
    buffer_load_ushort v98, v47, s[8:11], s41 offen sc1
    s_add_u32 s27, s25, 98304
    s_add_u32 m0, s26, 98304
    s_nop 0
    buffer_load_dwordx4 v3, s[8:11], s27 offen offset:0  lds
    buffer_load_dwordx4 v3, s[8:11], s27 offen offset:1024  lds
    buffer_load_dwordx4 v3, s[8:11], s27 offen offset:2048  lds
    buffer_load_dwordx4 v3, s[8:11], s27 offen offset:3072  lds
    s_add_u32 s27, s27, 4096
    s_add_u32 m0, s26, 102400
    s_nop 0
    buffer_load_dwordx4 v3, s[8:11], s27 offen offset:0  lds
    buffer_load_dwordx4 v3, s[8:11], s27 offen offset:1024  lds
    s_cmp_ge_u32 s32, 2
    s_cbranch_scc1 fb1_right
    v_lshl_add_u32 v19, v16, 4, v17
    v_lshl_add_u32 v46, v18, 3, v17
    v_add_u32 v46, 64, v46
    s_waitcnt vmcnt(12)
    v_lshlrev_b32 v48, 16, v100
    v_and_b32 v49, 0xffff0000, v100
    v_lshlrev_b32 v50, 16, v101
    v_and_b32 v51, 0xffff0000, v101
    v_lshlrev_b32 v52, 16, v102
    v_and_b32 v53, 0xffff0000, v102
    v_lshlrev_b32 v54, 16, v103
    v_and_b32 v55, 0xffff0000, v103
    v_lshlrev_b32 v56, 16, v104
    v_and_b32 v57, 0xffff0000, v104
    v_lshlrev_b32 v58, 16, v105
    v_and_b32 v59, 0xffff0000, v105
    v_lshlrev_b32 v60, 16, v106
    v_and_b32 v61, 0xffff0000, v106
    v_lshlrev_b32 v62, 16, v107
    v_and_b32 v63, 0xffff0000, v107
    v_lshlrev_b32 v64, 16, v108
    v_and_b32 v65, 0xffff0000, v108
    v_lshlrev_b32 v66, 16, v109
    v_and_b32 v67, 0xffff0000, v109
    v_lshlrev_b32 v68, 16, v110
    v_and_b32 v69, 0xffff0000, v110
    v_lshlrev_b32 v70, 16, v111
    v_and_b32 v71, 0xffff0000, v111
    v_mov_b32 v40, v48
    v_mov_b32 v41, v60
    s_waitcnt vmcnt(6)
    ds_write_b128 v96, v[120:123] offset:0
    ds_write_b128 v96, v[124:127] offset:1024
    ds_write_b128 v96, v[128:131] offset:2048
    ds_write_b128 v96, v[132:135] offset:3072
    ds_write_b128 v96, v[136:139] offset:4096
    ds_write_b16 v97, v98
    ds_read_b64_tr_b16 v[72:73], v19 offset:0
    ds_read_b64_tr_b16 v[74:75], v19 offset:320
    ds_read_b64_tr_b16 v[76:77], v19 offset:2560
    ds_read_b64_tr_b16 v[78:79], v19 offset:2880
    ds_read_b64_tr_b16 v[80:81], v19 offset:8
    ds_read_b64_tr_b16 v[82:83], v19 offset:328
    ds_read_b64_tr_b16 v[84:85], v19 offset:2568
    ds_read_b64_tr_b16 v[86:87], v19 offset:2888
    ds_read_b64_tr_b16 v[88:89], v46 offset:0
    ds_read_b64_tr_b16 v[90:91], v46 offset:320
    ds_read_b64_tr_b16 v[92:93], v46 offset:2560
    ds_read_b64_tr_b16 v[94:95], v46 offset:2880
    s_waitcnt lgkmcnt(8)
    v_mfma_f32_16x16x32_bf16 v[48:51], v[72:75], v[20:23], v[48:51]
    v_mfma_f32_16x16x32_bf16 v[60:63], v[72:75], v[28:31], v[60:63]
    v_mfma_f32_16x16x32_bf16 v[48:51], v[76:79], v[24:27], v[48:51]
    v_mfma_f32_16x16x32_bf16 v[60:63], v[76:79], v[32:35], v[60:63]
    s_waitcnt lgkmcnt(4)
    v_mfma_f32_16x16x32_bf16 v[52:55], v[80:83], v[20:23], v[52:55]
    v_mfma_f32_16x16x32_bf16 v[64:67], v[80:83], v[28:31], v[64:67]
    v_mfma_f32_16x16x32_bf16 v[52:55], v[84:87], v[24:27], v[52:55]
    v_mfma_f32_16x16x32_bf16 v[64:67], v[84:87], v[32:35], v[64:67]
    s_waitcnt lgkmcnt(0)
    v_mfma_f32_16x16x32_bf16 v[56:59], v[88:91], v[20:23], v[56:59]
    v_mfma_f32_16x16x32_bf16 v[68:71], v[88:91], v[28:31], v[68:71]
    v_mfma_f32_16x16x32_bf16 v[56:59], v[92:95], v[24:27], v[56:59]
    v_mfma_f32_16x16x32_bf16 v[68:71], v[92:95], v[32:35], v[68:71]
    s_cmp_eq_u32 s33, 0
    s_cselect_b32 s54, 0xffff, 0
    s_mov_b32 s55, 0
    v_cndmask_b32 v48, v48, v40, s[54:55]
    v_cndmask_b32 v60, v60, v41, s[54:55]
    v_cvt_pk_bf16_f32 v100, v48, v49
    v_cvt_pk_bf16_f32 v101, v50, v51
    v_cvt_pk_bf16_f32 v102, v52, v53
    v_cvt_pk_bf16_f32 v103, v54, v55
    v_cvt_pk_bf16_f32 v104, v56, v57
    v_cvt_pk_bf16_f32 v105, v58, v59
    buffer_store_dwordx4 v[100:103], v3, s[8:11], s44 offen sc1
    v_cvt_pk_bf16_f32 v106, v60, v61
    v_cvt_pk_bf16_f32 v107, v62, v63
    v_cvt_pk_bf16_f32 v108, v64, v65
    v_cvt_pk_bf16_f32 v109, v66, v67
    v_cvt_pk_bf16_f32 v110, v68, v69
    v_cvt_pk_bf16_f32 v111, v70, v71
    buffer_store_dwordx4 v[106:109], v3, s[8:11], s45 offen sc1
    s_mov_b64 exec, s[52:53]
    buffer_store_dwordx2 v[104:105], v5, s[8:11], s44 offen offset:1024 sc1
    buffer_store_dwordx2 v[110:111], v5, s[8:11], s45 offen offset:1024 sc1
    s_mov_b64 exec, -1
    v_cndmask_b32 v72, 0, v104, s[52:53]
    v_cndmask_b32 v73, 0, v105, s[52:53]
    v_cndmask_b32 v74, 0, v110, s[52:53]
    v_cndmask_b32 v75, 0, v111, s[52:53]
    v_dot2_f32_bf16 v40, v100, v39, 0
    v_dot2_f32_bf16 v41, v100, v100, 0
    v_dot2_f32_bf16 v40, v101, v39, v40
    v_dot2_f32_bf16 v41, v101, v101, v41
    v_dot2_f32_bf16 v40, v102, v39, v40
    v_dot2_f32_bf16 v41, v102, v102, v41
    v_dot2_f32_bf16 v40, v103, v39, v40
    v_dot2_f32_bf16 v41, v103, v103, v41
    v_dot2_f32_bf16 v40, v72, v39, v40
    v_dot2_f32_bf16 v41, v72, v72, v41
    v_dot2_f32_bf16 v40, v73, v39, v40
    v_dot2_f32_bf16 v41, v73, v73, v41
    v_dot2_f32_bf16 v42, v106, v39, 0
    v_dot2_f32_bf16 v43, v106, v106, 0
    v_dot2_f32_bf16 v42, v107, v39, v42
    v_dot2_f32_bf16 v43, v107, v107, v43
    v_dot2_f32_bf16 v42, v108, v39, v42
    v_dot2_f32_bf16 v43, v108, v108, v43
    v_dot2_f32_bf16 v42, v109, v39, v42
    v_dot2_f32_bf16 v43, v109, v109, v43
    v_dot2_f32_bf16 v42, v74, v39, v42
    v_dot2_f32_bf16 v43, v74, v74, v43
    v_dot2_f32_bf16 v42, v75, v39, v42
    v_dot2_f32_bf16 v43, v75, v75, v43
    v_mov_b32 v76, v40
    v_mov_b32 v77, v41
    v_mov_b32 v78, v42
    v_mov_b32 v79, v43
    v_permlane16_swap_b32 v40, v76
    v_permlane16_swap_b32 v41, v77
    v_permlane16_swap_b32 v42, v78
    v_permlane16_swap_b32 v43, v79
    v_add_f32 v40, v40, v76
    v_add_f32 v41, v41, v77
    v_add_f32 v42, v42, v78
    v_add_f32 v43, v43, v79
    v_mov_b32 v76, v40
    v_mov_b32 v77, v41
    v_mov_b32 v78, v42
    v_mov_b32 v79, v43
    v_permlane32_swap_b32 v40, v76
    v_permlane32_swap_b32 v41, v77
    v_permlane32_swap_b32 v42, v78
    v_permlane32_swap_b32 v43, v79
    v_add_f32 v40, v40, v76
    v_add_f32 v41, v41, v77
    v_add_f32 v42, v42, v78
    v_add_f32 v43, v43, v79
    s_mov_b64 exec, 0xffff0000
    v_mov_b32 v40, v42
    v_mov_b32 v41, v43
    s_mov_b64 exec, s[52:53]
    buffer_store_dwordx2 v[40:41], v9, s[8:11], s50 offen sc1
    s_mov_b64 exec, -1
    s_branch fb1_s2done
fb1_right:
    v_lshlrev_b32 v16, 4, v16
    v_sub_u32 v19, v17, v16
    v_add_u32 v19, 64, v19
    v_lshlrev_b32 v18, 3, v18
    v_sub_u32 v46, v17, v18
    v_add_u32 v46, 8, v46
    s_waitcnt vmcnt(12)
    v_lshlrev_b32 v51, 16, v100
    v_and_b32 v50, 0xffff0000, v100
    v_lshlrev_b32 v49, 16, v101
    v_and_b32 v48, 0xffff0000, v101
    v_lshlrev_b32 v55, 16, v102
    v_and_b32 v54, 0xffff0000, v102
    v_lshlrev_b32 v53, 16, v103
    v_and_b32 v52, 0xffff0000, v103
    v_lshlrev_b32 v59, 16, v104
    v_and_b32 v58, 0xffff0000, v104
    v_lshlrev_b32 v57, 16, v105
    v_and_b32 v56, 0xffff0000, v105
    v_lshlrev_b32 v63, 16, v106
    v_and_b32 v62, 0xffff0000, v106
    v_lshlrev_b32 v61, 16, v107
    v_and_b32 v60, 0xffff0000, v107
    v_lshlrev_b32 v67, 16, v108
    v_and_b32 v66, 0xffff0000, v108
    v_lshlrev_b32 v65, 16, v109
    v_and_b32 v64, 0xffff0000, v109
    v_lshlrev_b32 v71, 16, v110
    v_and_b32 v70, 0xffff0000, v110
    v_lshlrev_b32 v69, 16, v111
    v_and_b32 v68, 0xffff0000, v111
    s_waitcnt vmcnt(6)
    ds_write_b128 v96, v[120:123] offset:0
    ds_write_b128 v96, v[124:127] offset:1024
    ds_write_b128 v96, v[128:131] offset:2048
    ds_write_b128 v96, v[132:135] offset:3072
    ds_write_b128 v96, v[136:139] offset:4096
    ds_read_b64_tr_b16 v[72:73], v19 offset:8
    ds_read_b64_tr_b16 v[74:75], v19 offset:328
    ds_read_b64_tr_b16 v[76:77], v19 offset:2568
    ds_read_b64_tr_b16 v[78:79], v19 offset:2888
    ds_read_b64_tr_b16 v[80:81], v19 offset:0
    ds_read_b64_tr_b16 v[82:83], v19 offset:320
    ds_read_b64_tr_b16 v[84:85], v19 offset:2560
    ds_read_b64_tr_b16 v[86:87], v19 offset:2880
    ds_read_b64_tr_b16 v[88:89], v46 offset:0
    ds_read_b64_tr_b16 v[90:91], v46 offset:320
    ds_read_b64_tr_b16 v[92:93], v46 offset:2560
    ds_read_b64_tr_b16 v[94:95], v46 offset:2880
    s_waitcnt lgkmcnt(8)
    v_mfma_f32_16x16x32_bf16 v[48:51], v[72:75], v[20:23], v[48:51]
    v_mfma_f32_16x16x32_bf16 v[60:63], v[72:75], v[28:31], v[60:63]
    v_mfma_f32_16x16x32_bf16 v[48:51], v[76:79], v[24:27], v[48:51]
    v_mfma_f32_16x16x32_bf16 v[60:63], v[76:79], v[32:35], v[60:63]
    s_waitcnt lgkmcnt(4)
    v_mfma_f32_16x16x32_bf16 v[52:55], v[80:83], v[20:23], v[52:55]
    v_mfma_f32_16x16x32_bf16 v[64:67], v[80:83], v[28:31], v[64:67]
    v_mfma_f32_16x16x32_bf16 v[52:55], v[84:87], v[24:27], v[52:55]
    v_mfma_f32_16x16x32_bf16 v[64:67], v[84:87], v[32:35], v[64:67]
    s_waitcnt lgkmcnt(0)
    v_mfma_f32_16x16x32_bf16 v[56:59], v[88:91], v[20:23], v[56:59]
    v_mfma_f32_16x16x32_bf16 v[68:71], v[88:91], v[28:31], v[68:71]
    v_mfma_f32_16x16x32_bf16 v[56:59], v[92:95], v[24:27], v[56:59]
    v_mfma_f32_16x16x32_bf16 v[68:71], v[92:95], v[32:35], v[68:71]
    v_cvt_pk_bf16_f32 v100, v51, v50
    v_cvt_pk_bf16_f32 v101, v49, v48
    v_cvt_pk_bf16_f32 v102, v55, v54
    v_cvt_pk_bf16_f32 v103, v53, v52
    s_nop 2
    v_cvt_pk_bf16_f32 v104, v59, v58
    v_cvt_pk_bf16_f32 v105, v57, v56
    buffer_store_dwordx4 v[100:103], v3, s[8:11], s44 offen sc1
    v_cvt_pk_bf16_f32 v106, v63, v62
    v_cvt_pk_bf16_f32 v107, v61, v60
    v_cvt_pk_bf16_f32 v108, v67, v66
    v_cvt_pk_bf16_f32 v109, v65, v64
    v_cvt_pk_bf16_f32 v110, v71, v70
    v_cvt_pk_bf16_f32 v111, v69, v68
    buffer_store_dwordx4 v[106:109], v3, s[8:11], s45 offen sc1
    s_mov_b64 exec, s[52:53]
    buffer_store_dwordx2 v[104:105], v5, s[8:11], s44 offen offset:1024 sc1
    buffer_store_dwordx2 v[110:111], v5, s[8:11], s45 offen offset:1024 sc1
    s_mov_b64 exec, -1
    v_cndmask_b32 v72, 0, v104, s[52:53]
    v_cndmask_b32 v73, 0, v105, s[52:53]
    v_cndmask_b32 v74, 0, v110, s[52:53]
    v_cndmask_b32 v75, 0, v111, s[52:53]
    v_dot2_f32_bf16 v40, v100, v39, 0
    v_dot2_f32_bf16 v41, v100, v100, 0
    v_dot2_f32_bf16 v40, v101, v39, v40
    v_dot2_f32_bf16 v41, v101, v101, v41
    v_dot2_f32_bf16 v40, v102, v39, v40
    v_dot2_f32_bf16 v41, v102, v102, v41
    v_dot2_f32_bf16 v40, v103, v39, v40
    v_dot2_f32_bf16 v41, v103, v103, v41
    v_dot2_f32_bf16 v40, v72, v39, v40
    v_dot2_f32_bf16 v41, v72, v72, v41
    v_dot2_f32_bf16 v40, v73, v39, v40
    v_dot2_f32_bf16 v41, v73, v73, v41
    v_dot2_f32_bf16 v42, v106, v39, 0
    v_dot2_f32_bf16 v43, v106, v106, 0
    v_dot2_f32_bf16 v42, v107, v39, v42
    v_dot2_f32_bf16 v43, v107, v107, v43
    v_dot2_f32_bf16 v42, v108, v39, v42
    v_dot2_f32_bf16 v43, v108, v108, v43
    v_dot2_f32_bf16 v42, v109, v39, v42
    v_dot2_f32_bf16 v43, v109, v109, v43
    v_dot2_f32_bf16 v42, v74, v39, v42
    v_dot2_f32_bf16 v43, v74, v74, v43
    v_dot2_f32_bf16 v42, v75, v39, v42
    v_dot2_f32_bf16 v43, v75, v75, v43
    v_mov_b32 v76, v40
    v_mov_b32 v77, v41
    v_mov_b32 v78, v42
    v_mov_b32 v79, v43
    v_permlane16_swap_b32 v40, v76
    v_permlane16_swap_b32 v41, v77
    v_permlane16_swap_b32 v42, v78
    v_permlane16_swap_b32 v43, v79
    v_add_f32 v40, v40, v76
    v_add_f32 v41, v41, v77
    v_add_f32 v42, v42, v78
    v_add_f32 v43, v43, v79
    v_mov_b32 v76, v40
    v_mov_b32 v77, v41
    v_mov_b32 v78, v42
    v_mov_b32 v79, v43
    v_permlane32_swap_b32 v40, v76
    v_permlane32_swap_b32 v41, v77
    v_permlane32_swap_b32 v42, v78
    v_permlane32_swap_b32 v43, v79
    v_add_f32 v40, v40, v76
    v_add_f32 v41, v41, v77
    v_add_f32 v42, v42, v78
    v_add_f32 v43, v43, v79
    s_mov_b64 exec, 0xffff0000
    v_mov_b32 v40, v42
    v_mov_b32 v41, v43
    s_mov_b64 exec, s[52:53]
    buffer_store_dwordx2 v[40:41], v9, s[8:11], s50 offen sc1
    s_mov_b64 exec, -1
fb1_s2done:
    s_add_u32 s27, s25, 122880
    s_add_u32 m0, s26, 122880
    s_nop 0
    buffer_load_dwordx4 v3, s[8:11], s27 offen offset:0  lds
    buffer_load_dwordx4 v3, s[8:11], s27 offen offset:1024  lds
    buffer_load_dwordx4 v3, s[8:11], s27 offen offset:2048  lds
    buffer_load_dwordx4 v3, s[8:11], s27 offen offset:3072  lds
    s_add_u32 s27, s27, 4096
    s_add_u32 m0, s26, 126976
    s_nop 0
    buffer_load_dwordx4 v3, s[8:11], s27 offen offset:0  lds
    s_waitcnt vmcnt(5)
    s_lshr_b32 s56, s38, 1
    s_lshr_b32 s57, s32, 1
    s_lshl_b32 s58, s33, 1
    s_add_u32 s57, s57, s58
    s_lshl_b32 s56, s56, 10
    s_lshl_b32 s57, s57, 5
    s_add_u32 s56, s56, s57
    s_add_u32 s56, s56, 37621760
    v_mov_b32 v252, s100
    v_mov_b32 v253, s101
    s_mov_b64 exec, 1
    buffer_store_dwordx2 v[252:253], v3, s[8:11], s56 offen sc1
    s_mov_b64 exec, -1
    buffer_load_dwordx4 v3, s[8:11], s27 offen offset:1024  lds
    s_lshl_b32 s33, s20, 2
    s_add_u32 s33, s33, s32
    s_mul_i32 s34, s33, 40960
    s_add_u32 s34, s34, 10485760
    s_mul_i32 s40, s33, 98304
    s_mul_i32 s41, s21, 3072
    s_add_u32 s40, s40, s41
    s_add_u32 s40, s40, 20971520
    s_add_u32 s41, s40, 49152
    s_lshl_b32 s43, s33, 12
    s_add_u32 s43, s43, 14155776
    v_lshlrev_b32 v15, 3, v8
    v_lshl_add_u32 v15, v4, 7, v15
    v_lshlrev_b32 v14, 4, v8
    v_add_u32 v14, 147456, v14
    v_add_u32 v5, 49152, v3
    v_add_u32 v6, 98304, v3
    s_mov_b32 s46, 0xffff
    s_mov_b32 s47, 0
    s_add_u32 s56, s32, 0
    s_and_b32 s56, s56, 3
    s_lshl_b32 s57, s60, 2
    s_add_u32 s57, s57, s56
    s_mul_i32 s57, s57, 49152
    s_mul_i32 s56, s32, 12288
    s_add_u32 s57, s57, s56
    s_add_u32 s48, s57, 20971520
    s_add_u32 s56, s32, 1
    s_and_b32 s56, s56, 3
    s_lshl_b32 s57, s60, 2
    s_add_u32 s57, s57, s56
    s_mul_i32 s57, s57, 49152
    s_mul_i32 s56, s32, 12288
    s_add_u32 s57, s57, s56
    s_add_u32 s49, s57, 20971520
    s_add_u32 s56, s32, 2
    s_and_b32 s56, s56, 3
    s_lshl_b32 s57, s60, 2
    s_add_u32 s57, s57, s56
    s_mul_i32 s57, s57, 49152
    s_mul_i32 s56, s32, 12288
    s_add_u32 s57, s57, s56
    s_add_u32 s50, s57, 20971520
    s_add_u32 s56, s32, 3
    s_and_b32 s56, s56, 3
    s_lshl_b32 s57, s60, 2
    s_add_u32 s57, s57, s56
    s_mul_i32 s57, s57, 49152
    s_mul_i32 s56, s32, 12288
    s_add_u32 s57, s57, s56
    s_add_u32 s51, s57, 20971520
    s_lshl_b32 s56, s60, 2
    s_add_u32 s56, s56, s32
    s_mul_i32 s56, s56, 20480
    s_mul_i32 s57, s61, 2560
    s_add_u32 s52, s56, s57
    s_mul_i32 s53, s32, 12288
    s_lshl_b32 s54, s32, 13
    s_mul_i32 s56, s32, 12288
    s_sub_u32 s55, s48, s56
    s_add_u32 s55, s55, 2048
    s_lshl_b32 s57, s20, 2
    s_add_u32 s57, s57, s32
    s_mov_b32 s58, 0
    s_lshl_b32 s57, s57, 10
    s_lshl_b32 s58, s58, 5
    s_add_u32 s57, s57, s58
    s_add_u32 s59, s57, 37621760
    v_lshlrev_b32 v254, 5, v2
    s_waitcnt vmcnt(47)
    s_barrier
    s_mov_b64 exec, 0xffff
    s_mov_b32 s58, 0x40000
sync_16_p:
    buffer_load_dwordx2 v[252:253], v254, s[8:11], s59 offen sc1
    s_sub_u32 s58, s58, 1
    s_waitcnt vmcnt(0)
    v_cmp_ne_u64 vcc, s[100:101], v[252:253]
    s_cbranch_scc1 sync_16_x
    s_cbranch_vccnz sync_16_p
sync_16_x:
    s_mov_b64 exec, -1
    s_add_u32 s38, s34, 0
    buffer_load_dwordx4 a[0:3], v3, s[8:11], s38 offen offset:0 sc1
    s_add_u32 s39, s34, 20480
    buffer_load_dwordx4 a[4:7], v3, s[8:11], s39 offen offset:0 sc1
    buffer_load_dwordx4 a[8:11], v3, s[8:11], s38 offen offset:1024 sc1
    buffer_load_dwordx4 a[12:15], v3, s[8:11], s39 offen offset:1024 sc1
    ds_read_b128 v[112:115], v3 offset:0
    ds_read_b128 v[116:119], v3 offset:1024
    ds_read_b128 v[120:123], v3 offset:2048
    ds_read_b128 v[124:127], v3 offset:3072
    ds_read_b128 v[128:131], v3 offset:4096
    ds_read_b128 v[132:135], v3 offset:5120
    ds_read_b128 v[136:139], v3 offset:6144
    ds_read_b128 v[140:143], v3 offset:7168
    s_waitcnt vmcnt(2)
    s_waitcnt lgkmcnt(6)
    v_mfma_f32_16x16x32_bf16 v[16:19], v[112:115], a[0:3], 0
    ds_read_b128 v[144:147], v3 offset:8192
    v_mfma_f32_16x16x32_bf16 v[20:23], v[112:115], a[4:7], 0
    buffer_load_dwordx4 a[16:19], v3, s[8:11], s38 offen offset:2048 sc1
    v_mfma_f32_16x16x32_bf16 v[28:31], v[116:119], a[4:7], 0
    ds_read_b128 v[148:151], v3 offset:9216
    v_mfma_f32_16x16x32_bf16 v[24:27], v[116:119], a[0:3], 0
    s_waitcnt lgkmcnt(6)
    v_mfma_f32_16x16x32_bf16 v[32:35], v[120:123], a[0:3], 0
    ds_read_b128 v[112:115], v3 offset:10240
    v_mfma_f32_16x16x32_bf16 v[36:39], v[120:123], a[4:7], 0
    buffer_load_dwordx4 a[20:23], v3, s[8:11], s39 offen offset:2048 sc1
    v_mfma_f32_16x16x32_bf16 v[44:47], v[124:127], a[4:7], 0
    ds_read_b128 v[116:119], v3 offset:11264
    v_mfma_f32_16x16x32_bf16 v[40:43], v[124:127], a[0:3], 0
    s_waitcnt lgkmcnt(6)
    v_mfma_f32_16x16x32_bf16 v[48:51], v[128:131], a[0:3], 0
    ds_read_b128 v[120:123], v3 offset:12288
    v_mfma_f32_16x16x32_bf16 v[52:55], v[128:131], a[4:7], 0
    buffer_load_dwordx4 a[24:27], v3, s[8:11], s38 offen offset:3072 sc1
    v_mfma_f32_16x16x32_bf16 v[60:63], v[132:135], a[4:7], 0
    ds_read_b128 v[124:127], v3 offset:13312
    v_mfma_f32_16x16x32_bf16 v[56:59], v[132:135], a[0:3], 0
    s_waitcnt lgkmcnt(6)
    v_mfma_f32_16x16x32_bf16 v[64:67], v[136:139], a[0:3], 0
    ds_read_b128 v[128:131], v3 offset:14336
    v_mfma_f32_16x16x32_bf16 v[68:71], v[136:139], a[4:7], 0
    buffer_load_dwordx4 a[28:31], v3, s[8:11], s39 offen offset:3072 sc1
    v_mfma_f32_16x16x32_bf16 v[76:79], v[140:143], a[4:7], 0
    ds_read_b128 v[132:135], v3 offset:15360
    v_mfma_f32_16x16x32_bf16 v[72:75], v[140:143], a[0:3], 0
    s_waitcnt lgkmcnt(6)
    v_mfma_f32_16x16x32_bf16 v[80:83], v[144:147], a[0:3], 0
    ds_read_b128 v[136:139], v3 offset:16384
    v_mfma_f32_16x16x32_bf16 v[84:87], v[144:147], a[4:7], 0
    s_add_u32 s38, s34, 4096
    buffer_load_dwordx4 a[32:35], v3, s[8:11], s38 offen offset:0 sc1
    v_mfma_f32_16x16x32_bf16 v[92:95], v[148:151], a[4:7], 0
    ds_read_b128 v[140:143], v3 offset:17408
    v_mfma_f32_16x16x32_bf16 v[88:91], v[148:151], a[0:3], 0
    s_waitcnt lgkmcnt(6)
    v_mfma_f32_16x16x32_bf16 v[96:99], v[112:115], a[0:3], 0
    ds_read_b128 v[144:147], v3 offset:18432
    v_mfma_f32_16x16x32_bf16 v[100:103], v[112:115], a[4:7], 0
    s_add_u32 s39, s34, 24576
    buffer_load_dwordx4 a[36:39], v3, s[8:11], s39 offen offset:0 sc1
    v_mfma_f32_16x16x32_bf16 v[108:111], v[116:119], a[4:7], 0
    ds_read_b128 v[148:151], v3 offset:19456
    v_mfma_f32_16x16x32_bf16 v[104:107], v[116:119], a[0:3], 0
    s_waitcnt vmcnt(6)
    s_waitcnt lgkmcnt(6)
    v_mfma_f32_16x16x32_bf16 v[16:19], v[120:123], a[8:11], v[16:19]
    ds_read_b128 v[112:115], v3 offset:20480
    v_mfma_f32_16x16x32_bf16 v[20:23], v[120:123], a[12:15], v[20:23]
    buffer_load_dwordx4 a[40:43], v3, s[8:11], s38 offen offset:1024 sc1
    v_mfma_f32_16x16x32_bf16 v[28:31], v[124:127], a[12:15], v[28:31]
    ds_read_b128 v[116:119], v3 offset:21504
    v_mfma_f32_16x16x32_bf16 v[24:27], v[124:127], a[8:11], v[24:27]
    s_waitcnt lgkmcnt(6)
    v_mfma_f32_16x16x32_bf16 v[32:35], v[128:131], a[8:11], v[32:35]
    ds_read_b128 v[120:123], v3 offset:22528
    v_mfma_f32_16x16x32_bf16 v[36:39], v[128:131], a[12:15], v[36:39]
    buffer_load_dwordx4 a[44:47], v3, s[8:11], s39 offen offset:1024 sc1
    v_mfma_f32_16x16x32_bf16 v[44:47], v[132:135], a[12:15], v[44:47]
    ds_read_b128 v[124:127], v3 offset:23552
    v_mfma_f32_16x16x32_bf16 v[40:43], v[132:135], a[8:11], v[40:43]
    s_waitcnt vmcnt(52)
    s_barrier
    s_waitcnt lgkmcnt(6)
    v_mfma_f32_16x16x32_bf16 v[48:51], v[136:139], a[8:11], v[48:51]
    ds_read_b128 v[128:131], v3 offset:24576
    v_mfma_f32_16x16x32_bf16 v[52:55], v[136:139], a[12:15], v[52:55]
    buffer_load_dwordx4 a[48:51], v3, s[8:11], s38 offen offset:2048 sc1
    v_mfma_f32_16x16x32_bf16 v[60:63], v[140:143], a[12:15], v[60:63]
    ds_read_b128 v[132:135], v3 offset:25600
    v_mfma_f32_16x16x32_bf16 v[56:59], v[140:143], a[8:11], v[56:59]
    s_waitcnt lgkmcnt(6)
    v_mfma_f32_16x16x32_bf16 v[64:67], v[144:147], a[8:11], v[64:67]
    ds_read_b128 v[136:139], v3 offset:26624
    v_mfma_f32_16x16x32_bf16 v[68:71], v[144:147], a[12:15], v[68:71]
    buffer_load_dwordx4 a[52:55], v3, s[8:11], s39 offen offset:2048 sc1
    v_mfma_f32_16x16x32_bf16 v[76:79], v[148:151], a[12:15], v[76:79]
    ds_read_b128 v[140:143], v3 offset:27648
    v_mfma_f32_16x16x32_bf16 v[72:75], v[148:151], a[8:11], v[72:75]
    s_waitcnt lgkmcnt(6)
    v_mfma_f32_16x16x32_bf16 v[80:83], v[112:115], a[8:11], v[80:83]
    ds_read_b128 v[144:147], v3 offset:28672
    v_mfma_f32_16x16x32_bf16 v[84:87], v[112:115], a[12:15], v[84:87]
    buffer_load_dwordx4 a[56:59], v3, s[8:11], s38 offen offset:3072 sc1
    v_mfma_f32_16x16x32_bf16 v[92:95], v[116:119], a[12:15], v[92:95]
    ds_read_b128 v[148:151], v3 offset:29696
    v_mfma_f32_16x16x32_bf16 v[88:91], v[116:119], a[8:11], v[88:91]
    s_waitcnt lgkmcnt(6)
    v_mfma_f32_16x16x32_bf16 v[96:99], v[120:123], a[8:11], v[96:99]
    ds_read_b128 v[112:115], v3 offset:30720
    v_mfma_f32_16x16x32_bf16 v[100:103], v[120:123], a[12:15], v[100:103]
    buffer_load_dwordx4 a[60:63], v3, s[8:11], s39 offen offset:3072 sc1
    v_mfma_f32_16x16x32_bf16 v[108:111], v[124:127], a[12:15], v[108:111]
    ds_read_b128 v[116:119], v3 offset:31744
    v_mfma_f32_16x16x32_bf16 v[104:107], v[124:127], a[8:11], v[104:107]
    s_waitcnt vmcnt(10)
    s_waitcnt lgkmcnt(6)
    v_mfma_f32_16x16x32_bf16 v[16:19], v[128:131], a[16:19], v[16:19]
    ds_read_b128 v[120:123], v3 offset:32768
    v_mfma_f32_16x16x32_bf16 v[20:23], v[128:131], a[20:23], v[20:23]
    s_add_u32 s38, s34, 8192
    buffer_load_dwordx4 a[64:67], v3, s[8:11], s38 offen offset:0 sc1
    v_mfma_f32_16x16x32_bf16 v[28:31], v[132:135], a[20:23], v[28:31]
    ds_read_b128 v[124:127], v3 offset:33792
    v_mfma_f32_16x16x32_bf16 v[24:27], v[132:135], a[16:19], v[24:27]
    s_waitcnt lgkmcnt(6)
    v_mfma_f32_16x16x32_bf16 v[32:35], v[136:139], a[16:19], v[32:35]
    ds_read_b128 v[128:131], v3 offset:34816
    v_mfma_f32_16x16x32_bf16 v[36:39], v[136:139], a[20:23], v[36:39]
    s_add_u32 s39, s34, 28672
    buffer_load_dwordx4 a[68:71], v3, s[8:11], s39 offen offset:0 sc1
    v_mfma_f32_16x16x32_bf16 v[44:47], v[140:143], a[20:23], v[44:47]
    ds_read_b128 v[132:135], v3 offset:35840
    v_mfma_f32_16x16x32_bf16 v[40:43], v[140:143], a[16:19], v[40:43]
    s_waitcnt lgkmcnt(6)
    v_mfma_f32_16x16x32_bf16 v[48:51], v[144:147], a[16:19], v[48:51]
    ds_read_b128 v[136:139], v3 offset:36864
    v_mfma_f32_16x16x32_bf16 v[52:55], v[144:147], a[20:23], v[52:55]
    buffer_load_dwordx4 a[72:75], v3, s[8:11], s38 offen offset:1024 sc1
    v_mfma_f32_16x16x32_bf16 v[60:63], v[148:151], a[20:23], v[60:63]
    ds_read_b128 v[140:143], v3 offset:37888
    v_mfma_f32_16x16x32_bf16 v[56:59], v[148:151], a[16:19], v[56:59]
    s_waitcnt lgkmcnt(6)
    v_mfma_f32_16x16x32_bf16 v[64:67], v[112:115], a[16:19], v[64:67]
    ds_read_b128 v[144:147], v3 offset:38912
    v_mfma_f32_16x16x32_bf16 v[68:71], v[112:115], a[20:23], v[68:71]
    buffer_load_dwordx4 a[76:79], v3, s[8:11], s39 offen offset:1024 sc1
    v_mfma_f32_16x16x32_bf16 v[76:79], v[116:119], a[20:23], v[76:79]
    ds_read_b128 v[148:151], v3 offset:39936
    v_mfma_f32_16x16x32_bf16 v[72:75], v[116:119], a[16:19], v[72:75]
    s_waitcnt lgkmcnt(6)
    v_mfma_f32_16x16x32_bf16 v[80:83], v[120:123], a[16:19], v[80:83]
    ds_read_b128 v[112:115], v3 offset:40960
    v_mfma_f32_16x16x32_bf16 v[84:87], v[120:123], a[20:23], v[84:87]
    buffer_load_dwordx2 v[160:161], v15, s[8:11], s43 offen offset:0 sc1
    v_mfma_f32_16x16x32_bf16 v[92:95], v[124:127], a[20:23], v[92:95]
    ds_read_b128 v[116:119], v3 offset:41984
    v_mfma_f32_16x16x32_bf16 v[88:91], v[124:127], a[16:19], v[88:91]
    s_waitcnt lgkmcnt(6)
    v_mfma_f32_16x16x32_bf16 v[96:99], v[128:131], a[16:19], v[96:99]
    ds_read_b128 v[120:123], v3 offset:43008
    v_mfma_f32_16x16x32_bf16 v[100:103], v[128:131], a[20:23], v[100:103]
    buffer_load_dwordx2 v[162:163], v15, s[8:11], s43 offen offset:512 sc1
    v_mfma_f32_16x16x32_bf16 v[108:111], v[132:135], a[20:23], v[108:111]
    ds_read_b128 v[124:127], v3 offset:44032
    v_mfma_f32_16x16x32_bf16 v[104:107], v[132:135], a[16:19], v[104:107]
    s_waitcnt vmcnt(14)
    s_waitcnt lgkmcnt(6)
    v_mfma_f32_16x16x32_bf16 v[16:19], v[136:139], a[24:27], v[16:19]
    ds_read_b128 v[128:131], v3 offset:45056
    v_mfma_f32_16x16x32_bf16 v[20:23], v[136:139], a[28:31], v[20:23]
    buffer_load_dwordx2 v[164:165], v15, s[8:11], s43 offen offset:1024 sc1
    v_mfma_f32_16x16x32_bf16 v[28:31], v[140:143], a[28:31], v[28:31]
    ds_read_b128 v[132:135], v3 offset:46080
    v_mfma_f32_16x16x32_bf16 v[24:27], v[140:143], a[24:27], v[24:27]
    s_waitcnt lgkmcnt(6)
    v_mfma_f32_16x16x32_bf16 v[32:35], v[144:147], a[24:27], v[32:35]
    ds_read_b128 v[136:139], v3 offset:47104
    v_mfma_f32_16x16x32_bf16 v[36:39], v[144:147], a[28:31], v[36:39]
    buffer_load_dwordx2 v[166:167], v15, s[8:11], s43 offen offset:1536 sc1
    v_mfma_f32_16x16x32_bf16 v[44:47], v[148:151], a[28:31], v[44:47]
    ds_read_b128 v[140:143], v3 offset:48128
    v_mfma_f32_16x16x32_bf16 v[40:43], v[148:151], a[24:27], v[40:43]
    s_waitcnt vmcnt(58)
    s_barrier
    s_waitcnt lgkmcnt(6)
    v_mfma_f32_16x16x32_bf16 v[48:51], v[112:115], a[24:27], v[48:51]
    ds_read_b128 v[144:147], v5 offset:0
    v_mfma_f32_16x16x32_bf16 v[52:55], v[112:115], a[28:31], v[52:55]
    buffer_load_dwordx2 v[168:169], v15, s[8:11], s43 offen offset:2048 sc1
    v_mfma_f32_16x16x32_bf16 v[60:63], v[116:119], a[28:31], v[60:63]
    ds_read_b128 v[148:151], v5 offset:1024
    v_mfma_f32_16x16x32_bf16 v[56:59], v[116:119], a[24:27], v[56:59]
    s_waitcnt lgkmcnt(6)
    v_mfma_f32_16x16x32_bf16 v[64:67], v[120:123], a[24:27], v[64:67]
    ds_read_b128 v[112:115], v5 offset:2048
    v_mfma_f32_16x16x32_bf16 v[68:71], v[120:123], a[28:31], v[68:71]
    buffer_load_dwordx2 v[170:171], v15, s[8:11], s43 offen offset:2560 sc1
    v_mfma_f32_16x16x32_bf16 v[76:79], v[124:127], a[28:31], v[76:79]
    ds_read_b128 v[116:119], v5 offset:3072
    v_mfma_f32_16x16x32_bf16 v[72:75], v[124:127], a[24:27], v[72:75]
    s_waitcnt lgkmcnt(6)
    v_mfma_f32_16x16x32_bf16 v[80:83], v[128:131], a[24:27], v[80:83]
    ds_read_b128 v[120:123], v5 offset:4096
    v_mfma_f32_16x16x32_bf16 v[84:87], v[128:131], a[28:31], v[84:87]
    buffer_load_dwordx2 v[172:173], v15, s[8:11], s43 offen offset:3072 sc1
    v_mfma_f32_16x16x32_bf16 v[92:95], v[132:135], a[28:31], v[92:95]
    ds_read_b128 v[124:127], v5 offset:5120
    v_mfma_f32_16x16x32_bf16 v[88:91], v[132:135], a[24:27], v[88:91]
    s_waitcnt lgkmcnt(6)
    v_mfma_f32_16x16x32_bf16 v[96:99], v[136:139], a[24:27], v[96:99]
    ds_read_b128 v[128:131], v5 offset:6144
    v_mfma_f32_16x16x32_bf16 v[100:103], v[136:139], a[28:31], v[100:103]
    buffer_load_dwordx2 v[174:175], v15, s[8:11], s43 offen offset:3584 sc1
    v_mfma_f32_16x16x32_bf16 v[108:111], v[140:143], a[28:31], v[108:111]
    ds_read_b128 v[132:135], v5 offset:7168
    v_mfma_f32_16x16x32_bf16 v[104:107], v[140:143], a[24:27], v[104:107]
    s_waitcnt vmcnt(18)
    s_waitcnt lgkmcnt(6)
    v_mfma_f32_16x16x32_bf16 v[16:19], v[144:147], a[32:35], v[16:19]
    ds_read_b128 v[136:139], v5 offset:8192
    v_mfma_f32_16x16x32_bf16 v[20:23], v[144:147], a[36:39], v[20:23]
    buffer_load_dwordx4 a[80:83], v3, s[8:11], s38 offen offset:2048 sc1
    v_mfma_f32_16x16x32_bf16 v[28:31], v[148:151], a[36:39], v[28:31]
    ds_read_b128 v[140:143], v5 offset:9216
    v_mfma_f32_16x16x32_bf16 v[24:27], v[148:151], a[32:35], v[24:27]
    s_waitcnt lgkmcnt(6)
    v_mfma_f32_16x16x32_bf16 v[32:35], v[112:115], a[32:35], v[32:35]
    ds_read_b128 v[144:147], v5 offset:10240
    v_mfma_f32_16x16x32_bf16 v[36:39], v[112:115], a[36:39], v[36:39]
    buffer_load_dwordx4 a[84:87], v3, s[8:11], s39 offen offset:2048 sc1
    v_mfma_f32_16x16x32_bf16 v[44:47], v[116:119], a[36:39], v[44:47]
    ds_read_b128 v[148:151], v5 offset:11264
    v_mfma_f32_16x16x32_bf16 v[40:43], v[116:119], a[32:35], v[40:43]
    s_waitcnt lgkmcnt(6)
    v_mfma_f32_16x16x32_bf16 v[48:51], v[120:123], a[32:35], v[48:51]
    ds_read_b128 v[112:115], v5 offset:12288
    v_mfma_f32_16x16x32_bf16 v[52:55], v[120:123], a[36:39], v[52:55]
    buffer_load_dwordx4 a[88:91], v3, s[8:11], s38 offen offset:3072 sc1
    v_mfma_f32_16x16x32_bf16 v[60:63], v[124:127], a[36:39], v[60:63]
    ds_read_b128 v[116:119], v5 offset:13312
    v_mfma_f32_16x16x32_bf16 v[56:59], v[124:127], a[32:35], v[56:59]
    s_waitcnt lgkmcnt(6)
    v_mfma_f32_16x16x32_bf16 v[64:67], v[128:131], a[32:35], v[64:67]
    ds_read_b128 v[120:123], v5 offset:14336
    v_mfma_f32_16x16x32_bf16 v[68:71], v[128:131], a[36:39], v[68:71]
    buffer_load_dwordx4 a[92:95], v3, s[8:11], s39 offen offset:3072 sc1
    v_mfma_f32_16x16x32_bf16 v[76:79], v[132:135], a[36:39], v[76:79]
    ds_read_b128 v[124:127], v5 offset:15360
    v_mfma_f32_16x16x32_bf16 v[72:75], v[132:135], a[32:35], v[72:75]
    s_waitcnt lgkmcnt(6)
    v_mfma_f32_16x16x32_bf16 v[80:83], v[136:139], a[32:35], v[80:83]
    ds_read_b128 v[128:131], v5 offset:16384
    v_mfma_f32_16x16x32_bf16 v[84:87], v[136:139], a[36:39], v[84:87]
    s_add_u32 s38, s34, 12288
    buffer_load_dwordx4 a[96:99], v3, s[8:11], s38 offen offset:0 sc1
    v_mfma_f32_16x16x32_bf16 v[92:95], v[140:143], a[36:39], v[92:95]
    ds_read_b128 v[132:135], v5 offset:17408
    v_mfma_f32_16x16x32_bf16 v[88:91], v[140:143], a[32:35], v[88:91]
    s_waitcnt lgkmcnt(6)
    v_mfma_f32_16x16x32_bf16 v[96:99], v[144:147], a[32:35], v[96:99]
    ds_read_b128 v[136:139], v5 offset:18432
    v_mfma_f32_16x16x32_bf16 v[100:103], v[144:147], a[36:39], v[100:103]
    s_add_u32 s39, s34, 32768
    buffer_load_dwordx4 a[100:103], v3, s[8:11], s39 offen offset:0 sc1
    v_mfma_f32_16x16x32_bf16 v[108:111], v[148:151], a[36:39], v[108:111]
    ds_read_b128 v[140:143], v5 offset:19456
    v_mfma_f32_16x16x32_bf16 v[104:107], v[148:151], a[32:35], v[104:107]
    s_waitcnt vmcnt(22)
    s_waitcnt lgkmcnt(6)
    v_mfma_f32_16x16x32_bf16 v[16:19], v[112:115], a[40:43], v[16:19]
    ds_read_b128 v[144:147], v5 offset:20480
    v_mfma_f32_16x16x32_bf16 v[20:23], v[112:115], a[44:47], v[20:23]
    buffer_load_dwordx4 a[104:107], v3, s[8:11], s38 offen offset:1024 sc1
    v_mfma_f32_16x16x32_bf16 v[28:31], v[116:119], a[44:47], v[28:31]
    ds_read_b128 v[148:151], v5 offset:21504
    v_mfma_f32_16x16x32_bf16 v[24:27], v[116:119], a[40:43], v[24:27]
    s_waitcnt lgkmcnt(6)
    v_mfma_f32_16x16x32_bf16 v[32:35], v[120:123], a[40:43], v[32:35]
    ds_read_b128 v[112:115], v5 offset:22528
    v_mfma_f32_16x16x32_bf16 v[36:39], v[120:123], a[44:47], v[36:39]
    buffer_load_dwordx4 a[108:111], v3, s[8:11], s39 offen offset:1024 sc1
    v_mfma_f32_16x16x32_bf16 v[44:47], v[124:127], a[44:47], v[44:47]
    ds_read_b128 v[116:119], v5 offset:23552
    v_mfma_f32_16x16x32_bf16 v[40:43], v[124:127], a[40:43], v[40:43]
    s_waitcnt vmcnt(63)
    s_barrier
    s_waitcnt lgkmcnt(6)
    v_mfma_f32_16x16x32_bf16 v[48:51], v[128:131], a[40:43], v[48:51]
    ds_read_b128 v[120:123], v5 offset:24576
    v_mfma_f32_16x16x32_bf16 v[52:55], v[128:131], a[44:47], v[52:55]
    buffer_load_dwordx4 a[112:115], v3, s[8:11], s38 offen offset:2048 sc1
    v_mfma_f32_16x16x32_bf16 v[60:63], v[132:135], a[44:47], v[60:63]
    ds_read_b128 v[124:127], v5 offset:25600
    v_mfma_f32_16x16x32_bf16 v[56:59], v[132:135], a[40:43], v[56:59]
    s_waitcnt lgkmcnt(6)
    v_mfma_f32_16x16x32_bf16 v[64:67], v[136:139], a[40:43], v[64:67]
    ds_read_b128 v[128:131], v5 offset:26624
    v_mfma_f32_16x16x32_bf16 v[68:71], v[136:139], a[44:47], v[68:71]
    buffer_load_dwordx4 a[116:119], v3, s[8:11], s39 offen offset:2048 sc1
    v_mfma_f32_16x16x32_bf16 v[76:79], v[140:143], a[44:47], v[76:79]
    ds_read_b128 v[132:135], v5 offset:27648
    v_mfma_f32_16x16x32_bf16 v[72:75], v[140:143], a[40:43], v[72:75]
    s_waitcnt lgkmcnt(6)
    v_mfma_f32_16x16x32_bf16 v[80:83], v[144:147], a[40:43], v[80:83]
    ds_read_b128 v[136:139], v5 offset:28672
    v_mfma_f32_16x16x32_bf16 v[84:87], v[144:147], a[44:47], v[84:87]
    buffer_load_dwordx4 a[120:123], v3, s[8:11], s38 offen offset:3072 sc1
    v_mfma_f32_16x16x32_bf16 v[92:95], v[148:151], a[44:47], v[92:95]
    ds_read_b128 v[140:143], v5 offset:29696
    v_mfma_f32_16x16x32_bf16 v[88:91], v[148:151], a[40:43], v[88:91]
    s_waitcnt lgkmcnt(6)
    v_mfma_f32_16x16x32_bf16 v[96:99], v[112:115], a[40:43], v[96:99]
    ds_read_b128 v[144:147], v5 offset:30720
    v_mfma_f32_16x16x32_bf16 v[100:103], v[112:115], a[44:47], v[100:103]
    buffer_load_dwordx4 a[124:127], v3, s[8:11], s39 offen offset:3072 sc1
    v_mfma_f32_16x16x32_bf16 v[108:111], v[116:119], a[44:47], v[108:111]
    ds_read_b128 v[148:151], v5 offset:31744
    v_mfma_f32_16x16x32_bf16 v[104:107], v[116:119], a[40:43], v[104:107]
    s_waitcnt vmcnt(26)
    s_waitcnt lgkmcnt(6)
    v_mfma_f32_16x16x32_bf16 v[16:19], v[120:123], a[48:51], v[16:19]
    ds_read_b128 v[112:115], v5 offset:32768
    v_mfma_f32_16x16x32_bf16 v[20:23], v[120:123], a[52:55], v[20:23]
    s_add_u32 s38, s34, 16384
    buffer_load_dwordx4 a[128:131], v3, s[8:11], s38 offen offset:0 sc1
    v_mfma_f32_16x16x32_bf16 v[28:31], v[124:127], a[52:55], v[28:31]
    ds_read_b128 v[116:119], v5 offset:33792
    v_mfma_f32_16x16x32_bf16 v[24:27], v[124:127], a[48:51], v[24:27]
    s_waitcnt lgkmcnt(6)
    v_mfma_f32_16x16x32_bf16 v[32:35], v[128:131], a[48:51], v[32:35]
    ds_read_b128 v[120:123], v5 offset:34816
    v_mfma_f32_16x16x32_bf16 v[36:39], v[128:131], a[52:55], v[36:39]
    s_add_u32 s39, s34, 36864
    buffer_load_dwordx4 a[132:135], v3, s[8:11], s39 offen offset:0 sc1
    v_mfma_f32_16x16x32_bf16 v[44:47], v[132:135], a[52:55], v[44:47]
    ds_read_b128 v[124:127], v5 offset:35840
    v_mfma_f32_16x16x32_bf16 v[40:43], v[132:135], a[48:51], v[40:43]
    s_waitcnt vmcnt(14)
    s_waitcnt lgkmcnt(6)
    v_mfma_f32_16x16x32_bf16 v[48:51], v[136:139], a[48:51], v[48:51]
    ds_read_b128 v[128:131], v5 offset:36864
    v_add_f32 v160, v160, v162
    v_mfma_f32_16x16x32_bf16 v[52:55], v[136:139], a[52:55], v[52:55]
    buffer_load_dwordx4 a[136:139], v3, s[8:11], s38 offen offset:1024 sc1
    v_add_f32 v161, v161, v163
    v_add_f32 v164, v164, v166
    v_mfma_f32_16x16x32_bf16 v[60:63], v[140:143], a[52:55], v[60:63]
    ds_read_b128 v[132:135], v5 offset:37888
    v_add_f32 v165, v165, v167
    v_mfma_f32_16x16x32_bf16 v[56:59], v[140:143], a[48:51], v[56:59]
    v_add_f32 v160, v160, v164
    v_add_f32 v161, v161, v165
    s_waitcnt lgkmcnt(6)
    v_mfma_f32_16x16x32_bf16 v[64:67], v[144:147], a[48:51], v[64:67]
    ds_read_b128 v[136:139], v5 offset:38912
    v_add_f32 v168, v168, v170
    v_mfma_f32_16x16x32_bf16 v[68:71], v[144:147], a[52:55], v[68:71]
    buffer_load_dwordx4 a[140:143], v3, s[8:11], s39 offen offset:1024 sc1
    v_add_f32 v169, v169, v171
    v_add_f32 v172, v172, v174
    v_mfma_f32_16x16x32_bf16 v[76:79], v[148:151], a[52:55], v[76:79]
    ds_read_b128 v[140:143], v5 offset:39936
    v_add_f32 v173, v173, v175
    v_mfma_f32_16x16x32_bf16 v[72:75], v[148:151], a[48:51], v[72:75]
    v_add_f32 v168, v168, v172
    v_add_f32 v169, v169, v173
    s_waitcnt lgkmcnt(6)
    v_mfma_f32_16x16x32_bf16 v[80:83], v[112:115], a[48:51], v[80:83]
    ds_read_b128 v[144:147], v5 offset:40960
    v_mov_b32 v176, v160
    v_mfma_f32_16x16x32_bf16 v[84:87], v[112:115], a[52:55], v[84:87]
    buffer_load_dwordx4 a[144:147], v3, s[8:11], s38 offen offset:2048 sc1
    v_mov_b32 v177, v161
    v_mov_b32 v178, v168
    v_mfma_f32_16x16x32_bf16 v[92:95], v[116:119], a[52:55], v[92:95]
    ds_read_b128 v[148:151], v5 offset:41984
    v_mov_b32 v179, v169
    v_mfma_f32_16x16x32_bf16 v[88:91], v[116:119], a[48:51], v[88:91]
    v_permlane16_swap_b32 v160, v176
    v_permlane16_swap_b32 v161, v177
    s_waitcnt lgkmcnt(6)
    v_mfma_f32_16x16x32_bf16 v[96:99], v[120:123], a[48:51], v[96:99]
    ds_read_b128 v[112:115], v5 offset:43008
    v_permlane16_swap_b32 v168, v178
    v_mfma_f32_16x16x32_bf16 v[100:103], v[120:123], a[52:55], v[100:103]
    buffer_load_dwordx4 a[148:151], v3, s[8:11], s39 offen offset:2048 sc1
    v_permlane16_swap_b32 v169, v179
    v_add_f32 v160, v160, v176
    v_mfma_f32_16x16x32_bf16 v[108:111], v[124:127], a[52:55], v[108:111]
    ds_read_b128 v[116:119], v5 offset:44032
    v_add_f32 v161, v161, v177
    v_mfma_f32_16x16x32_bf16 v[104:107], v[124:127], a[48:51], v[104:107]
    v_add_f32 v168, v168, v178
    v_add_f32 v169, v169, v179
    s_waitcnt vmcnt(30)
    s_waitcnt lgkmcnt(6)
    v_mfma_f32_16x16x32_bf16 v[16:19], v[128:131], a[56:59], v[16:19]
    ds_read_b128 v[120:123], v5 offset:45056
    v_mov_b32 v176, v160
    v_mfma_f32_16x16x32_bf16 v[20:23], v[128:131], a[60:63], v[20:23]
    buffer_load_dwordx4 a[152:155], v3, s[8:11], s38 offen offset:3072 sc1
    v_mov_b32 v177, v161
    v_mov_b32 v178, v168
    v_mfma_f32_16x16x32_bf16 v[28:31], v[132:135], a[60:63], v[28:31]
    ds_read_b128 v[124:127], v5 offset:46080
    v_mov_b32 v179, v169
    v_mfma_f32_16x16x32_bf16 v[24:27], v[132:135], a[56:59], v[24:27]
    v_permlane32_swap_b32 v160, v176
    v_permlane32_swap_b32 v161, v177
    s_waitcnt lgkmcnt(6)
    v_mfma_f32_16x16x32_bf16 v[32:35], v[136:139], a[56:59], v[32:35]
    ds_read_b128 v[128:131], v5 offset:47104
    v_permlane32_swap_b32 v168, v178
    v_mfma_f32_16x16x32_bf16 v[36:39], v[136:139], a[60:63], v[36:39]
    buffer_load_dwordx4 a[156:159], v3, s[8:11], s39 offen offset:3072 sc1
    v_permlane32_swap_b32 v169, v179
    v_add_f32 v160, v160, v176
    v_mfma_f32_16x16x32_bf16 v[44:47], v[140:143], a[60:63], v[44:47]
    ds_read_b128 v[132:135], v5 offset:48128
    v_add_f32 v161, v161, v177
    v_mfma_f32_16x16x32_bf16 v[40:43], v[140:143], a[56:59], v[40:43]
    v_add_f32 v168, v168, v178
    v_add_f32 v169, v169, v179
    s_waitcnt vmcnt(60)
    s_barrier
    s_waitcnt lgkmcnt(6)
    v_mfma_f32_16x16x32_bf16 v[48:51], v[144:147], a[56:59], v[48:51]
    ds_read_b128 v[136:139], v6 offset:0
    v_mul_f32 v160, 0x3acccccd, v160
    v_mfma_f32_16x16x32_bf16 v[52:55], v[144:147], a[60:63], v[52:55]
    v_mul_f32 v161, 0x3acccccd, v161
    v_mul_f32 v168, 0x3acccccd, v168
    v_mfma_f32_16x16x32_bf16 v[60:63], v[148:151], a[60:63], v[60:63]
    ds_read_b128 v[140:143], v6 offset:1024
    v_mul_f32 v169, 0x3acccccd, v169
    v_mfma_f32_16x16x32_bf16 v[56:59], v[148:151], a[56:59], v[56:59]
    v_fma_f32 v161, -v160, v160, v161
    v_fma_f32 v169, -v168, v168, v169
    s_waitcnt lgkmcnt(6)
    v_mfma_f32_16x16x32_bf16 v[64:67], v[112:115], a[56:59], v[64:67]
    ds_read_b128 v[144:147], v6 offset:2048
    v_max_f32 v161, 0, v161
    v_mfma_f32_16x16x32_bf16 v[68:71], v[112:115], a[60:63], v[68:71]
    v_max_f32 v169, 0, v169
    v_cvt_pk_bf16_f32 v161, v161, v161
    v_mfma_f32_16x16x32_bf16 v[76:79], v[116:119], a[60:63], v[76:79]
    ds_read_b128 v[148:151], v6 offset:3072
    v_lshlrev_b32 v161, 16, v161
    v_mfma_f32_16x16x32_bf16 v[72:75], v[116:119], a[56:59], v[72:75]
    v_cvt_pk_bf16_f32 v169, v169, v169
    v_lshlrev_b32 v169, 16, v169
    s_waitcnt lgkmcnt(6)
    v_mfma_f32_16x16x32_bf16 v[80:83], v[120:123], a[56:59], v[80:83]
    ds_read_b128 v[112:115], v6 offset:4096
    v_add_f32 v161, 0x3727c5ac, v161
    v_mfma_f32_16x16x32_bf16 v[84:87], v[120:123], a[60:63], v[84:87]
    v_add_f32 v169, 0x3727c5ac, v169
    v_cvt_pk_bf16_f32 v161, v161, v161
    v_mfma_f32_16x16x32_bf16 v[92:95], v[124:127], a[60:63], v[92:95]
    ds_read_b128 v[116:119], v6 offset:5120
    v_lshlrev_b32 v161, 16, v161
    v_mfma_f32_16x16x32_bf16 v[88:91], v[124:127], a[56:59], v[88:91]
    v_cvt_pk_bf16_f32 v169, v169, v169
    v_lshlrev_b32 v169, 16, v169
    s_waitcnt lgkmcnt(6)
    v_mfma_f32_16x16x32_bf16 v[96:99], v[128:131], a[56:59], v[96:99]
    ds_read_b128 v[120:123], v6 offset:6144
    v_sqrt_f32 v161, v161
    v_mfma_f32_16x16x32_bf16 v[100:103], v[128:131], a[60:63], v[100:103]
    v_sqrt_f32 v169, v169
    v_cvt_pk_bf16_f32 v161, v161, v161
    v_mfma_f32_16x16x32_bf16 v[108:111], v[132:135], a[60:63], v[108:111]
    ds_read_b128 v[124:127], v6 offset:7168
    v_lshlrev_b32 v161, 16, v161
    v_mfma_f32_16x16x32_bf16 v[104:107], v[132:135], a[56:59], v[104:107]
    v_cvt_pk_bf16_f32 v169, v169, v169
    v_lshlrev_b32 v169, 16, v169
    s_waitcnt vmcnt(30)
    s_waitcnt lgkmcnt(6)
    v_mfma_f32_16x16x32_bf16 v[16:19], v[136:139], a[64:67], v[16:19]
    ds_read_b128 v[128:131], v6 offset:8192
    v_cvt_pk_bf16_f32 v162, -v160, -v160
    v_mfma_f32_16x16x32_bf16 v[20:23], v[136:139], a[68:71], v[20:23]
    v_rcp_f32 v160, v161
    v_cndmask_b32 v164, 0, v162, s[46:47]
    v_mfma_f32_16x16x32_bf16 v[28:31], v[140:143], a[68:71], v[28:31]
    ds_read_b128 v[132:135], v6 offset:9216
    v_mov_b32 v165, 0
    v_mfma_f32_16x16x32_bf16 v[24:27], v[140:143], a[64:67], v[24:27]
    v_mov_b32 v166, 0
    v_mov_b32 v167, 0
    s_waitcnt vmcnt(28)
    s_waitcnt lgkmcnt(6)
    v_mfma_f32_16x16x32_bf16 v[16:19], v[144:147], a[72:75], v[16:19]
    ds_read_b128 v[136:139], v6 offset:10240
    v_mul_f32 v160, 0xbfb8aa3b, v160
    v_mfma_f32_16x16x32_bf16 v[20:23], v[144:147], a[76:79], v[20:23]
    s_add_u32 s27, s25, 147456
    s_add_u32 m0, s26, 0
    s_nop 0
    buffer_load_dwordx4 v3, s[8:11], s27 offen offset:0  lds
    v_cvt_pk_bf16_f32 v170, -v168, -v168
    v_rcp_f32 v168, v169
    v_mfma_f32_16x16x32_bf16 v[28:31], v[148:151], a[76:79], v[28:31]
    ds_read_b128 v[140:143], v6 offset:11264
    v_cndmask_b32 v172, 0, v170, s[46:47]
    v_mfma_f32_16x16x32_bf16 v[24:27], v[148:151], a[72:75], v[24:27]
    v_mov_b32 v173, 0
    v_mov_b32 v174, 0
    s_waitcnt vmcnt(19)
    s_waitcnt lgkmcnt(6)
    v_mfma_f32_16x16x32_bf16 v[16:19], v[112:115], a[80:83], v[16:19]
    ds_read_b128 v[144:147], v6 offset:12288
    v_mov_b32 v175, 0
    v_mfma_f32_16x16x32_bf16 v[20:23], v[112:115], a[84:87], v[20:23]
    buffer_load_dwordx4 v3, s[8:11], s27 offen offset:1024  lds
    v_mul_f32 v168, 0xbfb8aa3b, v168
    v_mfma_f32_16x16x32_bf16 v[28:31], v[116:119], a[84:87], v[28:31]
    ds_read_b128 v[148:151], v6 offset:13312
    v_mfma_f32_16x16x32_bf16 v[24:27], v[116:119], a[80:83], v[24:27]
    s_waitcnt vmcnt(18)
    s_waitcnt lgkmcnt(6)
    v_mfma_f32_16x16x32_bf16 v[16:19], v[120:123], a[88:91], v[16:19]
    ds_read_b128 v[112:115], v6 offset:14336
    v_mfma_f32_16x16x32_bf16 v[20:23], v[120:123], a[92:95], v[20:23]
    v_mfma_f32_16x16x32_bf16 v[28:31], v[124:127], a[92:95], v[28:31]
    ds_read_b128 v[116:119], v6 offset:15360
    v_mfma_f32_16x16x32_bf16 v[24:27], v[124:127], a[88:91], v[24:27]
    buffer_load_dwordx4 v3, s[8:11], s27 offen offset:2048  lds
    s_waitcnt vmcnt(17)
    s_waitcnt lgkmcnt(6)
    v_mfma_f32_16x16x32_bf16 v[16:19], v[128:131], a[96:99], v[16:19]
    ds_read_b128 v[120:123], v6 offset:16384
    v_mfma_f32_16x16x32_bf16 v[20:23], v[128:131], a[100:103], v[20:23]
    v_mfma_f32_16x16x32_bf16 v[28:31], v[132:135], a[100:103], v[28:31]
    ds_read_b128 v[124:127], v6 offset:17408
    v_mfma_f32_16x16x32_bf16 v[24:27], v[132:135], a[96:99], v[24:27]
    buffer_load_dwordx4 v3, s[8:11], s27 offen offset:3072  lds
    s_waitcnt vmcnt(16)
    s_waitcnt lgkmcnt(6)
    v_mfma_f32_16x16x32_bf16 v[16:19], v[136:139], a[104:107], v[16:19]
    ds_read_b128 v[128:131], v6 offset:18432
    v_mfma_f32_16x16x32_bf16 v[20:23], v[136:139], a[108:111], v[20:23]
    v_mfma_f32_16x16x32_bf16 v[28:31], v[140:143], a[108:111], v[28:31]
    ds_read_b128 v[132:135], v6 offset:19456
    v_mfma_f32_16x16x32_bf16 v[24:27], v[140:143], a[104:107], v[24:27]
    s_waitcnt vmcnt(14)
    s_waitcnt lgkmcnt(6)
    v_mfma_f32_16x16x32_bf16 v[16:19], v[144:147], a[112:115], v[16:19]
    ds_read_b128 v[136:139], v6 offset:20480
    v_mfma_f32_16x16x32_bf16 v[20:23], v[144:147], a[116:119], v[20:23]
    s_add_u32 s27, s27, 4096
    s_add_u32 m0, s26, 4096
    s_nop 0
    buffer_load_dwordx4 v3, s[8:11], s27 offen offset:0  lds
    v_mfma_f32_16x16x32_bf16 v[28:31], v[148:151], a[116:119], v[28:31]
    ds_read_b128 v[140:143], v6 offset:21504
    v_mfma_f32_16x16x32_bf16 v[24:27], v[148:151], a[112:115], v[24:27]
    s_waitcnt vmcnt(13)
    s_waitcnt lgkmcnt(6)
    v_mfma_f32_16x16x32_bf16 v[16:19], v[112:115], a[120:123], v[16:19]
    ds_read_b128 v[144:147], v6 offset:22528
    v_mfma_f32_16x16x32_bf16 v[20:23], v[112:115], a[124:127], v[20:23]
    buffer_load_dwordx4 v3, s[8:11], s27 offen offset:1024  lds
    v_mfma_f32_16x16x32_bf16 v[28:31], v[116:119], a[124:127], v[28:31]
    ds_read_b128 v[148:151], v6 offset:23552
    v_mfma_f32_16x16x32_bf16 v[24:27], v[116:119], a[120:123], v[24:27]
    s_waitcnt vmcnt(12)
    s_waitcnt lgkmcnt(6)
    v_mfma_f32_16x16x32_bf16 v[16:19], v[120:123], a[128:131], v[16:19]
    ds_read_b128 v[112:115], v14 offset:0
    v_mfma_f32_16x16x32_bf16 v[20:23], v[120:123], a[132:135], v[20:23]
    v_mfma_f32_16x16x32_bf16 v[28:31], v[124:127], a[132:135], v[28:31]
    ds_read_b128 v[116:119], v14 offset:256
    v_mfma_f32_16x16x32_bf16 v[24:27], v[124:127], a[128:131], v[24:27]
    s_add_u32 s27, s25, 172032
    s_add_u32 m0, s26, 24576
    s_nop 0
    buffer_load_dwordx4 v3, s[8:11], s27 offen offset:0  lds
    s_waitcnt vmcnt(55)
    s_barrier
    s_waitcnt vmcnt(11)
    s_waitcnt lgkmcnt(6)
    v_mfma_f32_16x16x32_bf16 v[16:19], v[128:131], a[136:139], v[16:19]
    ds_read_b128 v[120:123], v6 offset:24576
    v_mfma_f32_16x16x32_bf16 v[20:23], v[128:131], a[140:143], v[20:23]
    v_mfma_f32_16x16x32_bf16 v[28:31], v[132:135], a[140:143], v[28:31]
    ds_read_b128 v[124:127], v6 offset:25600
    v_mfma_f32_16x16x32_bf16 v[24:27], v[132:135], a[136:139], v[24:27]
    buffer_load_dwordx4 v3, s[8:11], s27 offen offset:1024  lds
    s_waitcnt vmcnt(10)
    s_waitcnt lgkmcnt(6)
    v_mfma_f32_16x16x32_bf16 v[16:19], v[136:139], a[144:147], v[16:19]
    ds_read_b128 v[128:131], v6 offset:26624
    v_mfma_f32_16x16x32_bf16 v[20:23], v[136:139], a[148:151], v[20:23]
    v_mfma_f32_16x16x32_bf16 v[28:31], v[140:143], a[148:151], v[28:31]
    ds_read_b128 v[132:135], v6 offset:27648
    v_mfma_f32_16x16x32_bf16 v[24:27], v[140:143], a[144:147], v[24:27]
    s_waitcnt vmcnt(8)
    s_waitcnt lgkmcnt(6)
    v_mfma_f32_16x16x32_bf16 v[16:19], v[144:147], a[152:155], v[16:19]
    ds_read_b128 v[136:139], v6 offset:28672
    v_mfma_f32_16x16x32_bf16 v[20:23], v[144:147], a[156:159], v[20:23]
    buffer_load_dwordx4 v3, s[8:11], s27 offen offset:2048  lds
    v_mfma_f32_16x16x32_bf16 v[28:31], v[148:151], a[156:159], v[28:31]
    ds_read_b128 v[140:143], v6 offset:29696
    v_mfma_f32_16x16x32_bf16 v[24:27], v[148:151], a[152:155], v[24:27]
    s_waitcnt lgkmcnt(6)
    v_mfma_f32_16x16x32_bf16 v[16:19], v[112:115], v[164:167], v[16:19]
    ds_read_b128 v[144:147], v6 offset:30720
    v_mfma_f32_16x16x32_bf16 v[20:23], v[112:115], v[172:175], v[20:23]
    v_mfma_f32_16x16x32_bf16 v[28:31], v[116:119], v[172:175], v[28:31]
    ds_read_b128 v[148:151], v6 offset:31744
    v_mfma_f32_16x16x32_bf16 v[24:27], v[116:119], v[164:167], v[24:27]
    s_waitcnt lgkmcnt(6)
    v_mfma_f32_16x16x32_bf16 v[32:35], v[120:123], a[64:67], v[32:35]
    ds_read_b128 v[112:115], v6 offset:32768
    v_mfma_f32_16x16x32_bf16 v[36:39], v[120:123], a[68:71], v[36:39]
    buffer_load_dwordx4 v3, s[8:11], s27 offen offset:3072  lds
    v_mfma_f32_16x16x32_bf16 v[44:47], v[124:127], a[68:71], v[44:47]
    ds_read_b128 v[116:119], v6 offset:33792
    v_mfma_f32_16x16x32_bf16 v[40:43], v[124:127], a[64:67], v[40:43]
    s_waitcnt lgkmcnt(6)
    v_mfma_f32_16x16x32_bf16 v[32:35], v[128:131], a[72:75], v[32:35]
    ds_read_b128 v[120:123], v6 offset:34816
    v_mfma_f32_16x16x32_bf16 v[36:39], v[128:131], a[76:79], v[36:39]
    v_mul_f32 v16, v160, v16
    v_mul_f32 v17, v160, v17
    v_mfma_f32_16x16x32_bf16 v[44:47], v[132:135], a[76:79], v[44:47]
    ds_read_b128 v[124:127], v6 offset:35840
    v_mul_f32 v18, v160, v18
    v_mfma_f32_16x16x32_bf16 v[40:43], v[132:135], a[72:75], v[40:43]
    s_add_u32 s27, s27, 4096
    s_add_u32 m0, s26, 28672
    s_nop 0
    buffer_load_dwordx4 v3, s[8:11], s27 offen offset:0  lds
    v_mul_f32 v19, v160, v19
    v_exp_f32 v16, v16
    s_waitcnt lgkmcnt(6)
    v_mfma_f32_16x16x32_bf16 v[32:35], v[136:139], a[80:83], v[32:35]
    ds_read_b128 v[128:131], v6 offset:36864
    v_exp_f32 v17, v17
    v_mfma_f32_16x16x32_bf16 v[36:39], v[136:139], a[84:87], v[36:39]
    v_exp_f32 v18, v18
    v_exp_f32 v19, v19
    v_mfma_f32_16x16x32_bf16 v[44:47], v[140:143], a[84:87], v[44:47]
    ds_read_b128 v[132:135], v6 offset:37888
    v_fma_f32 v16, v16, v161, v161
    v_mfma_f32_16x16x32_bf16 v[40:43], v[140:143], a[80:83], v[40:43]
    buffer_load_dwordx4 v3, s[8:11], s27 offen offset:1024  lds
    v_fma_f32 v17, v17, v161, v161
    v_fma_f32 v18, v18, v161, v161
    s_waitcnt lgkmcnt(6)
    v_mfma_f32_16x16x32_bf16 v[32:35], v[144:147], a[88:91], v[32:35]
    ds_read_b128 v[136:139], v6 offset:38912
    v_fma_f32 v19, v19, v161, v161
    v_mfma_f32_16x16x32_bf16 v[36:39], v[144:147], a[92:95], v[36:39]
    v_rcp_f32 v16, v16
    v_rcp_f32 v17, v17
    v_mfma_f32_16x16x32_bf16 v[44:47], v[148:151], a[92:95], v[44:47]
    ds_read_b128 v[140:143], v6 offset:39936
    v_rcp_f32 v18, v18
    v_mfma_f32_16x16x32_bf16 v[40:43], v[148:151], a[88:91], v[40:43]
    v_rcp_f32 v19, v19
    v_mul_f32 v16, v16, v24
    s_waitcnt lgkmcnt(6)
    v_mfma_f32_16x16x32_bf16 v[32:35], v[112:115], a[96:99], v[32:35]
    ds_read_b128 v[144:147], v6 offset:40960
    v_mul_f32 v17, v17, v25
    v_mfma_f32_16x16x32_bf16 v[36:39], v[112:115], a[100:103], v[36:39]
    s_add_u32 s27, s25, 196608
    s_add_u32 m0, s26, 49152
    s_nop 0
    buffer_load_dwordx4 v3, s[8:11], s27 offen offset:0  lds
    v_mul_f32 v18, v18, v26
    v_mul_f32 v19, v19, v27
    v_mfma_f32_16x16x32_bf16 v[44:47], v[116:119], a[100:103], v[44:47]
    ds_read_b128 v[148:151], v6 offset:41984
    v_cvt_pk_bf16_f32 v152, v16, v17
    v_mfma_f32_16x16x32_bf16 v[40:43], v[116:119], a[96:99], v[40:43]
    v_cvt_pk_bf16_f32 v153, v18, v19
    v_mul_f32 v20, v168, v20
    s_waitcnt lgkmcnt(6)
    v_mfma_f32_16x16x32_bf16 v[32:35], v[120:123], a[104:107], v[32:35]
    ds_read_b128 v[112:115], v6 offset:43008
    v_mul_f32 v21, v168, v21
    v_mfma_f32_16x16x32_bf16 v[36:39], v[120:123], a[108:111], v[36:39]
    buffer_load_dwordx4 v3, s[8:11], s27 offen offset:1024  lds
    v_mul_f32 v22, v168, v22
    v_mul_f32 v23, v168, v23
    v_mfma_f32_16x16x32_bf16 v[44:47], v[124:127], a[108:111], v[44:47]
    ds_read_b128 v[116:119], v6 offset:44032
    v_exp_f32 v20, v20
    v_mfma_f32_16x16x32_bf16 v[40:43], v[124:127], a[104:107], v[40:43]
    v_exp_f32 v21, v21
    v_exp_f32 v22, v22
    s_waitcnt lgkmcnt(6)
    v_mfma_f32_16x16x32_bf16 v[32:35], v[128:131], a[112:115], v[32:35]
    ds_read_b128 v[120:123], v6 offset:45056
    v_exp_f32 v23, v23
    v_mfma_f32_16x16x32_bf16 v[36:39], v[128:131], a[116:119], v[36:39]
    v_fma_f32 v20, v20, v169, v169
    v_fma_f32 v21, v21, v169, v169
    v_mfma_f32_16x16x32_bf16 v[44:47], v[132:135], a[116:119], v[44:47]
    ds_read_b128 v[124:127], v6 offset:46080
    v_fma_f32 v22, v22, v169, v169
    v_mfma_f32_16x16x32_bf16 v[40:43], v[132:135], a[112:115], v[40:43]
    buffer_load_dwordx4 v3, s[8:11], s27 offen offset:2048  lds
    v_fma_f32 v23, v23, v169, v169
    v_rcp_f32 v20, v20
    s_waitcnt lgkmcnt(6)
    v_mfma_f32_16x16x32_bf16 v[32:35], v[136:139], a[120:123], v[32:35]
    ds_read_b128 v[128:131], v6 offset:47104
    v_rcp_f32 v21, v21
    v_mfma_f32_16x16x32_bf16 v[36:39], v[136:139], a[124:127], v[36:39]
    v_rcp_f32 v22, v22
    v_rcp_f32 v23, v23
    v_mfma_f32_16x16x32_bf16 v[44:47], v[140:143], a[124:127], v[44:47]
    ds_read_b128 v[132:135], v6 offset:48128
    v_mul_f32 v20, v20, v28
    v_mfma_f32_16x16x32_bf16 v[40:43], v[140:143], a[120:123], v[40:43]
    buffer_load_dwordx4 v3, s[8:11], s27 offen offset:3072  lds
    v_mul_f32 v21, v21, v29
    v_mul_f32 v22, v22, v30
    s_waitcnt lgkmcnt(6)
    v_mfma_f32_16x16x32_bf16 v[32:35], v[144:147], a[128:131], v[32:35]
    ds_read_b128 v[136:139], v14 offset:512
    v_mul_f32 v23, v23, v31
    v_mfma_f32_16x16x32_bf16 v[36:39], v[144:147], a[132:135], v[36:39]
    v_cvt_pk_bf16_f32 v156, v20, v21
    v_cvt_pk_bf16_f32 v157, v22, v23
    v_mfma_f32_16x16x32_bf16 v[44:47], v[148:151], a[132:135], v[44:47]
    ds_read_b128 v[140:143], v14 offset:768
    v_mfma_f32_16x16x32_bf16 v[40:43], v[148:151], a[128:131], v[40:43]
    s_waitcnt vmcnt(10)
    s_barrier
    s_waitcnt lgkmcnt(6)
    v_mfma_f32_16x16x32_bf16 v[32:35], v[112:115], a[136:139], v[32:35]
    ds_read_b128 v[144:147], v3 offset:0
    v_mfma_f32_16x16x32_bf16 v[36:39], v[112:115], a[140:143], v[36:39]
    s_add_u32 s27, s27, 4096
    s_add_u32 m0, s26, 53248
    s_nop 0
    buffer_load_dwordx4 v3, s[8:11], s27 offen offset:0  lds
    v_mfma_f32_16x16x32_bf16 v[44:47], v[116:119], a[140:143], v[44:47]
    ds_read_b128 v[148:151], v3 offset:1024
    v_mfma_f32_16x16x32_bf16 v[40:43], v[116:119], a[136:139], v[40:43]
    s_waitcnt lgkmcnt(6)
    v_mfma_f32_16x16x32_bf16 v[32:35], v[120:123], a[144:147], v[32:35]
    ds_read_b128 v[112:115], v3 offset:2048
    v_mfma_f32_16x16x32_bf16 v[36:39], v[120:123], a[148:151], v[36:39]
    buffer_load_dwordx4 v3, s[8:11], s27 offen offset:1024  lds
    v_mfma_f32_16x16x32_bf16 v[44:47], v[124:127], a[148:151], v[44:47]
    ds_read_b128 v[116:119], v3 offset:3072
    v_mfma_f32_16x16x32_bf16 v[40:43], v[124:127], a[144:147], v[40:43]
    s_waitcnt lgkmcnt(6)
    v_mfma_f32_16x16x32_bf16 v[32:35], v[128:131], a[152:155], v[32:35]
    ds_read_b128 v[120:123], v3 offset:4096
    v_mfma_f32_16x16x32_bf16 v[36:39], v[128:131], a[156:159], v[36:39]
    v_mfma_f32_16x16x32_bf16 v[44:47], v[132:135], a[156:159], v[44:47]
    ds_read_b128 v[124:127], v3 offset:5120
    v_mfma_f32_16x16x32_bf16 v[40:43], v[132:135], a[152:155], v[40:43]
    s_waitcnt lgkmcnt(6)
    v_mfma_f32_16x16x32_bf16 v[32:35], v[136:139], v[164:167], v[32:35]
    ds_read_b128 v[128:131], v3 offset:6144
    v_mfma_f32_16x16x32_bf16 v[36:39], v[136:139], v[172:175], v[36:39]
    v_mfma_f32_16x16x32_bf16 v[44:47], v[140:143], v[172:175], v[44:47]
    ds_read_b128 v[132:135], v3 offset:7168
    v_mfma_f32_16x16x32_bf16 v[40:43], v[140:143], v[164:167], v[40:43]
    s_waitcnt lgkmcnt(6)
    v_mfma_f32_16x16x32_bf16 v[48:51], v[144:147], a[64:67], v[48:51]
    ds_read_b128 v[136:139], v3 offset:8192
    v_mfma_f32_16x16x32_bf16 v[52:55], v[144:147], a[68:71], v[52:55]
    v_mfma_f32_16x16x32_bf16 v[60:63], v[148:151], a[68:71], v[60:63]
    ds_read_b128 v[140:143], v3 offset:9216
    v_mfma_f32_16x16x32_bf16 v[56:59], v[148:151], a[64:67], v[56:59]
    s_waitcnt lgkmcnt(6)
    v_mfma_f32_16x16x32_bf16 v[48:51], v[112:115], a[72:75], v[48:51]
    ds_read_b128 v[144:147], v3 offset:10240
    v_mfma_f32_16x16x32_bf16 v[52:55], v[112:115], a[76:79], v[52:55]
    s_add_u32 s30, s31, 51200
    buffer_load_dwordx4 a[0:3], v3, s[8:11], s30 offen offset:0
    v_mul_f32 v32, v160, v32
    v_mul_f32 v33, v160, v33
    v_mfma_f32_16x16x32_bf16 v[60:63], v[116:119], a[76:79], v[60:63]
    ds_read_b128 v[148:151], v3 offset:11264
    v_mul_f32 v34, v160, v34
    v_mfma_f32_16x16x32_bf16 v[56:59], v[116:119], a[72:75], v[56:59]
    v_mul_f32 v35, v160, v35
    v_exp_f32 v32, v32
    s_waitcnt lgkmcnt(6)
    v_mfma_f32_16x16x32_bf16 v[48:51], v[120:123], a[80:83], v[48:51]
    ds_read_b128 v[112:115], v3 offset:12288
    v_exp_f32 v33, v33
    v_mfma_f32_16x16x32_bf16 v[52:55], v[120:123], a[84:87], v[52:55]
    buffer_load_dwordx4 a[4:7], v3, s[8:11], s30 offen offset:1024
    v_exp_f32 v34, v34
    v_exp_f32 v35, v35
    v_mfma_f32_16x16x32_bf16 v[60:63], v[124:127], a[84:87], v[60:63]
    ds_read_b128 v[116:119], v3 offset:13312
    v_fma_f32 v32, v32, v161, v161
    v_mfma_f32_16x16x32_bf16 v[56:59], v[124:127], a[80:83], v[56:59]
    v_fma_f32 v33, v33, v161, v161
    v_fma_f32 v34, v34, v161, v161
    s_waitcnt lgkmcnt(6)
    v_mfma_f32_16x16x32_bf16 v[48:51], v[128:131], a[88:91], v[48:51]
    ds_read_b128 v[120:123], v3 offset:14336
    v_fma_f32 v35, v35, v161, v161
    v_mfma_f32_16x16x32_bf16 v[52:55], v[128:131], a[92:95], v[52:55]
    v_rcp_f32 v32, v32
    v_rcp_f32 v33, v33
    v_mfma_f32_16x16x32_bf16 v[60:63], v[132:135], a[92:95], v[60:63]
    ds_read_b128 v[124:127], v3 offset:15360
    v_rcp_f32 v34, v34
    v_mfma_f32_16x16x32_bf16 v[56:59], v[132:135], a[88:91], v[56:59]
    buffer_load_dwordx4 a[8:11], v3, s[8:11], s30 offen offset:2048
    v_rcp_f32 v35, v35
    v_mul_f32 v32, v32, v40
    s_waitcnt lgkmcnt(6)
    v_mfma_f32_16x16x32_bf16 v[48:51], v[136:139], a[96:99], v[48:51]
    ds_read_b128 v[128:131], v3 offset:16384
    v_mul_f32 v33, v33, v41
    v_mfma_f32_16x16x32_bf16 v[52:55], v[136:139], a[100:103], v[52:55]
    v_mul_f32 v34, v34, v42
    v_mul_f32 v35, v35, v43
    v_mfma_f32_16x16x32_bf16 v[60:63], v[140:143], a[100:103], v[60:63]
    ds_read_b128 v[132:135], v3 offset:17408
    v_cvt_pk_bf16_f32 v154, v32, v33
    v_mfma_f32_16x16x32_bf16 v[56:59], v[140:143], a[96:99], v[56:59]
    buffer_load_dwordx4 a[12:15], v3, s[8:11], s30 offen offset:3072
    v_cvt_pk_bf16_f32 v155, v34, v35
    buffer_store_dwordx4 v[152:155], v3, s[8:11], s40 offen offset:0 sc1
    s_waitcnt lgkmcnt(6)
    v_mfma_f32_16x16x32_bf16 v[48:51], v[144:147], a[104:107], v[48:51]
    ds_read_b128 v[136:139], v3 offset:18432
    v_mul_f32 v36, v168, v36
    v_mfma_f32_16x16x32_bf16 v[52:55], v[144:147], a[108:111], v[52:55]
    v_mul_f32 v37, v168, v37
    v_mul_f32 v38, v168, v38
    v_mfma_f32_16x16x32_bf16 v[60:63], v[148:151], a[108:111], v[60:63]
    ds_read_b128 v[140:143], v3 offset:19456
    v_mul_f32 v39, v168, v39
    v_mfma_f32_16x16x32_bf16 v[56:59], v[148:151], a[104:107], v[56:59]
    v_exp_f32 v36, v36
    v_exp_f32 v37, v37
    s_waitcnt lgkmcnt(6)
    v_mfma_f32_16x16x32_bf16 v[48:51], v[112:115], a[112:115], v[48:51]
    ds_read_b128 v[144:147], v3 offset:20480
    v_exp_f32 v38, v38
    v_mfma_f32_16x16x32_bf16 v[52:55], v[112:115], a[116:119], v[52:55]
    s_add_u32 s30, s31, 55296
    buffer_load_dwordx4 a[16:19], v3, s[8:11], s30 offen offset:0
    v_exp_f32 v39, v39
    v_fma_f32 v36, v36, v169, v169
    v_mfma_f32_16x16x32_bf16 v[60:63], v[116:119], a[116:119], v[60:63]
    ds_read_b128 v[148:151], v3 offset:21504
    v_fma_f32 v37, v37, v169, v169
    v_mfma_f32_16x16x32_bf16 v[56:59], v[116:119], a[112:115], v[56:59]
    v_fma_f32 v38, v38, v169, v169
    v_fma_f32 v39, v39, v169, v169
    s_waitcnt lgkmcnt(6)
    v_mfma_f32_16x16x32_bf16 v[48:51], v[120:123], a[120:123], v[48:51]
    ds_read_b128 v[112:115], v3 offset:22528
    v_rcp_f32 v36, v36
    v_mfma_f32_16x16x32_bf16 v[52:55], v[120:123], a[124:127], v[52:55]
    s_add_u32 s27, s25, 221184
    s_add_u32 m0, s26, 73728
    s_nop 0
    buffer_load_dwordx4 v3, s[8:11], s27 offen offset:0  lds
    v_rcp_f32 v37, v37
    v_rcp_f32 v38, v38
    v_mfma_f32_16x16x32_bf16 v[60:63], v[124:127], a[124:127], v[60:63]
    ds_read_b128 v[116:119], v3 offset:23552
    v_rcp_f32 v39, v39
    v_mfma_f32_16x16x32_bf16 v[56:59], v[124:127], a[120:123], v[56:59]
    v_mul_f32 v36, v36, v44
    v_mul_f32 v37, v37, v45
    s_waitcnt lgkmcnt(6)
    v_mfma_f32_16x16x32_bf16 v[48:51], v[128:131], a[128:131], v[48:51]
    ds_read_b128 v[120:123], v14 offset:1024
    v_mul_f32 v38, v38, v46
    v_mfma_f32_16x16x32_bf16 v[52:55], v[128:131], a[132:135], v[52:55]
    v_mul_f32 v39, v39, v47
    v_cvt_pk_bf16_f32 v158, v36, v37
    v_mfma_f32_16x16x32_bf16 v[60:63], v[132:135], a[132:135], v[60:63]
    ds_read_b128 v[124:127], v14 offset:1280
    v_cvt_pk_bf16_f32 v159, v38, v39
    v_mfma_f32_16x16x32_bf16 v[56:59], v[132:135], a[128:131], v[56:59]
    buffer_load_dwordx4 v3, s[8:11], s27 offen offset:1024  lds
    buffer_store_dwordx4 v[156:159], v3, s[8:11], s41 offen offset:0 sc1
    s_waitcnt vmcnt(15)
    s_barrier
    s_waitcnt lgkmcnt(6)
    v_mfma_f32_16x16x32_bf16 v[48:51], v[136:139], a[136:139], v[48:51]
    ds_read_b128 v[128:131], v3 offset:24576
    v_mfma_f32_16x16x32_bf16 v[52:55], v[136:139], a[140:143], v[52:55]
    v_mfma_f32_16x16x32_bf16 v[60:63], v[140:143], a[140:143], v[60:63]
    ds_read_b128 v[132:135], v3 offset:25600
    v_mfma_f32_16x16x32_bf16 v[56:59], v[140:143], a[136:139], v[56:59]
    buffer_load_dwordx4 v3, s[8:11], s27 offen offset:2048  lds
    s_waitcnt lgkmcnt(6)
    v_mfma_f32_16x16x32_bf16 v[48:51], v[144:147], a[144:147], v[48:51]
    ds_read_b128 v[136:139], v3 offset:26624
    v_mfma_f32_16x16x32_bf16 v[52:55], v[144:147], a[148:151], v[52:55]
    v_mfma_f32_16x16x32_bf16 v[60:63], v[148:151], a[148:151], v[60:63]
    ds_read_b128 v[140:143], v3 offset:27648
    v_mfma_f32_16x16x32_bf16 v[56:59], v[148:151], a[144:147], v[56:59]
    s_waitcnt lgkmcnt(6)
    v_mfma_f32_16x16x32_bf16 v[48:51], v[112:115], a[152:155], v[48:51]
    ds_read_b128 v[144:147], v3 offset:28672
    v_mfma_f32_16x16x32_bf16 v[52:55], v[112:115], a[156:159], v[52:55]
    buffer_load_dwordx4 v3, s[8:11], s27 offen offset:3072  lds
    v_mfma_f32_16x16x32_bf16 v[60:63], v[116:119], a[156:159], v[60:63]
    ds_read_b128 v[148:151], v3 offset:29696
    v_mfma_f32_16x16x32_bf16 v[56:59], v[116:119], a[152:155], v[56:59]
    s_waitcnt lgkmcnt(6)
    v_mfma_f32_16x16x32_bf16 v[48:51], v[120:123], v[164:167], v[48:51]
    ds_read_b128 v[112:115], v3 offset:30720
    v_mfma_f32_16x16x32_bf16 v[52:55], v[120:123], v[172:175], v[52:55]
    v_mfma_f32_16x16x32_bf16 v[60:63], v[124:127], v[172:175], v[60:63]
    ds_read_b128 v[116:119], v3 offset:31744
    v_mfma_f32_16x16x32_bf16 v[56:59], v[124:127], v[164:167], v[56:59]
    s_waitcnt lgkmcnt(6)
    v_mfma_f32_16x16x32_bf16 v[64:67], v[128:131], a[64:67], v[64:67]
    ds_read_b128 v[120:123], v3 offset:32768
    v_mfma_f32_16x16x32_bf16 v[68:71], v[128:131], a[68:71], v[68:71]
    s_add_u32 s27, s27, 4096
    s_add_u32 m0, s26, 77824
    s_nop 0
    buffer_load_dwordx4 v3, s[8:11], s27 offen offset:0  lds
    v_mfma_f32_16x16x32_bf16 v[76:79], v[132:135], a[68:71], v[76:79]
    ds_read_b128 v[124:127], v3 offset:33792
    v_mfma_f32_16x16x32_bf16 v[72:75], v[132:135], a[64:67], v[72:75]
    s_waitcnt lgkmcnt(6)
    v_mfma_f32_16x16x32_bf16 v[64:67], v[136:139], a[72:75], v[64:67]
    ds_read_b128 v[128:131], v3 offset:34816
    v_mfma_f32_16x16x32_bf16 v[68:71], v[136:139], a[76:79], v[68:71]
    v_mul_f32 v48, v160, v48
    v_mul_f32 v49, v160, v49
    v_mfma_f32_16x16x32_bf16 v[76:79], v[140:143], a[76:79], v[76:79]
    ds_read_b128 v[132:135], v3 offset:35840
    v_mul_f32 v50, v160, v50
    v_mfma_f32_16x16x32_bf16 v[72:75], v[140:143], a[72:75], v[72:75]
    buffer_load_dwordx4 v3, s[8:11], s27 offen offset:1024  lds
    v_mul_f32 v51, v160, v51
    v_exp_f32 v48, v48
    s_waitcnt lgkmcnt(6)
    v_mfma_f32_16x16x32_bf16 v[64:67], v[144:147], a[80:83], v[64:67]
    ds_read_b128 v[136:139], v3 offset:36864
    v_exp_f32 v49, v49
    v_mfma_f32_16x16x32_bf16 v[68:71], v[144:147], a[84:87], v[68:71]
    v_exp_f32 v50, v50
    v_exp_f32 v51, v51
    v_mfma_f32_16x16x32_bf16 v[76:79], v[148:151], a[84:87], v[76:79]
    ds_read_b128 v[140:143], v3 offset:37888
    v_fma_f32 v48, v48, v161, v161
    v_mfma_f32_16x16x32_bf16 v[72:75], v[148:151], a[80:83], v[72:75]
    s_add_u32 s30, s31, 10240
    s_add_u32 m0, s53, 98304
    s_nop 0
    buffer_load_dwordx4 v3, s[8:11], s30 offen  lds
    v_fma_f32 v49, v49, v161, v161
    v_fma_f32 v50, v50, v161, v161
    s_waitcnt lgkmcnt(6)
    v_mfma_f32_16x16x32_bf16 v[64:67], v[112:115], a[88:91], v[64:67]
    ds_read_b128 v[144:147], v3 offset:38912
    v_fma_f32 v51, v51, v161, v161
    v_mfma_f32_16x16x32_bf16 v[68:71], v[112:115], a[92:95], v[68:71]
    v_rcp_f32 v48, v48
    v_rcp_f32 v49, v49
    v_mfma_f32_16x16x32_bf16 v[76:79], v[116:119], a[92:95], v[76:79]
    ds_read_b128 v[148:151], v3 offset:39936
    v_rcp_f32 v50, v50
    v_mfma_f32_16x16x32_bf16 v[72:75], v[116:119], a[88:91], v[72:75]
    v_rcp_f32 v51, v51
    v_mul_f32 v48, v48, v56
    s_waitcnt lgkmcnt(6)
    v_mfma_f32_16x16x32_bf16 v[64:67], v[120:123], a[96:99], v[64:67]
    ds_read_b128 v[112:115], v3 offset:40960
    v_mul_f32 v49, v49, v57
    v_mfma_f32_16x16x32_bf16 v[68:71], v[120:123], a[100:103], v[68:71]
    s_add_u32 s30, s31, 11264
    s_add_u32 m0, s53, 99328
    s_nop 0
    buffer_load_dwordx4 v3, s[8:11], s30 offen  lds
    v_mul_f32 v50, v50, v58
    v_mul_f32 v51, v51, v59
    v_mfma_f32_16x16x32_bf16 v[76:79], v[124:127], a[100:103], v[76:79]
    ds_read_b128 v[116:119], v3 offset:41984
    v_cvt_pk_bf16_f32 v152, v48, v49
    v_mfma_f32_16x16x32_bf16 v[72:75], v[124:127], a[96:99], v[72:75]
    v_cvt_pk_bf16_f32 v153, v50, v51
    v_mul_f32 v52, v168, v52
    s_waitcnt lgkmcnt(6)
    v_mfma_f32_16x16x32_bf16 v[64:67], v[128:131], a[104:107], v[64:67]
    ds_read_b128 v[120:123], v3 offset:43008
    v_mul_f32 v53, v168, v53
    v_mfma_f32_16x16x32_bf16 v[68:71], v[128:131], a[108:111], v[68:71]
    s_add_u32 s30, s31, 12288
    s_add_u32 m0, s53, 100352
    s_nop 0
    buffer_load_dwordx4 v3, s[8:11], s30 offen  lds
    v_mul_f32 v54, v168, v54
    v_mul_f32 v55, v168, v55
    s_waitcnt vmcnt(7)
    s_lshl_b32 s56, s20, 1
    s_lshr_b32 s57, s32, 1
    s_add_u32 s56, s56, s57
    s_and_b32 s57, s32, 1
    s_lshl_b32 s58, s21, 1
    s_add_u32 s57, s57, s58
    s_lshl_b32 s56, s56, 10
    s_lshl_b32 s57, s57, 5
    s_add_u32 s56, s56, s57
    s_add_u32 s56, s56, 37752832
    v_mov_b32 v250, s100
    v_mov_b32 v251, s101
    s_mov_b64 exec, 1
    buffer_store_dwordx2 v[250:251], v3, s[8:11], s56 offen sc1
    s_mov_b64 exec, -1
    v_mfma_f32_16x16x32_bf16 v[76:79], v[132:135], a[108:111], v[76:79]
    ds_read_b128 v[124:127], v3 offset:44032
    v_exp_f32 v52, v52
    v_mfma_f32_16x16x32_bf16 v[72:75], v[132:135], a[104:107], v[72:75]
    v_exp_f32 v53, v53
    v_exp_f32 v54, v54
    s_waitcnt lgkmcnt(6)
    v_mfma_f32_16x16x32_bf16 v[64:67], v[136:139], a[112:115], v[64:67]
    ds_read_b128 v[128:131], v3 offset:45056
    v_exp_f32 v55, v55
    v_mfma_f32_16x16x32_bf16 v[68:71], v[136:139], a[116:119], v[68:71]
    v_fma_f32 v52, v52, v169, v169
    v_fma_f32 v53, v53, v169, v169
    v_mfma_f32_16x16x32_bf16 v[76:79], v[140:143], a[116:119], v[76:79]
    ds_read_b128 v[132:135], v3 offset:46080
    v_fma_f32 v54, v54, v169, v169
    v_mfma_f32_16x16x32_bf16 v[72:75], v[140:143], a[112:115], v[72:75]
    s_add_u32 s30, s31, 13312
    s_add_u32 m0, s53, 101376
    s_nop 0
    buffer_load_dwordx4 v3, s[8:11], s30 offen  lds
    v_fma_f32 v55, v55, v169, v169
    v_rcp_f32 v52, v52
    s_waitcnt lgkmcnt(6)
    v_mfma_f32_16x16x32_bf16 v[64:67], v[144:147], a[120:123], v[64:67]
    ds_read_b128 v[136:139], v3 offset:47104
    v_rcp_f32 v53, v53
    v_mfma_f32_16x16x32_bf16 v[68:71], v[144:147], a[124:127], v[68:71]
    v_rcp_f32 v54, v54
    v_rcp_f32 v55, v55
    v_mfma_f32_16x16x32_bf16 v[76:79], v[148:151], a[124:127], v[76:79]
    ds_read_b128 v[140:143], v3 offset:48128
    v_mul_f32 v52, v52, v60
    v_mfma_f32_16x16x32_bf16 v[72:75], v[148:151], a[120:123], v[72:75]
    s_add_u32 s30, s31, 14336
    s_add_u32 m0, s53, 102400
    s_nop 0
    buffer_load_dwordx4 v3, s[8:11], s30 offen  lds
    v_mul_f32 v53, v53, v61
    v_mul_f32 v54, v54, v62
    s_waitcnt lgkmcnt(6)
    v_mfma_f32_16x16x32_bf16 v[64:67], v[112:115], a[128:131], v[64:67]
    ds_read_b128 v[144:147], v14 offset:1536
    v_mul_f32 v55, v55, v63
    v_mfma_f32_16x16x32_bf16 v[68:71], v[112:115], a[132:135], v[68:71]
    v_cvt_pk_bf16_f32 v156, v52, v53
    v_cvt_pk_bf16_f32 v157, v54, v55
    v_mfma_f32_16x16x32_bf16 v[76:79], v[116:119], a[132:135], v[76:79]
    ds_read_b128 v[148:151], v14 offset:1792
    v_mfma_f32_16x16x32_bf16 v[72:75], v[116:119], a[128:131], v[72:75]
    s_waitcnt vmcnt(19)
    s_barrier
    s_waitcnt lgkmcnt(6)
    v_mfma_f32_16x16x32_bf16 v[64:67], v[120:123], a[136:139], v[64:67]
    ds_read_b128 v[112:115], v5 offset:0
    v_mfma_f32_16x16x32_bf16 v[68:71], v[120:123], a[140:143], v[68:71]
    s_add_u32 s30, s31, 25600
    s_add_u32 m0, s53, 103424
    s_nop 0
    buffer_load_dwordx4 v3, s[8:11], s30 offen  lds
    v_mfma_f32_16x16x32_bf16 v[76:79], v[124:127], a[140:143], v[76:79]
    ds_read_b128 v[116:119], v5 offset:1024
    v_mfma_f32_16x16x32_bf16 v[72:75], v[124:127], a[136:139], v[72:75]
    s_waitcnt lgkmcnt(6)
    v_mfma_f32_16x16x32_bf16 v[64:67], v[128:131], a[144:147], v[64:67]
    ds_read_b128 v[120:123], v5 offset:2048
    v_mfma_f32_16x16x32_bf16 v[68:71], v[128:131], a[148:151], v[68:71]
    s_add_u32 s30, s31, 26624
    s_add_u32 m0, s53, 104448
    s_nop 0
    buffer_load_dwordx4 v3, s[8:11], s30 offen  lds
    v_mfma_f32_16x16x32_bf16 v[76:79], v[132:135], a[148:151], v[76:79]
    ds_read_b128 v[124:127], v5 offset:3072
    v_mfma_f32_16x16x32_bf16 v[72:75], v[132:135], a[144:147], v[72:75]
    s_waitcnt lgkmcnt(6)
    v_mfma_f32_16x16x32_bf16 v[64:67], v[136:139], a[152:155], v[64:67]
    ds_read_b128 v[128:131], v5 offset:4096
    v_mfma_f32_16x16x32_bf16 v[68:71], v[136:139], a[156:159], v[68:71]
    v_mfma_f32_16x16x32_bf16 v[76:79], v[140:143], a[156:159], v[76:79]
    ds_read_b128 v[132:135], v5 offset:5120
    v_mfma_f32_16x16x32_bf16 v[72:75], v[140:143], a[152:155], v[72:75]
    s_add_u32 s30, s31, 27648
    s_add_u32 m0, s53, 105472
    s_nop 0
    buffer_load_dwordx4 v3, s[8:11], s30 offen  lds
    s_waitcnt lgkmcnt(6)
    v_mfma_f32_16x16x32_bf16 v[64:67], v[144:147], v[164:167], v[64:67]
    ds_read_b128 v[136:139], v5 offset:6144
    v_mfma_f32_16x16x32_bf16 v[68:71], v[144:147], v[172:175], v[68:71]
    v_mfma_f32_16x16x32_bf16 v[76:79], v[148:151], v[172:175], v[76:79]
    ds_read_b128 v[140:143], v5 offset:7168
    v_mfma_f32_16x16x32_bf16 v[72:75], v[148:151], v[164:167], v[72:75]
    s_waitcnt lgkmcnt(6)
    v_mfma_f32_16x16x32_bf16 v[80:83], v[112:115], a[64:67], v[80:83]
    ds_read_b128 v[144:147], v5 offset:8192
    v_mfma_f32_16x16x32_bf16 v[84:87], v[112:115], a[68:71], v[84:87]
    v_mfma_f32_16x16x32_bf16 v[92:95], v[116:119], a[68:71], v[92:95]
    ds_read_b128 v[148:151], v5 offset:9216
    v_mfma_f32_16x16x32_bf16 v[88:91], v[116:119], a[64:67], v[88:91]
    s_add_u32 s30, s31, 28672
    s_add_u32 m0, s53, 106496
    s_nop 0
    buffer_load_dwordx4 v3, s[8:11], s30 offen  lds
    s_waitcnt lgkmcnt(6)
    v_mfma_f32_16x16x32_bf16 v[80:83], v[120:123], a[72:75], v[80:83]
    ds_read_b128 v[112:115], v5 offset:10240
    v_mfma_f32_16x16x32_bf16 v[84:87], v[120:123], a[76:79], v[84:87]
    v_mul_f32 v64, v160, v64
    v_mul_f32 v65, v160, v65
    v_mfma_f32_16x16x32_bf16 v[92:95], v[124:127], a[76:79], v[92:95]
    ds_read_b128 v[116:119], v5 offset:11264
    v_mul_f32 v66, v160, v66
    v_mfma_f32_16x16x32_bf16 v[88:91], v[124:127], a[72:75], v[88:91]
    v_mul_f32 v67, v160, v67
    v_exp_f32 v64, v64
    s_waitcnt lgkmcnt(6)
    v_mfma_f32_16x16x32_bf16 v[80:83], v[128:131], a[80:83], v[80:83]
    ds_read_b128 v[120:123], v5 offset:12288
    v_exp_f32 v65, v65
    v_mfma_f32_16x16x32_bf16 v[84:87], v[128:131], a[84:87], v[84:87]
    s_add_u32 s30, s31, 29696
    s_add_u32 m0, s53, 107520
    s_nop 0
    buffer_load_dwordx4 v3, s[8:11], s30 offen  lds
    v_exp_f32 v66, v66
    v_exp_f32 v67, v67
    v_mfma_f32_16x16x32_bf16 v[92:95], v[132:135], a[84:87], v[92:95]
    ds_read_b128 v[124:127], v5 offset:13312
    v_fma_f32 v64, v64, v161, v161
    v_mfma_f32_16x16x32_bf16 v[88:91], v[132:135], a[80:83], v[88:91]
    v_fma_f32 v65, v65, v161, v161
    v_fma_f32 v66, v66, v161, v161
    s_waitcnt lgkmcnt(6)
    v_mfma_f32_16x16x32_bf16 v[80:83], v[136:139], a[88:91], v[80:83]
    ds_read_b128 v[128:131], v5 offset:14336
    v_fma_f32 v67, v67, v161, v161
    v_mfma_f32_16x16x32_bf16 v[84:87], v[136:139], a[92:95], v[84:87]
    s_add_u32 s30, s31, 40960
    s_add_u32 m0, s53, 108544
    s_nop 0
    buffer_load_dwordx4 v3, s[8:11], s30 offen  lds
    v_rcp_f32 v64, v64
    v_rcp_f32 v65, v65
    v_mfma_f32_16x16x32_bf16 v[92:95], v[140:143], a[92:95], v[92:95]
    ds_read_b128 v[132:135], v5 offset:15360
    v_rcp_f32 v66, v66
    v_mfma_f32_16x16x32_bf16 v[88:91], v[140:143], a[88:91], v[88:91]
    v_rcp_f32 v67, v67
    v_mul_f32 v64, v64, v72
    s_waitcnt lgkmcnt(6)
    v_mfma_f32_16x16x32_bf16 v[80:83], v[144:147], a[96:99], v[80:83]
    ds_read_b128 v[136:139], v5 offset:16384
    v_mul_f32 v65, v65, v73
    v_mfma_f32_16x16x32_bf16 v[84:87], v[144:147], a[100:103], v[84:87]
    v_mul_f32 v66, v66, v74
    v_mul_f32 v67, v67, v75
    v_mfma_f32_16x16x32_bf16 v[92:95], v[148:151], a[100:103], v[92:95]
    ds_read_b128 v[140:143], v5 offset:17408
    v_cvt_pk_bf16_f32 v154, v64, v65
    v_mfma_f32_16x16x32_bf16 v[88:91], v[148:151], a[96:99], v[88:91]
    s_add_u32 s30, s31, 41984
    s_add_u32 m0, s53, 109568
    s_nop 0
    buffer_load_dwordx4 v3, s[8:11], s30 offen  lds
    v_cvt_pk_bf16_f32 v155, v66, v67
    buffer_store_dwordx4 v[152:155], v3, s[8:11], s40 offen offset:1024 sc1
    s_waitcnt lgkmcnt(6)
    v_mfma_f32_16x16x32_bf16 v[80:83], v[112:115], a[104:107], v[80:83]
    ds_read_b128 v[144:147], v5 offset:18432
    v_mul_f32 v68, v168, v68
    v_mfma_f32_16x16x32_bf16 v[84:87], v[112:115], a[108:111], v[84:87]
    v_mul_f32 v69, v168, v69
    v_mul_f32 v70, v168, v70
    v_mfma_f32_16x16x32_bf16 v[92:95], v[116:119], a[108:111], v[92:95]
    ds_read_b128 v[148:151], v5 offset:19456
    v_mul_f32 v71, v168, v71
    v_mfma_f32_16x16x32_bf16 v[88:91], v[116:119], a[104:107], v[88:91]
    v_exp_f32 v68, v68
    v_exp_f32 v69, v69
    s_waitcnt lgkmcnt(6)
    v_mfma_f32_16x16x32_bf16 v[80:83], v[120:123], a[112:115], v[80:83]
    ds_read_b128 v[112:115], v5 offset:20480
    v_exp_f32 v70, v70
    v_mfma_f32_16x16x32_bf16 v[84:87], v[120:123], a[116:119], v[84:87]
    v_exp_f32 v71, v71
    v_fma_f32 v68, v68, v169, v169
    v_mfma_f32_16x16x32_bf16 v[92:95], v[124:127], a[116:119], v[92:95]
    ds_read_b128 v[116:119], v5 offset:21504
    v_fma_f32 v69, v69, v169, v169
    v_mfma_f32_16x16x32_bf16 v[88:91], v[124:127], a[112:115], v[88:91]
    v_fma_f32 v70, v70, v169, v169
    v_fma_f32 v71, v71, v169, v169
    s_waitcnt lgkmcnt(6)
    v_mfma_f32_16x16x32_bf16 v[80:83], v[128:131], a[120:123], v[80:83]
    ds_read_b128 v[120:123], v5 offset:22528
    v_rcp_f32 v68, v68
    v_mfma_f32_16x16x32_bf16 v[84:87], v[128:131], a[124:127], v[84:87]
    v_rcp_f32 v69, v69
    v_rcp_f32 v70, v70
    s_add_u32 s57, s60, 0
    s_lshl_b32 s58, s32, 3
    s_lshl_b32 s57, s57, 10
    s_lshl_b32 s58, s58, 5
    s_add_u32 s57, s57, s58
    s_add_u32 s59, s57, 37752832
    v_lshlrev_b32 v254, 5, v2
    s_mov_b64 exec, 0xff
    buffer_load_dwordx2 v[252:253], v254, s[8:11], s59 offen sc1
    s_mov_b64 exec, -1
    v_mfma_f32_16x16x32_bf16 v[92:95], v[132:135], a[124:127], v[92:95]
    ds_read_b128 v[124:127], v5 offset:23552
    v_rcp_f32 v71, v71
    v_mfma_f32_16x16x32_bf16 v[88:91], v[132:135], a[120:123], v[88:91]
    v_mul_f32 v68, v68, v76
    v_mul_f32 v69, v69, v77
    s_waitcnt lgkmcnt(6)
    v_mfma_f32_16x16x32_bf16 v[80:83], v[136:139], a[128:131], v[80:83]
    ds_read_b128 v[128:131], v14 offset:2048
    v_mul_f32 v70, v70, v78
    v_mfma_f32_16x16x32_bf16 v[84:87], v[136:139], a[132:135], v[84:87]
    v_mul_f32 v71, v71, v79
    v_cvt_pk_bf16_f32 v158, v68, v69
    v_mfma_f32_16x16x32_bf16 v[92:95], v[140:143], a[132:135], v[92:95]
    ds_read_b128 v[132:135], v14 offset:2304
    v_cvt_pk_bf16_f32 v159, v70, v71
    v_mfma_f32_16x16x32_bf16 v[88:91], v[140:143], a[128:131], v[88:91]
    buffer_store_dwordx4 v[156:159], v3, s[8:11], s41 offen offset:1024 sc1
    s_waitcnt vmcnt(16)
    s_barrier
    s_waitcnt lgkmcnt(6)
    v_mfma_f32_16x16x32_bf16 v[80:83], v[144:147], a[136:139], v[80:83]
    ds_read_b128 v[136:139], v5 offset:24576
    v_mfma_f32_16x16x32_bf16 v[84:87], v[144:147], a[140:143], v[84:87]
    v_mfma_f32_16x16x32_bf16 v[92:95], v[148:151], a[140:143], v[92:95]
    ds_read_b128 v[140:143], v5 offset:25600
    v_mfma_f32_16x16x32_bf16 v[88:91], v[148:151], a[136:139], v[88:91]
    s_waitcnt lgkmcnt(6)
    v_mfma_f32_16x16x32_bf16 v[80:83], v[112:115], a[144:147], v[80:83]
    ds_read_b128 v[144:147], v5 offset:26624
    v_mfma_f32_16x16x32_bf16 v[84:87], v[112:115], a[148:151], v[84:87]
    v_mfma_f32_16x16x32_bf16 v[92:95], v[116:119], a[148:151], v[92:95]
    ds_read_b128 v[148:151], v5 offset:27648
    v_mfma_f32_16x16x32_bf16 v[88:91], v[116:119], a[144:147], v[88:91]
    s_waitcnt lgkmcnt(6)
    v_mfma_f32_16x16x32_bf16 v[80:83], v[120:123], a[152:155], v[80:83]
    ds_read_b128 v[112:115], v5 offset:28672
    v_mfma_f32_16x16x32_bf16 v[84:87], v[120:123], a[156:159], v[84:87]
    v_mfma_f32_16x16x32_bf16 v[92:95], v[124:127], a[156:159], v[92:95]
    ds_read_b128 v[116:119], v5 offset:29696
    v_mfma_f32_16x16x32_bf16 v[88:91], v[124:127], a[152:155], v[88:91]
    s_waitcnt lgkmcnt(6)
    v_mfma_f32_16x16x32_bf16 v[80:83], v[128:131], v[164:167], v[80:83]
    ds_read_b128 v[120:123], v5 offset:30720
    v_mfma_f32_16x16x32_bf16 v[84:87], v[128:131], v[172:175], v[84:87]
    v_mfma_f32_16x16x32_bf16 v[92:95], v[132:135], v[172:175], v[92:95]
    ds_read_b128 v[124:127], v5 offset:31744
    v_mfma_f32_16x16x32_bf16 v[88:91], v[132:135], v[164:167], v[88:91]
    s_waitcnt lgkmcnt(6)
    v_mfma_f32_16x16x32_bf16 v[96:99], v[136:139], a[64:67], v[96:99]
    ds_read_b128 v[128:131], v5 offset:32768
    v_mfma_f32_16x16x32_bf16 v[100:103], v[136:139], a[68:71], v[100:103]
    v_mfma_f32_16x16x32_bf16 v[108:111], v[140:143], a[68:71], v[108:111]
    ds_read_b128 v[132:135], v5 offset:33792
    v_mfma_f32_16x16x32_bf16 v[104:107], v[140:143], a[64:67], v[104:107]
    s_waitcnt lgkmcnt(6)
    v_mfma_f32_16x16x32_bf16 v[96:99], v[144:147], a[72:75], v[96:99]
    ds_read_b128 v[136:139], v5 offset:34816
    v_mfma_f32_16x16x32_bf16 v[100:103], v[144:147], a[76:79], v[100:103]
    v_mul_f32 v80, v160, v80
    v_mul_f32 v81, v160, v81
    v_mfma_f32_16x16x32_bf16 v[108:111], v[148:151], a[76:79], v[108:111]
    ds_read_b128 v[140:143], v5 offset:35840
    v_mul_f32 v82, v160, v82
    v_mfma_f32_16x16x32_bf16 v[104:107], v[148:151], a[72:75], v[104:107]
    v_mul_f32 v83, v160, v83
    v_exp_f32 v80, v80
    s_waitcnt lgkmcnt(6)
    v_mfma_f32_16x16x32_bf16 v[96:99], v[112:115], a[80:83], v[96:99]
    ds_read_b128 v[144:147], v5 offset:36864
    v_exp_f32 v81, v81
    v_mfma_f32_16x16x32_bf16 v[100:103], v[112:115], a[84:87], v[100:103]
    v_exp_f32 v82, v82
    v_exp_f32 v83, v83
    s_waitcnt vmcnt(1)
    s_mov_b64 exec, 0xff
    v_cmp_ne_u64 vcc, s[100:101], v[252:253]
    s_mov_b64 exec, -1
    s_cbranch_vccz chk_17
    s_mov_b64 exec, 0xff
    s_mov_b32 s58, 0x40000
sync_18_p:
    buffer_load_dwordx2 v[252:253], v254, s[8:11], s59 offen sc1
    s_sub_u32 s58, s58, 1
    s_waitcnt vmcnt(0)
    v_cmp_ne_u64 vcc, s[100:101], v[252:253]
    s_cbranch_scc1 sync_18_x
    s_cbranch_vccnz sync_18_p
sync_18_x:
    s_mov_b64 exec, -1
chk_17:
    v_mfma_f32_16x16x32_bf16 v[108:111], v[116:119], a[84:87], v[108:111]
    ds_read_b128 v[148:151], v5 offset:37888
    v_fma_f32 v80, v80, v161, v161
    v_mfma_f32_16x16x32_bf16 v[104:107], v[116:119], a[80:83], v[104:107]
    s_add_u32 s17, s48, 0
    buffer_load_dwordx4 v[16:19], v3, s[8:11], s17 offen sc1
    v_fma_f32 v81, v81, v161, v161
    v_fma_f32 v82, v82, v161, v161
    s_waitcnt lgkmcnt(6)
    v_mfma_f32_16x16x32_bf16 v[96:99], v[120:123], a[88:91], v[96:99]
    ds_read_b128 v[112:115], v5 offset:38912
    v_fma_f32 v83, v83, v161, v161
    v_mfma_f32_16x16x32_bf16 v[100:103], v[120:123], a[92:95], v[100:103]
    s_add_u32 s17, s49, 0
    buffer_load_dwordx4 v[20:23], v3, s[8:11], s17 offen sc1
    v_rcp_f32 v80, v80
    v_rcp_f32 v81, v81
    v_mfma_f32_16x16x32_bf16 v[108:111], v[124:127], a[92:95], v[108:111]
    ds_read_b128 v[116:119], v5 offset:39936
    v_rcp_f32 v82, v82
    v_mfma_f32_16x16x32_bf16 v[104:107], v[124:127], a[88:91], v[104:107]
    s_add_u32 s17, s50, 0
    buffer_load_dwordx4 v[24:27], v3, s[8:11], s17 offen sc1
    v_rcp_f32 v83, v83
    v_mul_f32 v80, v80, v88
    s_waitcnt lgkmcnt(6)
    v_mfma_f32_16x16x32_bf16 v[96:99], v[128:131], a[96:99], v[96:99]
    ds_read_b128 v[120:123], v5 offset:40960
    v_mul_f32 v81, v81, v89
    v_mfma_f32_16x16x32_bf16 v[100:103], v[128:131], a[100:103], v[100:103]
    s_add_u32 s17, s51, 0
    buffer_load_dwordx4 v[28:31], v3, s[8:11], s17 offen sc1
    v_mul_f32 v82, v82, v90
    v_mul_f32 v83, v83, v91
    v_mfma_f32_16x16x32_bf16 v[108:111], v[132:135], a[100:103], v[108:111]
    ds_read_b128 v[124:127], v5 offset:41984
    v_cvt_pk_bf16_f32 v152, v80, v81
    v_mfma_f32_16x16x32_bf16 v[104:107], v[132:135], a[96:99], v[104:107]
    s_add_u32 s17, s48, 3072
    buffer_load_dwordx4 v[32:35], v3, s[8:11], s17 offen sc1
    v_cvt_pk_bf16_f32 v153, v82, v83
    v_mul_f32 v84, v168, v84
    s_waitcnt lgkmcnt(6)
    v_mfma_f32_16x16x32_bf16 v[96:99], v[136:139], a[104:107], v[96:99]
    ds_read_b128 v[128:131], v5 offset:43008
    v_mul_f32 v85, v168, v85
    v_mfma_f32_16x16x32_bf16 v[100:103], v[136:139], a[108:111], v[100:103]
    s_add_u32 s17, s49, 3072
    buffer_load_dwordx4 v[36:39], v3, s[8:11], s17 offen sc1
    v_mul_f32 v86, v168, v86
    v_mul_f32 v87, v168, v87
    s_waitcnt vmcnt(6)
    s_lshl_b32 s56, s20, 1
    s_lshr_b32 s57, s32, 1
    s_add_u32 s56, s56, s57
    s_and_b32 s57, s32, 1
    s_lshl_b32 s58, s21, 1
    s_add_u32 s57, s57, s58
    s_add_u32 s56, s56, 32
    s_lshl_b32 s56, s56, 10
    s_lshl_b32 s57, s57, 5
    s_add_u32 s56, s56, s57
    s_add_u32 s56, s56, 37752832
    v_mov_b32 v250, s100
    v_mov_b32 v251, s101
    s_mov_b64 exec, 1
    buffer_store_dwordx2 v[250:251], v3, s[8:11], s56 offen sc1
    s_mov_b64 exec, -1
    v_mfma_f32_16x16x32_bf16 v[108:111], v[140:143], a[108:111], v[108:111]
    ds_read_b128 v[132:135], v5 offset:44032
    v_exp_f32 v84, v84
    v_mfma_f32_16x16x32_bf16 v[104:107], v[140:143], a[104:107], v[104:107]
    s_add_u32 s17, s50, 3072
    buffer_load_dwordx4 v[40:43], v3, s[8:11], s17 offen sc1
    v_exp_f32 v85, v85
    v_exp_f32 v86, v86
    s_waitcnt lgkmcnt(6)
    v_mfma_f32_16x16x32_bf16 v[96:99], v[144:147], a[112:115], v[96:99]
    ds_read_b128 v[136:139], v5 offset:45056
    v_exp_f32 v87, v87
    v_mfma_f32_16x16x32_bf16 v[100:103], v[144:147], a[116:119], v[100:103]
    s_add_u32 s17, s51, 3072
    buffer_load_dwordx4 v[44:47], v3, s[8:11], s17 offen sc1
    v_fma_f32 v84, v84, v169, v169
    v_fma_f32 v85, v85, v169, v169
    v_mfma_f32_16x16x32_bf16 v[108:111], v[148:151], a[116:119], v[108:111]
    ds_read_b128 v[140:143], v5 offset:46080
    v_fma_f32 v86, v86, v169, v169
    v_mfma_f32_16x16x32_bf16 v[104:107], v[148:151], a[112:115], v[104:107]
    s_add_u32 s17, s48, 6144
    buffer_load_dwordx4 v[48:51], v3, s[8:11], s17 offen sc1
    v_fma_f32 v87, v87, v169, v169
    v_rcp_f32 v84, v84
    s_waitcnt lgkmcnt(6)
    v_mfma_f32_16x16x32_bf16 v[96:99], v[112:115], a[120:123], v[96:99]
    ds_read_b128 v[144:147], v5 offset:47104
    v_rcp_f32 v85, v85
    v_mfma_f32_16x16x32_bf16 v[100:103], v[112:115], a[124:127], v[100:103]
    s_add_u32 s17, s49, 6144
    buffer_load_dwordx4 v[52:55], v3, s[8:11], s17 offen sc1
    v_rcp_f32 v86, v86
    v_rcp_f32 v87, v87
    v_mfma_f32_16x16x32_bf16 v[108:111], v[116:119], a[124:127], v[108:111]
    ds_read_b128 v[148:151], v5 offset:48128
    v_mul_f32 v84, v84, v92
    v_mfma_f32_16x16x32_bf16 v[104:107], v[116:119], a[120:123], v[104:107]
    s_add_u32 s17, s50, 6144
    buffer_load_dwordx4 v[56:59], v3, s[8:11], s17 offen sc1
    v_mul_f32 v85, v85, v93
    v_mul_f32 v86, v86, v94
    s_waitcnt lgkmcnt(6)
    v_mfma_f32_16x16x32_bf16 v[96:99], v[120:123], a[128:131], v[96:99]
    ds_read_b128 v[112:115], v14 offset:2560
    v_mul_f32 v87, v87, v95
    v_mfma_f32_16x16x32_bf16 v[100:103], v[120:123], a[132:135], v[100:103]
    s_add_u32 s17, s51, 6144
    buffer_load_dwordx4 v[60:63], v3, s[8:11], s17 offen sc1
    v_cvt_pk_bf16_f32 v156, v84, v85
    v_cvt_pk_bf16_f32 v157, v86, v87
    v_mfma_f32_16x16x32_bf16 v[108:111], v[124:127], a[132:135], v[108:111]
    ds_read_b128 v[116:119], v14 offset:2816
    v_mfma_f32_16x16x32_bf16 v[104:107], v[124:127], a[128:131], v[104:107]
    s_add_u32 s17, s48, 9216
    buffer_load_dwordx4 v[64:67], v3, s[8:11], s17 offen sc1
    s_waitcnt lgkmcnt(6)
    v_mfma_f32_16x16x32_bf16 v[96:99], v[128:131], a[136:139], v[96:99]
    v_mfma_f32_16x16x32_bf16 v[100:103], v[128:131], a[140:143], v[100:103]
    s_add_u32 s17, s49, 9216
    buffer_load_dwordx4 v[68:71], v3, s[8:11], s17 offen sc1
    v_mfma_f32_16x16x32_bf16 v[108:111], v[132:135], a[140:143], v[108:111]
    v_mfma_f32_16x16x32_bf16 v[104:107], v[132:135], a[136:139], v[104:107]
    s_add_u32 s17, s50, 9216
    buffer_load_dwordx4 v[72:75], v3, s[8:11], s17 offen sc1
    s_waitcnt lgkmcnt(4)
    v_mfma_f32_16x16x32_bf16 v[96:99], v[136:139], a[144:147], v[96:99]
    v_mfma_f32_16x16x32_bf16 v[100:103], v[136:139], a[148:151], v[100:103]
    s_add_u32 s17, s51, 9216
    buffer_load_dwordx4 v[76:79], v3, s[8:11], s17 offen sc1
    v_mfma_f32_16x16x32_bf16 v[108:111], v[140:143], a[148:151], v[108:111]
    v_mfma_f32_16x16x32_bf16 v[104:107], v[140:143], a[144:147], v[104:107]
    s_waitcnt lgkmcnt(2)
    v_mfma_f32_16x16x32_bf16 v[96:99], v[144:147], a[152:155], v[96:99]
    v_mfma_f32_16x16x32_bf16 v[100:103], v[144:147], a[156:159], v[100:103]
    v_mfma_f32_16x16x32_bf16 v[108:111], v[148:151], a[156:159], v[108:111]
    v_mfma_f32_16x16x32_bf16 v[104:107], v[148:151], a[152:155], v[104:107]
    s_waitcnt lgkmcnt(0)
    v_mfma_f32_16x16x32_bf16 v[96:99], v[112:115], v[164:167], v[96:99]
    v_mfma_f32_16x16x32_bf16 v[100:103], v[112:115], v[172:175], v[100:103]
    v_mfma_f32_16x16x32_bf16 v[108:111], v[116:119], v[172:175], v[108:111]
    v_mfma_f32_16x16x32_bf16 v[104:107], v[116:119], v[164:167], v[104:107]
    s_add_u32 s57, s60, 32
    s_lshl_b32 s58, s32, 3
    s_lshl_b32 s57, s57, 10
    s_lshl_b32 s58, s58, 5
    s_add_u32 s57, s57, s58
    s_add_u32 s59, s57, 37752832
    v_lshlrev_b32 v254, 5, v2
    s_mov_b64 exec, 0xff
    buffer_load_dwordx2 v[252:253], v254, s[8:11], s59 offen sc1
    s_mov_b64 exec, -1
    v_mul_f32 v96, v160, v96
    v_mul_f32 v97, v160, v97
    v_mul_f32 v98, v160, v98
    v_mul_f32 v99, v160, v99
    v_exp_f32 v96, v96
    v_exp_f32 v97, v97
    v_exp_f32 v98, v98
    v_exp_f32 v99, v99
    v_fma_f32 v96, v96, v161, v161
    v_fma_f32 v97, v97, v161, v161
    v_fma_f32 v98, v98, v161, v161
    v_fma_f32 v99, v99, v161, v161
    v_rcp_f32 v96, v96
    v_rcp_f32 v97, v97
    v_rcp_f32 v98, v98
    v_rcp_f32 v99, v99
    v_mul_f32 v96, v96, v104
    v_mul_f32 v97, v97, v105
    v_mul_f32 v98, v98, v106
    v_mul_f32 v99, v99, v107
    v_cvt_pk_bf16_f32 v154, v96, v97
    v_cvt_pk_bf16_f32 v155, v98, v99
    buffer_store_dwordx4 v[152:155], v3, s[8:11], s40 offen offset:2048 sc1
    v_mul_f32 v100, v168, v100
    v_mul_f32 v101, v168, v101
    v_mul_f32 v102, v168, v102
    v_mul_f32 v103, v168, v103
    v_exp_f32 v100, v100
    v_exp_f32 v101, v101
    v_exp_f32 v102, v102
    v_exp_f32 v103, v103
    v_fma_f32 v100, v100, v169, v169
    v_fma_f32 v101, v101, v169, v169
    v_fma_f32 v102, v102, v169, v169
    v_fma_f32 v103, v103, v169, v169
    v_rcp_f32 v100, v100
    v_rcp_f32 v101, v101
    v_rcp_f32 v102, v102
    v_rcp_f32 v103, v103
    v_mul_f32 v100, v100, v108
    v_mul_f32 v101, v101, v109
    v_mul_f32 v102, v102, v110
    v_mul_f32 v103, v103, v111
    v_cvt_pk_bf16_f32 v158, v100, v101
    v_cvt_pk_bf16_f32 v159, v102, v103
    buffer_store_dwordx4 v[156:159], v3, s[8:11], s41 offen offset:2048 sc1
    s_waitcnt vmcnt(16)
    v_mfma_f32_16x16x32_bf16 v[116:119], a[160:163], v[20:23], 0
    s_add_u32 s45, s52, 10485760
    v_lshrrev_b32 v5, 1, v4
    v_mfma_f32_16x16x32_bf16 v[120:123], a[164:167], v[20:23], 0
    v_lshlrev_b32 v5, 8, v5
    v_lshl_add_u32 v5, v8, 4, v5
    v_mfma_f32_16x16x32_bf16 v[124:127], a[168:171], v[20:23], 0
    v_and_b32 v6, 1, v4
    v_lshl_add_u32 v5, v6, 3, v5
    v_mfma_f32_16x16x32_bf16 v[128:131], a[172:175], v[20:23], 0
    s_add_u32 s33, s32, 1
    s_and_b32 s33, s33, 3
    v_mfma_f32_16x16x32_bf16 v[132:135], a[176:179], v[20:23], 0
    s_mul_i32 s33, s33, 15360
    s_add_u32 s33, s33, 10240
    v_mfma_f32_16x16x32_bf16 v[152:155], a[176:179], v[24:27], 0
    v_add_u32 v10, s33, v3
    s_add_u32 s33, s32, 2
    v_mfma_f32_16x16x32_bf16 v[148:151], a[172:175], v[24:27], 0
    s_and_b32 s33, s33, 3
    s_mul_i32 s33, s33, 15360
    v_mfma_f32_16x16x32_bf16 v[144:147], a[168:171], v[24:27], 0
    s_add_u32 s33, s33, 5120
    v_add_u32 v11, s33, v3
    v_mfma_f32_16x16x32_bf16 v[140:143], a[164:167], v[24:27], 0
    s_add_u32 s33, s32, 3
    s_and_b32 s33, s33, 3
    v_mfma_f32_16x16x32_bf16 v[136:139], a[160:163], v[24:27], 0
    s_mul_i32 s33, s33, 15360
    s_add_u32 s33, s33, 0
    v_mfma_f32_16x16x32_bf16 v[156:159], a[160:163], v[28:31], 0
    v_add_u32 v12, s33, v3
    s_mul_i32 s33, s32, 15360
    v_mfma_f32_16x16x32_bf16 v[160:163], a[164:167], v[28:31], 0
    v_add_u32 v13, s33, v3
    v_add_u32 v14, 61440, v3
    v_mfma_f32_16x16x32_bf16 v[164:167], a[168:171], v[28:31], 0
    v_add_u32 v15, 98304, v3
    s_lshr_b32 s33, s32, 1
    v_mfma_f32_16x16x32_bf16 v[168:171], a[172:175], v[28:31], 0
    s_lshl_b32 s33, s33, 5
    s_add_u32 s33, s33, s63
    v_mfma_f32_16x16x32_bf16 v[172:175], a[176:179], v[28:31], 0
    s_and_b32 s34, s32, 1
    s_lshl_b32 s34, s34, 10
    v_mfma_f32_16x16x32_bf16 v[112:115], a[176:179], v[16:19], 0
    s_add_u32 s33, s33, s34
    s_mul_i32 s33, s33, 1280
    v_mfma_f32_16x16x32_bf16 v[108:111], a[172:175], v[16:19], 0
    s_mul_i32 s34, s61, 160
    s_add_u32 s44, s33, s34
    v_mfma_f32_16x16x32_bf16 v[104:107], a[168:171], v[16:19], 0
    v_mul_u32_u24 v6, 81920, v8
    v_lshl_add_u32 v7, v4, 3, v6
    v_mfma_f32_16x16x32_bf16 v[100:103], a[164:167], v[16:19], 0
    v_lshl_add_u32 v6, v4, 4, v6
    s_mov_b32 s12, s98
    v_mfma_f32_16x16x32_bf16 v[96:99], a[160:163], v[16:19], 0
    s_mov_b32 s13, s99
    s_mov_b32 s14, 2621440
    s_waitcnt vmcnt(2)
    s_mov_b64 exec, 0xff
    v_cmp_ne_u64 vcc, s[100:101], v[252:253]
    s_mov_b64 exec, -1
    s_cbranch_vccz chk_19
    s_mov_b64 exec, 0xff
    s_mov_b32 s58, 0x40000
sync_20_p:
    buffer_load_dwordx2 v[252:253], v254, s[8:11], s59 offen sc1
    s_sub_u32 s58, s58, 1
    s_waitcnt vmcnt(0)
    v_cmp_ne_u64 vcc, s[100:101], v[252:253]
    s_cbranch_scc1 sync_20_x
    s_cbranch_vccnz sync_20_p
sync_20_x:
    s_mov_b64 exec, -1
chk_19:
    s_waitcnt vmcnt(11)
    v_mfma_f32_16x16x32_bf16 v[116:119], a[180:183], v[36:39], v[116:119]
    s_add_u32 s17, s48, 1024
    buffer_load_dwordx4 a[96:99], v3, s[8:11], s17 offen sc1
    v_mfma_f32_16x16x32_bf16 v[120:123], a[184:187], v[36:39], v[120:123]
    s_mov_b32 s15, 0x20000
    v_mfma_f32_16x16x32_bf16 v[124:127], a[188:191], v[36:39], v[124:127]
    s_add_u32 s17, s49, 1024
    buffer_load_dwordx4 a[100:103], v3, s[8:11], s17 offen sc1
    v_mfma_f32_16x16x32_bf16 v[128:131], a[192:195], v[36:39], v[128:131]
    v_mfma_f32_16x16x32_bf16 v[132:135], a[196:199], v[36:39], v[132:135]
    s_add_u32 s17, s50, 1024
    buffer_load_dwordx4 a[104:107], v3, s[8:11], s17 offen sc1
    v_mfma_f32_16x16x32_bf16 v[152:155], a[196:199], v[40:43], v[152:155]
    v_mfma_f32_16x16x32_bf16 v[148:151], a[192:195], v[40:43], v[148:151]
    s_add_u32 s17, s51, 1024
    buffer_load_dwordx4 a[108:111], v3, s[8:11], s17 offen sc1
    v_mfma_f32_16x16x32_bf16 v[144:147], a[188:191], v[40:43], v[144:147]
    v_mfma_f32_16x16x32_bf16 v[140:143], a[184:187], v[40:43], v[140:143]
    s_add_u32 s17, s48, 4096
    buffer_load_dwordx4 a[112:115], v3, s[8:11], s17 offen sc1
    v_mfma_f32_16x16x32_bf16 v[136:139], a[180:183], v[40:43], v[136:139]
    v_mfma_f32_16x16x32_bf16 v[156:159], a[180:183], v[44:47], v[156:159]
    s_add_u32 s17, s49, 4096
    buffer_load_dwordx4 a[116:119], v3, s[8:11], s17 offen sc1
    v_mfma_f32_16x16x32_bf16 v[160:163], a[184:187], v[44:47], v[160:163]
    v_mfma_f32_16x16x32_bf16 v[164:167], a[188:191], v[44:47], v[164:167]
    s_add_u32 s17, s50, 4096
    buffer_load_dwordx4 a[120:123], v3, s[8:11], s17 offen sc1
    v_mfma_f32_16x16x32_bf16 v[168:171], a[192:195], v[44:47], v[168:171]
    v_mfma_f32_16x16x32_bf16 v[172:175], a[196:199], v[44:47], v[172:175]
    s_add_u32 s17, s51, 4096
    buffer_load_dwordx4 a[124:127], v3, s[8:11], s17 offen sc1
    v_mfma_f32_16x16x32_bf16 v[112:115], a[196:199], v[32:35], v[112:115]
    v_mfma_f32_16x16x32_bf16 v[108:111], a[192:195], v[32:35], v[108:111]
    v_mfma_f32_16x16x32_bf16 v[104:107], a[188:191], v[32:35], v[104:107]
    v_mfma_f32_16x16x32_bf16 v[100:103], a[184:187], v[32:35], v[100:103]
    v_mfma_f32_16x16x32_bf16 v[96:99], a[180:183], v[32:35], v[96:99]
    s_waitcnt vmcnt(15)
    v_mfma_f32_16x16x32_bf16 v[116:119], a[200:203], v[52:55], v[116:119]
    s_add_u32 s17, s48, 7168
    buffer_load_dwordx4 a[128:131], v3, s[8:11], s17 offen sc1
    v_mfma_f32_16x16x32_bf16 v[120:123], a[204:207], v[52:55], v[120:123]
    v_mfma_f32_16x16x32_bf16 v[124:127], a[208:211], v[52:55], v[124:127]
    s_add_u32 s17, s49, 7168
    buffer_load_dwordx4 a[132:135], v3, s[8:11], s17 offen sc1
    v_mfma_f32_16x16x32_bf16 v[128:131], a[212:215], v[52:55], v[128:131]
    v_mfma_f32_16x16x32_bf16 v[132:135], a[216:219], v[52:55], v[132:135]
    s_add_u32 s17, s50, 7168
    buffer_load_dwordx4 a[136:139], v3, s[8:11], s17 offen sc1
    v_mfma_f32_16x16x32_bf16 v[152:155], a[216:219], v[56:59], v[152:155]
    v_mfma_f32_16x16x32_bf16 v[148:151], a[212:215], v[56:59], v[148:151]
    s_add_u32 s17, s51, 7168
    buffer_load_dwordx4 a[140:143], v3, s[8:11], s17 offen sc1
    v_mfma_f32_16x16x32_bf16 v[144:147], a[208:211], v[56:59], v[144:147]
    v_mfma_f32_16x16x32_bf16 v[140:143], a[204:207], v[56:59], v[140:143]
    s_add_u32 s17, s48, 10240
    buffer_load_dwordx4 a[144:147], v3, s[8:11], s17 offen sc1
    v_mfma_f32_16x16x32_bf16 v[136:139], a[200:203], v[56:59], v[136:139]
    v_mfma_f32_16x16x32_bf16 v[156:159], a[200:203], v[60:63], v[156:159]
    s_add_u32 s17, s49, 10240
    buffer_load_dwordx4 a[148:151], v3, s[8:11], s17 offen sc1
    v_mfma_f32_16x16x32_bf16 v[160:163], a[204:207], v[60:63], v[160:163]
    v_mfma_f32_16x16x32_bf16 v[164:167], a[208:211], v[60:63], v[164:167]
    s_add_u32 s17, s50, 10240
    buffer_load_dwordx4 a[152:155], v3, s[8:11], s17 offen sc1
    v_mfma_f32_16x16x32_bf16 v[168:171], a[212:215], v[60:63], v[168:171]
    v_mfma_f32_16x16x32_bf16 v[172:175], a[216:219], v[60:63], v[172:175]
    s_add_u32 s17, s51, 10240
    buffer_load_dwordx4 a[156:159], v3, s[8:11], s17 offen sc1
    v_mfma_f32_16x16x32_bf16 v[112:115], a[216:219], v[48:51], v[112:115]
    v_mfma_f32_16x16x32_bf16 v[108:111], a[212:215], v[48:51], v[108:111]
    v_mfma_f32_16x16x32_bf16 v[104:107], a[208:211], v[48:51], v[104:107]
    v_mfma_f32_16x16x32_bf16 v[100:103], a[204:207], v[48:51], v[100:103]
    v_mfma_f32_16x16x32_bf16 v[96:99], a[200:203], v[48:51], v[96:99]
    s_waitcnt vmcnt(19)
    s_barrier
    v_mfma_f32_16x16x32_bf16 v[116:119], a[220:223], v[68:71], v[116:119]
    s_add_u32 s30, s31, 43008
    s_add_u32 m0, s54, 61440
    s_nop 0
    buffer_load_dwordx4 v3, s[8:11], s30 offen  lds
    v_mfma_f32_16x16x32_bf16 v[120:123], a[224:227], v[68:71], v[120:123]
    v_mfma_f32_16x16x32_bf16 v[124:127], a[228:231], v[68:71], v[124:127]
    s_add_u32 s30, s31, 44032
    s_add_u32 m0, s54, 62464
    s_nop 0
    buffer_load_dwordx4 v3, s[8:11], s30 offen  lds
    v_mfma_f32_16x16x32_bf16 v[128:131], a[232:235], v[68:71], v[128:131]
    v_mfma_f32_16x16x32_bf16 v[132:135], a[236:239], v[68:71], v[132:135]
    s_add_u32 s30, s31, 45056
    s_add_u32 m0, s54, 63488
    s_nop 0
    buffer_load_dwordx4 v3, s[8:11], s30 offen  lds
    v_mfma_f32_16x16x32_bf16 v[152:155], a[236:239], v[72:75], v[152:155]
    v_mfma_f32_16x16x32_bf16 v[148:151], a[232:235], v[72:75], v[148:151]
    s_add_u32 s30, s31, 56320
    s_add_u32 m0, s54, 64512
    s_nop 0
    buffer_load_dwordx4 v3, s[8:11], s30 offen  lds
    v_mfma_f32_16x16x32_bf16 v[144:147], a[228:231], v[72:75], v[144:147]
    v_mfma_f32_16x16x32_bf16 v[140:143], a[224:227], v[72:75], v[140:143]
    s_add_u32 s30, s31, 57344
    s_add_u32 m0, s54, 65536
    s_nop 0
    buffer_load_dwordx4 v3, s[8:11], s30 offen  lds
    v_mfma_f32_16x16x32_bf16 v[136:139], a[220:223], v[72:75], v[136:139]
    v_mfma_f32_16x16x32_bf16 v[156:159], a[220:223], v[76:79], v[156:159]
    s_add_u32 s30, s31, 58368
    s_add_u32 m0, s54, 66560
    s_nop 0
    buffer_load_dwordx4 v3, s[8:11], s30 offen  lds
    v_mfma_f32_16x16x32_bf16 v[160:163], a[224:227], v[76:79], v[160:163]
    v_mfma_f32_16x16x32_bf16 v[164:167], a[228:231], v[76:79], v[164:167]
    s_add_u32 s30, s31, 59392
    s_add_u32 m0, s54, 67584
    s_nop 0
    buffer_load_dwordx4 v3, s[8:11], s30 offen  lds
    v_mfma_f32_16x16x32_bf16 v[168:171], a[232:235], v[76:79], v[168:171]
    v_mfma_f32_16x16x32_bf16 v[172:175], a[236:239], v[76:79], v[172:175]
    s_add_u32 s30, s31, 60416
    s_add_u32 m0, s54, 68608
    s_nop 0
    buffer_load_dwordx4 v3, s[8:11], s30 offen  lds
    v_mfma_f32_16x16x32_bf16 v[112:115], a[236:239], v[64:67], v[112:115]
    v_mfma_f32_16x16x32_bf16 v[108:111], a[232:235], v[64:67], v[108:111]
    v_mfma_f32_16x16x32_bf16 v[104:107], a[228:231], v[64:67], v[104:107]
    v_mfma_f32_16x16x32_bf16 v[100:103], a[224:227], v[64:67], v[100:103]
    v_mfma_f32_16x16x32_bf16 v[96:99], a[220:223], v[64:67], v[96:99]
    s_waitcnt vmcnt(24)
    s_lshl_b32 s56, s20, 2
    s_add_u32 s56, s56, s32
    s_add_u32 s56, s56, 64
    s_mov_b32 s57, s21
    s_lshl_b32 s56, s56, 10
    s_lshl_b32 s57, s57, 5
    s_add_u32 s56, s56, s57
    s_add_u32 s56, s56, 37752832
    v_mov_b32 v250, s100
    v_mov_b32 v251, s101
    s_mov_b64 exec, 1
    buffer_store_dwordx2 v[250:251], v3, s[8:11], s56 offen sc1
    s_mov_b64 exec, -1
    s_waitcnt vmcnt(21)
    v_mfma_f32_16x16x32_bf16 v[116:119], a[240:243], a[100:103], v[116:119]
    v_mfma_f32_16x16x32_bf16 v[120:123], a[244:247], a[100:103], v[120:123]
    v_mfma_f32_16x16x32_bf16 v[124:127], a[248:251], a[100:103], v[124:127]
    v_mfma_f32_16x16x32_bf16 v[128:131], a[252:255], a[100:103], v[128:131]
    v_mfma_f32_16x16x32_bf16 v[132:135], v[196:199], a[100:103], v[132:135]
    v_mfma_f32_16x16x32_bf16 v[152:155], v[196:199], a[104:107], v[152:155]
    v_mfma_f32_16x16x32_bf16 v[148:151], a[252:255], a[104:107], v[148:151]
    v_mfma_f32_16x16x32_bf16 v[144:147], a[248:251], a[104:107], v[144:147]
    v_mfma_f32_16x16x32_bf16 v[140:143], a[244:247], a[104:107], v[140:143]
    v_mfma_f32_16x16x32_bf16 v[136:139], a[240:243], a[104:107], v[136:139]
    v_mfma_f32_16x16x32_bf16 v[156:159], a[240:243], a[108:111], v[156:159]
    v_mfma_f32_16x16x32_bf16 v[160:163], a[244:247], a[108:111], v[160:163]
    v_mfma_f32_16x16x32_bf16 v[164:167], a[248:251], a[108:111], v[164:167]
    v_mfma_f32_16x16x32_bf16 v[168:171], a[252:255], a[108:111], v[168:171]
    v_mfma_f32_16x16x32_bf16 v[172:175], v[196:199], a[108:111], v[172:175]
    v_mfma_f32_16x16x32_bf16 v[112:115], v[196:199], a[96:99], v[112:115]
    v_mfma_f32_16x16x32_bf16 v[108:111], a[252:255], a[96:99], v[108:111]
    v_mfma_f32_16x16x32_bf16 v[104:107], a[248:251], a[96:99], v[104:107]
    v_mfma_f32_16x16x32_bf16 v[100:103], a[244:247], a[96:99], v[100:103]
    v_mfma_f32_16x16x32_bf16 v[96:99], a[240:243], a[96:99], v[96:99]
    s_waitcnt vmcnt(17)
    v_mfma_f32_16x16x32_bf16 v[116:119], v[200:203], a[116:119], v[116:119]
    buffer_load_dwordx4 v[240:243], v3, s[8:11], s45 offen sc1
    v_mfma_f32_16x16x32_bf16 v[120:123], v[204:207], a[116:119], v[120:123]
    v_mfma_f32_16x16x32_bf16 v[124:127], v[208:211], a[116:119], v[124:127]
    buffer_load_dwordx4 v[244:247], v3, s[8:11], s45 offen offset:1024 sc1
    v_mfma_f32_16x16x32_bf16 v[128:131], v[212:215], a[116:119], v[128:131]
    v_mfma_f32_16x16x32_bf16 v[132:135], v[216:219], a[116:119], v[132:135]
    buffer_load_dwordx2 v[248:249], v5, s[8:11], s45 offen offset:2048 sc1
    v_mfma_f32_16x16x32_bf16 v[152:155], v[216:219], a[120:123], v[152:155]
    v_mfma_f32_16x16x32_bf16 v[148:151], v[212:215], a[120:123], v[148:151]
    v_mfma_f32_16x16x32_bf16 v[144:147], v[208:211], a[120:123], v[144:147]
    v_mfma_f32_16x16x32_bf16 v[140:143], v[204:207], a[120:123], v[140:143]
    v_mfma_f32_16x16x32_bf16 v[136:139], v[200:203], a[120:123], v[136:139]
    v_mfma_f32_16x16x32_bf16 v[156:159], v[200:203], a[124:127], v[156:159]
    v_mfma_f32_16x16x32_bf16 v[160:163], v[204:207], a[124:127], v[160:163]
    v_mfma_f32_16x16x32_bf16 v[164:167], v[208:211], a[124:127], v[164:167]
    v_mfma_f32_16x16x32_bf16 v[168:171], v[212:215], a[124:127], v[168:171]
    v_mfma_f32_16x16x32_bf16 v[172:175], v[216:219], a[124:127], v[172:175]
    s_waitcnt vmcnt(16)
    v_mfma_f32_16x16x32_bf16 v[116:119], v[220:223], a[132:135], v[116:119]
    v_mfma_f32_16x16x32_bf16 v[120:123], v[224:227], a[132:135], v[120:123]
    v_mfma_f32_16x16x32_bf16 v[124:127], v[228:231], a[132:135], v[124:127]
    v_mfma_f32_16x16x32_bf16 v[128:131], v[232:235], a[132:135], v[128:131]
    v_mfma_f32_16x16x32_bf16 v[132:135], v[236:239], a[132:135], v[132:135]
    v_mfma_f32_16x16x32_bf16 v[152:155], v[236:239], a[136:139], v[152:155]
    v_mfma_f32_16x16x32_bf16 v[148:151], v[232:235], a[136:139], v[148:151]
    v_mfma_f32_16x16x32_bf16 v[144:147], v[228:231], a[136:139], v[144:147]
    v_mfma_f32_16x16x32_bf16 v[140:143], v[224:227], a[136:139], v[140:143]
    v_mfma_f32_16x16x32_bf16 v[136:139], v[220:223], a[136:139], v[136:139]
    v_mfma_f32_16x16x32_bf16 v[156:159], v[220:223], a[140:143], v[156:159]
    v_mfma_f32_16x16x32_bf16 v[160:163], v[224:227], a[140:143], v[160:163]
    v_mfma_f32_16x16x32_bf16 v[164:167], v[228:231], a[140:143], v[164:167]
    v_mfma_f32_16x16x32_bf16 v[168:171], v[232:235], a[140:143], v[168:171]
    v_mfma_f32_16x16x32_bf16 v[172:175], v[236:239], a[140:143], v[172:175]
    s_waitcnt vmcnt(12)
    v_mfma_f32_16x16x32_bf16 v[116:119], a[0:3], a[148:151], v[116:119]
    v_mfma_f32_16x16x32_bf16 v[120:123], a[4:7], a[148:151], v[120:123]
    v_mfma_f32_16x16x32_bf16 v[124:127], a[8:11], a[148:151], v[124:127]
    v_mfma_f32_16x16x32_bf16 v[128:131], a[12:15], a[148:151], v[128:131]
    v_mfma_f32_16x16x32_bf16 v[132:135], a[16:19], a[148:151], v[132:135]
    v_mfma_f32_16x16x32_bf16 v[152:155], a[16:19], a[152:155], v[152:155]
    v_mfma_f32_16x16x32_bf16 v[148:151], a[12:15], a[152:155], v[148:151]
    v_mfma_f32_16x16x32_bf16 v[144:147], a[8:11], a[152:155], v[144:147]
    v_mfma_f32_16x16x32_bf16 v[140:143], a[4:7], a[152:155], v[140:143]
    v_mfma_f32_16x16x32_bf16 v[136:139], a[0:3], a[152:155], v[136:139]
    v_mfma_f32_16x16x32_bf16 v[156:159], a[0:3], a[156:159], v[156:159]
    v_mfma_f32_16x16x32_bf16 v[160:163], a[4:7], a[156:159], v[160:163]
    v_mfma_f32_16x16x32_bf16 v[164:167], a[8:11], a[156:159], v[164:167]
    v_mfma_f32_16x16x32_bf16 v[168:171], a[12:15], a[156:159], v[168:171]
    v_mfma_f32_16x16x32_bf16 v[172:175], a[16:19], a[156:159], v[172:175]
    s_lshl_b32 s57, s60, 1
    s_lshr_b32 s58, s32, 1
    s_add_u32 s57, s57, s58
    s_add_u32 s57, s57, 64
    s_mov_b32 s58, 0
    s_lshl_b32 s57, s57, 10
    s_lshl_b32 s58, s58, 5
    s_add_u32 s57, s57, s58
    s_add_u32 s59, s57, 37752832
    v_lshlrev_b32 v254, 5, v2
    s_mov_b64 exec, 0xffff
    buffer_load_dwordx2 v[252:253], v254, s[8:11], s59 offen sc1
    s_mov_b64 exec, -1
    v_mfma_f32_16x16x32_bf16 v[96:99], v[200:203], a[112:115], v[96:99]
    ds_write_b128 v10, v[116:119] offset:0
    v_mfma_f32_16x16x32_bf16 v[100:103], v[204:207], a[112:115], v[100:103]
    ds_write_b128 v10, v[120:123] offset:1024
    v_mfma_f32_16x16x32_bf16 v[104:107], v[208:211], a[112:115], v[104:107]
    ds_write_b128 v10, v[124:127] offset:2048
    v_mfma_f32_16x16x32_bf16 v[108:111], v[212:215], a[112:115], v[108:111]
    ds_write_b128 v10, v[128:131] offset:3072
    v_mfma_f32_16x16x32_bf16 v[112:115], v[216:219], a[112:115], v[112:115]
    ds_write_b128 v10, v[132:135] offset:4096
    v_mfma_f32_16x16x32_bf16 v[96:99], v[220:223], a[128:131], v[96:99]
    ds_write_b128 v11, v[136:139] offset:0
    v_mfma_f32_16x16x32_bf16 v[100:103], v[224:227], a[128:131], v[100:103]
    ds_write_b128 v11, v[140:143] offset:1024
    v_mfma_f32_16x16x32_bf16 v[104:107], v[228:231], a[128:131], v[104:107]
    ds_write_b128 v11, v[144:147] offset:2048
    v_mfma_f32_16x16x32_bf16 v[108:111], v[232:235], a[128:131], v[108:111]
    ds_write_b128 v11, v[148:151] offset:3072
    v_mfma_f32_16x16x32_bf16 v[112:115], v[236:239], a[128:131], v[112:115]
    ds_write_b128 v11, v[152:155] offset:4096
    v_mfma_f32_16x16x32_bf16 v[96:99], a[0:3], a[144:147], v[96:99]
    ds_write_b128 v12, v[156:159] offset:0
    v_mfma_f32_16x16x32_bf16 v[100:103], a[4:7], a[144:147], v[100:103]
    ds_write_b128 v12, v[160:163] offset:1024
    v_mfma_f32_16x16x32_bf16 v[104:107], a[8:11], a[144:147], v[104:107]
    ds_write_b128 v12, v[164:167] offset:2048
    v_mfma_f32_16x16x32_bf16 v[108:111], a[12:15], a[144:147], v[108:111]
    ds_write_b128 v12, v[168:171] offset:3072
    v_mfma_f32_16x16x32_bf16 v[112:115], a[16:19], a[144:147], v[112:115]
    ds_write_b128 v12, v[172:175] offset:4096
    s_waitcnt vmcnt(0)
    s_mov_b64 exec, 0xffff
    v_cmp_ne_u64 vcc, s[100:101], v[252:253]
    s_mov_b64 exec, -1
    s_cbranch_vccz chk_21
    s_mov_b64 exec, 0xffff
    s_mov_b32 s58, 0x40000
sync_22_p:
    buffer_load_dwordx2 v[252:253], v254, s[8:11], s59 offen sc1
    s_sub_u32 s58, s58, 1
    s_waitcnt vmcnt(0)
    v_cmp_ne_u64 vcc, s[100:101], v[252:253]
    s_cbranch_scc1 sync_22_x
    s_cbranch_vccnz sync_22_p
sync_22_x:
    s_mov_b64 exec, -1
chk_21:
    s_add_u32 s17, s55, 0
    buffer_load_dwordx4 v[16:19], v3, s[8:11], s17 offen sc1
    s_add_u32 s17, s55, 3072
    buffer_load_dwordx4 v[20:23], v3, s[8:11], s17 offen sc1
    s_add_u32 s17, s55, 6144
    buffer_load_dwordx4 v[24:27], v3, s[8:11], s17 offen sc1
    s_add_u32 s17, s55, 9216
    buffer_load_dwordx4 v[28:31], v3, s[8:11], s17 offen sc1
    s_add_u32 s17, s55, 12288
    buffer_load_dwordx4 v[32:35], v3, s[8:11], s17 offen sc1
    s_add_u32 s17, s55, 15360
    buffer_load_dwordx4 v[36:39], v3, s[8:11], s17 offen sc1
    s_add_u32 s17, s55, 18432
    buffer_load_dwordx4 v[40:43], v3, s[8:11], s17 offen sc1
    s_add_u32 s17, s55, 21504
    buffer_load_dwordx4 v[44:47], v3, s[8:11], s17 offen sc1
    s_add_u32 s17, s55, 24576
    buffer_load_dwordx4 v[48:51], v3, s[8:11], s17 offen sc1
    s_add_u32 s17, s55, 27648
    buffer_load_dwordx4 v[52:55], v3, s[8:11], s17 offen sc1
    s_add_u32 s17, s55, 30720
    buffer_load_dwordx4 v[56:59], v3, s[8:11], s17 offen sc1
    s_add_u32 s17, s55, 33792
    buffer_load_dwordx4 v[60:63], v3, s[8:11], s17 offen sc1
    s_add_u32 s17, s55, 36864
    buffer_load_dwordx4 v[64:67], v3, s[8:11], s17 offen sc1
    s_add_u32 s17, s55, 39936
    buffer_load_dwordx4 v[68:71], v3, s[8:11], s17 offen sc1
    s_add_u32 s17, s55, 43008
    buffer_load_dwordx4 v[72:75], v3, s[8:11], s17 offen sc1
    s_add_u32 s17, s55, 46080
    buffer_load_dwordx4 v[76:79], v3, s[8:11], s17 offen sc1
    s_waitcnt vmcnt(17)
    s_waitcnt lgkmcnt(0)
    s_barrier
    ds_read_b128 v[116:119], v13 offset:0
    ds_read_b128 v[120:123], v13 offset:1024
    ds_read_b128 v[124:127], v13 offset:2048
    ds_read_b128 v[128:131], v13 offset:3072
    ds_read_b128 v[132:135], v13 offset:4096
    ds_read_b128 v[136:139], v13 offset:5120
    ds_read_b128 v[140:143], v13 offset:6144
    ds_read_b128 v[144:147], v13 offset:7168
    ds_read_b128 v[148:151], v13 offset:8192
    ds_read_b128 v[152:155], v13 offset:9216
    ds_read_b128 v[156:159], v13 offset:10240
    ds_read_b128 v[160:163], v13 offset:11264
    ds_read_b128 v[164:167], v13 offset:12288
    ds_read_b128 v[168:171], v13 offset:13312
    ds_read_b128 v[172:175], v13 offset:14336
    v_lshlrev_b32 v250, 16, v240
    v_and_b32 v251, 0xffff0000, v240
    v_add_f32 v96, v96, v250
    v_add_f32 v97, v97, v251
    v_lshlrev_b32 v250, 16, v241
    v_and_b32 v251, 0xffff0000, v241
    v_add_f32 v98, v98, v250
    v_add_f32 v99, v99, v251
    v_lshlrev_b32 v250, 16, v242
    v_and_b32 v251, 0xffff0000, v242
    v_add_f32 v100, v100, v250
    v_add_f32 v101, v101, v251
    v_lshlrev_b32 v250, 16, v243
    v_and_b32 v251, 0xffff0000, v243
    v_add_f32 v102, v102, v250
    v_add_f32 v103, v103, v251
    v_lshlrev_b32 v250, 16, v244
    v_and_b32 v251, 0xffff0000, v244
    v_add_f32 v104, v104, v250
    v_add_f32 v105, v105, v251
    v_lshlrev_b32 v250, 16, v245
    v_and_b32 v251, 0xffff0000, v245
    v_add_f32 v106, v106, v250
    v_add_f32 v107, v107, v251
    v_lshlrev_b32 v250, 16, v246
    v_and_b32 v251, 0xffff0000, v246
    v_add_f32 v108, v108, v250
    v_add_f32 v109, v109, v251
    v_lshlrev_b32 v250, 16, v247
    v_and_b32 v251, 0xffff0000, v247
    v_add_f32 v110, v110, v250
    v_add_f32 v111, v111, v251
    v_lshlrev_b32 v250, 16, v248
    v_and_b32 v251, 0xffff0000, v248
    v_add_f32 v112, v112, v250
    v_add_f32 v113, v113, v251
    v_lshlrev_b32 v250, 16, v249
    v_and_b32 v251, 0xffff0000, v249
    v_add_f32 v114, v114, v250
    v_add_f32 v115, v115, v251
    s_waitcnt lgkmcnt(10)
    v_add_f32 v96, v96, v116
    v_add_f32 v97, v97, v117
    v_add_f32 v98, v98, v118
    v_add_f32 v99, v99, v119
    v_add_f32 v100, v100, v120
    v_add_f32 v101, v101, v121
    v_add_f32 v102, v102, v122
    v_add_f32 v103, v103, v123
    v_add_f32 v104, v104, v124
    v_add_f32 v105, v105, v125
    v_add_f32 v106, v106, v126
    v_add_f32 v107, v107, v127
    v_add_f32 v108, v108, v128
    v_add_f32 v109, v109, v129
    v_add_f32 v110, v110, v130
    v_add_f32 v111, v111, v131
    v_add_f32 v112, v112, v132
    v_add_f32 v113, v113, v133
    v_add_f32 v114, v114, v134
    v_add_f32 v115, v115, v135
    s_waitcnt lgkmcnt(5)
    v_add_f32 v96, v96, v136
    v_add_f32 v97, v97, v137
    v_add_f32 v98, v98, v138
    v_add_f32 v99, v99, v139
    v_add_f32 v100, v100, v140
    v_add_f32 v101, v101, v141
    v_add_f32 v102, v102, v142
    v_add_f32 v103, v103, v143
    v_add_f32 v104, v104, v144
    v_add_f32 v105, v105, v145
    v_add_f32 v106, v106, v146
    v_add_f32 v107, v107, v147
    v_add_f32 v108, v108, v148
    v_add_f32 v109, v109, v149
    v_add_f32 v110, v110, v150
    v_add_f32 v111, v111, v151
    v_add_f32 v112, v112, v152
    v_add_f32 v113, v113, v153
    v_add_f32 v114, v114, v154
    v_add_f32 v115, v115, v155
    s_waitcnt lgkmcnt(0)
    v_add_f32 v96, v96, v156
    v_add_f32 v97, v97, v157
    v_add_f32 v98, v98, v158
    v_add_f32 v99, v99, v159
    v_add_f32 v100, v100, v160
    v_add_f32 v101, v101, v161
    v_add_f32 v102, v102, v162
    v_add_f32 v103, v103, v163
    v_add_f32 v104, v104, v164
    v_add_f32 v105, v105, v165
    v_add_f32 v106, v106, v166
    v_add_f32 v107, v107, v167
    v_add_f32 v108, v108, v168
    v_add_f32 v109, v109, v169
    v_add_f32 v110, v110, v170
    v_add_f32 v111, v111, v171
    v_add_f32 v112, v112, v172
    v_add_f32 v113, v113, v173
    v_add_f32 v114, v114, v174
    v_add_f32 v115, v115, v175
    ds_read_b128 v[116:119], v15 offset:0
    ds_read_b128 v[120:123], v15 offset:1024
    ds_read_b128 v[124:127], v15 offset:2048
    ds_read_b128 v[128:131], v15 offset:3072
    ds_read_b128 v[132:135], v15 offset:4096
    ds_read_b128 v[136:139], v15 offset:5120
    ds_read_b128 v[140:143], v15 offset:6144
    ds_read_b128 v[144:147], v15 offset:7168
    ds_read_b128 v[148:151], v15 offset:8192
    ds_read_b128 v[152:155], v15 offset:9216
    s_waitcnt vmcnt(15)
    s_waitcnt lgkmcnt(9)
    v_mfma_f32_16x16x32_bf16 v[96:99], v[116:119], v[16:19], v[96:99]
    ds_read_b128 v[156:159], v15 offset:10240
    s_waitcnt lgkmcnt(9)
    v_mfma_f32_16x16x32_bf16 v[100:103], v[120:123], v[16:19], v[100:103]
    ds_read_b128 v[160:163], v15 offset:11264
    s_waitcnt lgkmcnt(9)
    v_mfma_f32_16x16x32_bf16 v[104:107], v[124:127], v[16:19], v[104:107]
    ds_read_b128 v[116:119], v14 offset:0
    s_waitcnt lgkmcnt(9)
    v_mfma_f32_16x16x32_bf16 v[108:111], v[128:131], v[16:19], v[108:111]
    ds_read_b128 v[120:123], v14 offset:1024
    s_waitcnt lgkmcnt(9)
    v_mfma_f32_16x16x32_bf16 v[112:115], v[132:135], v[16:19], v[112:115]
    ds_read_b128 v[124:127], v14 offset:2048
    s_waitcnt vmcnt(14)
    s_waitcnt lgkmcnt(9)
    v_mfma_f32_16x16x32_bf16 v[96:99], v[136:139], v[20:23], v[96:99]
    ds_read_b128 v[128:131], v14 offset:3072
    s_waitcnt lgkmcnt(9)
    v_mfma_f32_16x16x32_bf16 v[100:103], v[140:143], v[20:23], v[100:103]
    ds_read_b128 v[132:135], v14 offset:4096
    s_waitcnt lgkmcnt(9)
    v_mfma_f32_16x16x32_bf16 v[104:107], v[144:147], v[20:23], v[104:107]
    ds_read_b128 v[136:139], v14 offset:5120
    s_waitcnt lgkmcnt(9)
    v_mfma_f32_16x16x32_bf16 v[108:111], v[148:151], v[20:23], v[108:111]
    ds_read_b128 v[140:143], v14 offset:6144
    s_waitcnt lgkmcnt(9)
    v_mfma_f32_16x16x32_bf16 v[112:115], v[152:155], v[20:23], v[112:115]
    ds_read_b128 v[144:147], v14 offset:7168
    s_waitcnt vmcnt(13)
    s_waitcnt lgkmcnt(9)
    v_mfma_f32_16x16x32_bf16 v[96:99], v[156:159], v[24:27], v[96:99]
    ds_read_b128 v[148:151], v15 offset:12288
    s_waitcnt lgkmcnt(9)
    v_mfma_f32_16x16x32_bf16 v[100:103], v[160:163], v[24:27], v[100:103]
    ds_read_b128 v[152:155], v15 offset:13312
    s_waitcnt lgkmcnt(9)
    v_mfma_f32_16x16x32_bf16 v[104:107], v[116:119], v[24:27], v[104:107]
    ds_read_b128 v[156:159], v15 offset:14336
    s_waitcnt lgkmcnt(9)
    v_mfma_f32_16x16x32_bf16 v[108:111], v[120:123], v[24:27], v[108:111]
    ds_read_b128 v[160:163], v15 offset:15360
    s_waitcnt lgkmcnt(9)
    v_mfma_f32_16x16x32_bf16 v[112:115], v[124:127], v[24:27], v[112:115]
    ds_read_b128 v[116:119], v15 offset:16384
    s_waitcnt vmcnt(12)
    s_waitcnt lgkmcnt(9)
    v_mfma_f32_16x16x32_bf16 v[96:99], v[128:131], v[28:31], v[96:99]
    ds_read_b128 v[120:123], v15 offset:17408
    s_waitcnt lgkmcnt(9)
    v_mfma_f32_16x16x32_bf16 v[100:103], v[132:135], v[28:31], v[100:103]
    ds_read_b128 v[124:127], v15 offset:18432
    s_waitcnt lgkmcnt(9)
    v_mfma_f32_16x16x32_bf16 v[104:107], v[136:139], v[28:31], v[104:107]
    ds_read_b128 v[128:131], v15 offset:19456
    s_waitcnt lgkmcnt(9)
    v_mfma_f32_16x16x32_bf16 v[108:111], v[140:143], v[28:31], v[108:111]
    ds_read_b128 v[132:135], v15 offset:20480
    s_waitcnt lgkmcnt(9)
    v_mfma_f32_16x16x32_bf16 v[112:115], v[144:147], v[28:31], v[112:115]
    ds_read_b128 v[136:139], v15 offset:21504
    s_waitcnt vmcnt(11)
    s_waitcnt lgkmcnt(9)
    v_mfma_f32_16x16x32_bf16 v[96:99], v[148:151], v[32:35], v[96:99]
    ds_read_b128 v[140:143], v15 offset:22528
    s_waitcnt lgkmcnt(9)
    v_mfma_f32_16x16x32_bf16 v[100:103], v[152:155], v[32:35], v[100:103]
    ds_read_b128 v[144:147], v15 offset:23552
    s_waitcnt lgkmcnt(9)
    v_mfma_f32_16x16x32_bf16 v[104:107], v[156:159], v[32:35], v[104:107]
    ds_read_b128 v[148:151], v14 offset:8192
    s_waitcnt lgkmcnt(9)
    v_mfma_f32_16x16x32_bf16 v[108:111], v[160:163], v[32:35], v[108:111]
    ds_read_b128 v[152:155], v14 offset:9216
    s_waitcnt lgkmcnt(9)
    v_mfma_f32_16x16x32_bf16 v[112:115], v[116:119], v[32:35], v[112:115]
    ds_read_b128 v[156:159], v14 offset:10240
    s_waitcnt vmcnt(10)
    s_waitcnt lgkmcnt(9)
    v_mfma_f32_16x16x32_bf16 v[96:99], v[120:123], v[36:39], v[96:99]
    ds_read_b128 v[160:163], v14 offset:11264
    s_waitcnt lgkmcnt(9)
    v_mfma_f32_16x16x32_bf16 v[100:103], v[124:127], v[36:39], v[100:103]
    ds_read_b128 v[116:119], v14 offset:12288
    s_waitcnt lgkmcnt(9)
    v_mfma_f32_16x16x32_bf16 v[104:107], v[128:131], v[36:39], v[104:107]
    ds_read_b128 v[120:123], v14 offset:13312
    s_waitcnt lgkmcnt(9)
    v_mfma_f32_16x16x32_bf16 v[108:111], v[132:135], v[36:39], v[108:111]
    ds_read_b128 v[124:127], v14 offset:14336
    s_waitcnt lgkmcnt(9)
    v_mfma_f32_16x16x32_bf16 v[112:115], v[136:139], v[36:39], v[112:115]
    ds_read_b128 v[128:131], v14 offset:15360
    s_waitcnt vmcnt(9)
    s_waitcnt lgkmcnt(9)
    v_mfma_f32_16x16x32_bf16 v[96:99], v[140:143], v[40:43], v[96:99]
    ds_read_b128 v[132:135], v15 offset:24576
    s_waitcnt lgkmcnt(9)
    v_mfma_f32_16x16x32_bf16 v[100:103], v[144:147], v[40:43], v[100:103]
    ds_read_b128 v[136:139], v15 offset:25600
    s_waitcnt lgkmcnt(9)
    v_mfma_f32_16x16x32_bf16 v[104:107], v[148:151], v[40:43], v[104:107]
    ds_read_b128 v[140:143], v15 offset:26624
    s_waitcnt lgkmcnt(9)
    v_mfma_f32_16x16x32_bf16 v[108:111], v[152:155], v[40:43], v[108:111]
    ds_read_b128 v[144:147], v15 offset:27648
    s_waitcnt lgkmcnt(9)
    v_mfma_f32_16x16x32_bf16 v[112:115], v[156:159], v[40:43], v[112:115]
    ds_read_b128 v[148:151], v15 offset:28672
    s_waitcnt vmcnt(8)
    s_waitcnt lgkmcnt(9)
    v_mfma_f32_16x16x32_bf16 v[96:99], v[160:163], v[44:47], v[96:99]
    ds_read_b128 v[152:155], v15 offset:29696
    s_waitcnt lgkmcnt(9)
    v_mfma_f32_16x16x32_bf16 v[100:103], v[116:119], v[44:47], v[100:103]
    ds_read_b128 v[156:159], v15 offset:30720
    s_waitcnt lgkmcnt(9)
    v_mfma_f32_16x16x32_bf16 v[104:107], v[120:123], v[44:47], v[104:107]
    ds_read_b128 v[160:163], v15 offset:31744
    s_waitcnt lgkmcnt(9)
    v_mfma_f32_16x16x32_bf16 v[108:111], v[124:127], v[44:47], v[108:111]
    ds_read_b128 v[116:119], v15 offset:32768
    s_waitcnt lgkmcnt(9)
    v_mfma_f32_16x16x32_bf16 v[112:115], v[128:131], v[44:47], v[112:115]
    ds_read_b128 v[120:123], v15 offset:33792
    s_waitcnt vmcnt(7)
    s_waitcnt lgkmcnt(9)
    v_mfma_f32_16x16x32_bf16 v[96:99], v[132:135], v[48:51], v[96:99]
    ds_read_b128 v[124:127], v15 offset:34816
    s_waitcnt lgkmcnt(9)
    v_mfma_f32_16x16x32_bf16 v[100:103], v[136:139], v[48:51], v[100:103]
    ds_read_b128 v[128:131], v15 offset:35840
    s_waitcnt lgkmcnt(9)
    v_mfma_f32_16x16x32_bf16 v[104:107], v[140:143], v[48:51], v[104:107]
    ds_read_b128 v[132:135], v14 offset:16384
    s_waitcnt lgkmcnt(9)
    v_mfma_f32_16x16x32_bf16 v[108:111], v[144:147], v[48:51], v[108:111]
    ds_read_b128 v[136:139], v14 offset:17408
    s_waitcnt lgkmcnt(9)
    v_mfma_f32_16x16x32_bf16 v[112:115], v[148:151], v[48:51], v[112:115]
    ds_read_b128 v[140:143], v14 offset:18432
    s_waitcnt vmcnt(6)
    s_waitcnt lgkmcnt(9)
    v_mfma_f32_16x16x32_bf16 v[96:99], v[152:155], v[52:55], v[96:99]
    ds_read_b128 v[144:147], v14 offset:19456
    s_waitcnt lgkmcnt(9)
    v_mfma_f32_16x16x32_bf16 v[100:103], v[156:159], v[52:55], v[100:103]
    ds_read_b128 v[148:151], v14 offset:20480
    s_waitcnt lgkmcnt(9)
    v_mfma_f32_16x16x32_bf16 v[104:107], v[160:163], v[52:55], v[104:107]
    ds_read_b128 v[152:155], v14 offset:21504
    s_waitcnt lgkmcnt(9)
    v_mfma_f32_16x16x32_bf16 v[108:111], v[116:119], v[52:55], v[108:111]
    ds_read_b128 v[156:159], v14 offset:22528
    s_waitcnt lgkmcnt(9)
    v_mfma_f32_16x16x32_bf16 v[112:115], v[120:123], v[52:55], v[112:115]
    ds_read_b128 v[160:163], v14 offset:23552
    s_waitcnt vmcnt(5)
    s_waitcnt lgkmcnt(9)
    v_mfma_f32_16x16x32_bf16 v[96:99], v[124:127], v[56:59], v[96:99]
    ds_read_b128 v[116:119], v15 offset:36864
    s_waitcnt lgkmcnt(9)
    v_mfma_f32_16x16x32_bf16 v[100:103], v[128:131], v[56:59], v[100:103]
    ds_read_b128 v[120:123], v15 offset:37888
    s_waitcnt lgkmcnt(9)
    v_mfma_f32_16x16x32_bf16 v[104:107], v[132:135], v[56:59], v[104:107]
    ds_read_b128 v[124:127], v15 offset:38912
    s_waitcnt lgkmcnt(9)
    v_mfma_f32_16x16x32_bf16 v[108:111], v[136:139], v[56:59], v[108:111]
    ds_read_b128 v[128:131], v15 offset:39936
    s_waitcnt lgkmcnt(9)
    v_mfma_f32_16x16x32_bf16 v[112:115], v[140:143], v[56:59], v[112:115]
    ds_read_b128 v[132:135], v15 offset:40960
    s_waitcnt vmcnt(4)
    s_waitcnt lgkmcnt(9)
    v_mfma_f32_16x16x32_bf16 v[96:99], v[144:147], v[60:63], v[96:99]
    ds_read_b128 v[136:139], v15 offset:41984
    s_waitcnt lgkmcnt(9)
    v_mfma_f32_16x16x32_bf16 v[100:103], v[148:151], v[60:63], v[100:103]
    ds_read_b128 v[140:143], v15 offset:43008
    s_waitcnt lgkmcnt(9)
    v_mfma_f32_16x16x32_bf16 v[104:107], v[152:155], v[60:63], v[104:107]
    ds_read_b128 v[144:147], v15 offset:44032
    s_waitcnt lgkmcnt(9)
    v_mfma_f32_16x16x32_bf16 v[108:111], v[156:159], v[60:63], v[108:111]
    ds_read_b128 v[148:151], v15 offset:45056
    s_waitcnt lgkmcnt(9)
    v_mfma_f32_16x16x32_bf16 v[112:115], v[160:163], v[60:63], v[112:115]
    ds_read_b128 v[152:155], v15 offset:46080
    s_waitcnt vmcnt(3)
    s_waitcnt lgkmcnt(9)
    v_mfma_f32_16x16x32_bf16 v[96:99], v[116:119], v[64:67], v[96:99]
    ds_read_b128 v[156:159], v15 offset:47104
    s_waitcnt lgkmcnt(9)
    v_mfma_f32_16x16x32_bf16 v[100:103], v[120:123], v[64:67], v[100:103]
    ds_read_b128 v[160:163], v15 offset:48128
    s_waitcnt lgkmcnt(9)
    v_mfma_f32_16x16x32_bf16 v[104:107], v[124:127], v[64:67], v[104:107]
    ds_read_b128 v[116:119], v14 offset:24576
    s_waitcnt lgkmcnt(9)
    v_mfma_f32_16x16x32_bf16 v[108:111], v[128:131], v[64:67], v[108:111]
    ds_read_b128 v[120:123], v14 offset:25600
    s_waitcnt lgkmcnt(9)
    v_mfma_f32_16x16x32_bf16 v[112:115], v[132:135], v[64:67], v[112:115]
    ds_read_b128 v[124:127], v14 offset:26624
    s_waitcnt vmcnt(2)
    s_waitcnt lgkmcnt(9)
    v_mfma_f32_16x16x32_bf16 v[96:99], v[136:139], v[68:71], v[96:99]
    ds_read_b128 v[128:131], v14 offset:27648
    s_waitcnt lgkmcnt(9)
    v_mfma_f32_16x16x32_bf16 v[100:103], v[140:143], v[68:71], v[100:103]
    ds_read_b128 v[132:135], v14 offset:28672
    s_waitcnt lgkmcnt(9)
    v_mfma_f32_16x16x32_bf16 v[104:107], v[144:147], v[68:71], v[104:107]
    ds_read_b128 v[136:139], v14 offset:29696
    s_waitcnt lgkmcnt(9)
    v_mfma_f32_16x16x32_bf16 v[108:111], v[148:151], v[68:71], v[108:111]
    ds_read_b128 v[140:143], v14 offset:30720
    s_waitcnt lgkmcnt(9)
    v_mfma_f32_16x16x32_bf16 v[112:115], v[152:155], v[68:71], v[112:115]
    ds_read_b128 v[144:147], v14 offset:31744
    s_waitcnt vmcnt(1)
    s_waitcnt lgkmcnt(9)
    v_mfma_f32_16x16x32_bf16 v[96:99], v[156:159], v[72:75], v[96:99]
    s_waitcnt lgkmcnt(8)
    v_mfma_f32_16x16x32_bf16 v[100:103], v[160:163], v[72:75], v[100:103]
    s_waitcnt lgkmcnt(7)
    v_mfma_f32_16x16x32_bf16 v[104:107], v[116:119], v[72:75], v[104:107]
    s_waitcnt lgkmcnt(6)
    v_mfma_f32_16x16x32_bf16 v[108:111], v[120:123], v[72:75], v[108:111]
    s_waitcnt lgkmcnt(5)
    v_mfma_f32_16x16x32_bf16 v[112:115], v[124:127], v[72:75], v[112:115]
    s_waitcnt vmcnt(0)
    s_waitcnt lgkmcnt(4)
    v_mfma_f32_16x16x32_bf16 v[96:99], v[128:131], v[76:79], v[96:99]
    s_waitcnt lgkmcnt(3)
    v_mfma_f32_16x16x32_bf16 v[100:103], v[132:135], v[76:79], v[100:103]
    s_waitcnt lgkmcnt(2)
    v_mfma_f32_16x16x32_bf16 v[104:107], v[136:139], v[76:79], v[104:107]
    s_waitcnt lgkmcnt(1)
    v_mfma_f32_16x16x32_bf16 v[108:111], v[140:143], v[76:79], v[108:111]
    s_waitcnt lgkmcnt(0)
    v_mfma_f32_16x16x32_bf16 v[112:115], v[144:147], v[76:79], v[112:115]
    v_cvt_pk_bf16_f32 v240, v96, v97
    v_cvt_pk_bf16_f32 v241, v98, v99
    v_cvt_pk_bf16_f32 v242, v100, v101
    v_cvt_pk_bf16_f32 v243, v102, v103
    v_cvt_pk_bf16_f32 v244, v104, v105
    v_cvt_pk_bf16_f32 v245, v106, v107
    v_cvt_pk_bf16_f32 v246, v108, v109
    v_cvt_pk_bf16_f32 v247, v110, v111
    v_cvt_pk_bf16_f32 v248, v112, v113
    v_cvt_pk_bf16_f32 v249, v114, v115
    buffer_store_dwordx4 v[240:243], v6, s[12:15], s44 offen
    buffer_store_dwordx4 v[244:247], v6, s[12:15], s44 offen offset:64
    buffer_store_dwordx2 v[248:249], v7, s[12:15], s44 offen offset:128
    s_or_b32 s56, s2, s32
    s_cmp_lg_u32 s56, 0
    s_cbranch_scc1 interleave_layers__spectral_fnet__glu_gated_glu__prompt_kernel_fin
    v_mov_b32 v252, s100
    v_mov_b32 v253, s101
    s_mov_b32 s56, 37224448
    s_mov_b64 exec, 1
    buffer_store_dwordx2 v[252:253], v3, s[8:11], s56 offen
    s_mov_b64 exec, -1
interleave_layers__spectral_fnet__glu_gated_glu__prompt_kernel_fin:
interleave_layers__spectral_fnet__glu_gated_glu__prompt_kernel_end:
    s_endpgm
code_end:
.section .rodata,"a"
.p2align 6
.amdhsa_kernel interleave_layers__spectral_fnet__glu_gated_glu__prompt_kernel
  .amdhsa_next_free_vgpr 512
  .amdhsa_next_free_sgpr 102
  .amdhsa_accum_offset 256
  .amdhsa_group_segment_fixed_size 0
  .amdhsa_kernarg_size 96
  .amdhsa_user_sgpr_count 2
  .amdhsa_user_sgpr_kernarg_segment_ptr 1
  .amdhsa_system_sgpr_workgroup_id_x 1
.end_amdhsa_kernel
```
